```python
import torch

def _softmax(x, axis=-1):
    return torch.softmax(x, dim=axis)
def _gelu(x):
    return torch.nn.functional.gelu(x, approximate="tanh")
def _silu(x):
    return torch.nn.functional.silu(x)
def _sigmoid(x):
    return torch.sigmoid(x)
def _layernorm(x, axis=-1, eps=1e-5):
    m = x.mean(dim=axis, keepdim=True)
    v = x.var(dim=axis, keepdim=True, unbiased=False)
    return (x - m) / torch.sqrt(v + eps)
def _scatter_add(tgt, idx, src, axis=0):
    return tgt.clone().index_add_(axis, idx, src)
def _segment_sum(src, seg, n):
    out = torch.zeros((n,) + src.shape[1:], dtype=src.dtype)
    return out.index_add_(0, seg, src)
def _pad(x, pw):
    flat = tuple(v for pair in reversed(pw) for v in pair)
    return torch.nn.functional.pad(x, flat)

kernel_name = 'standalone__gqa_softmax__near_ridge'

def setup_inputs():

    _w = (lambda a: (lambda t: t.to(torch.bfloat16) if t.is_floating_point() else t)(torch.as_tensor(a)))
    B, Hq, Hkv, Sq, Sk, D = 16, 32, 4, 384, 384, 128
    return {
        "q": _w((lambda *s: torch.randn(*s, dtype=torch.bfloat16) * 0.8)(B, Hq, Sq, D)),
        "k": _w((lambda *s: torch.randn(*s, dtype=torch.bfloat16) * 0.8)(B, Hkv, Sk, D)),
        "v": _w((lambda *s: torch.randn(*s, dtype=torch.bfloat16) * 0.05)(B, Hkv, Sk, D)),
    }

def reference(q, k, v):
    B, Hq, Sq, D = q.shape
    Hkv = k.shape[1]
    rep = Hq // Hkv
    k = (lambda x, n, axis: torch.repeat_interleave(x, n, dim=axis))(k, rep, axis=1)
    v = (lambda x, n, axis: torch.repeat_interleave(x, n, dim=axis))(v, rep, axis=1)
    scale = D ** -0.5
    scores = torch.einsum("bhqd,bhkd->bhqk", q, k) * scale
    p = _softmax(scores, axis=-1)
    return torch.einsum("bhqk,bhkd->bhqd", p, v)
```

```asm
; @launch grid=(256,1,1) block=(256,1,1) lds=163840
.amdgcn_target "amdgcn-amd-amdhsa--gfx950"
.text
.globl standalone__gqa_softmax__near_ridge_kernel
.p2align 8
.type standalone__gqa_softmax__near_ridge_kernel,@function
standalone__gqa_softmax__near_ridge_kernel:
  s_cmp_ge_u32 s2, 256
  s_cbranch_scc1 L_end
  s_load_dwordx4 s[4:7], s[0:1], 0
  s_load_dwordx4 s[8:11], s[0:1], 16
  v_lshrrev_b32 v1, 6, v0
  v_and_b32 v0, 63, v0
  s_nop 1
  v_readfirstlane_b32 s3, v1
  s_getpc_b64 s[60:61]
  L_pc:
  v_lshlrev_b32 v2, 7, v0
  s_lshl_b32 s62, s3, 14
  v_add_u32 v2, s62, v2
  s_mov_b32 s62, L_end - L_pc - 4
  v_add_u32 v3, 0x2000, v2
  v_min_u32 v2, s62, v2
  v_min_u32 v3, s62, v3
  global_load_dword v200, v2, s[60:61]
  global_load_dword v201, v3, s[60:61]
  s_and_b32 s12, s2, 7
  s_lshr_b32 s13, s2, 5
  s_lshl_b32 s13, s13, 3
  s_add_u32 s12, s12, s13
  s_lshr_b32 s13, s2, 3
  s_and_b32 s13, s13, 3
  s_mul_i32 s14, s12, 98304
  s_mul_i32 s15, s12, 3072
  s_mul_i32 s16, s13, 768
  s_add_u32 s15, s15, s16
  s_mul_i32 s16, s3, 192
  s_add_u32 s15, s15, s16
  s_lshl_b32 s15, s15, 8
  s_lshl_b32 s40, s3, 10
  v_lshrrev_b32 v1, 5, v0
  v_and_b32 v2, 31, v0
  v_lshlrev_b32 v6, 8, v2
  v_lshlrev_b32 v7, 4, v1
  v_add_u32 v220, v6, v7
  s_mov_b32 s46, 0
  s_mov_b32 s52, 4096
  s_mov_b32 s47, 8192
  s_mov_b32 s53, 12288
  s_mov_b32 s48, 16384
  s_mov_b32 s54, 20480
  s_mov_b32 s49, 24576
  s_mov_b32 s55, 28672
  s_mov_b32 s50, 32768
  s_mov_b32 s56, 36864
  s_mov_b32 s51, 40960
  s_mov_b32 s57, 45056
  s_waitcnt lgkmcnt(0)
  s_add_u32 s20, s4, s15
  s_addc_u32 s21, s5, 0
  s_mov_b32 s22, 49152
  s_mov_b32 s23, 0x00020000
  v_lshrrev_b32 v6, 2, v0
  v_lshlrev_b32 v6, 8, v6
  v_and_b32 v7, 3, v0
  v_lshlrev_b32 v7, 4, v7
  v_add_u32 v249, v6, v7
  buffer_load_dwordx4 a[192:195], v249, s[20:23], s46 offen offset:0 nt
  buffer_load_dwordx4 a[200:203], v249, s[20:23], s46 offen offset:64 nt
  buffer_load_dwordx4 a[196:199], v249, s[20:23], s52 offen offset:0 nt
  buffer_load_dwordx4 a[204:207], v249, s[20:23], s52 offen offset:64 nt
  buffer_load_dwordx4 a[208:211], v249, s[20:23], s46 offen offset:128 nt
  buffer_load_dwordx4 a[216:219], v249, s[20:23], s46 offen offset:192 nt
  buffer_load_dwordx4 a[212:215], v249, s[20:23], s52 offen offset:128 nt
  buffer_load_dwordx4 a[220:223], v249, s[20:23], s52 offen offset:192 nt
  s_add_u32 s24, s6, s14
  s_addc_u32 s25, s7, 0
  s_mov_b32 s26, 98304
  s_mov_b32 s27, 0x00020000
  s_add_u32 s28, s8, s14
  s_addc_u32 s29, s9, 0
  s_mov_b32 s30, 98304
  s_mov_b32 s31, 0x00020000
  s_add_u32 s32, s10, s15
  s_addc_u32 s33, s11, 0
  s_mov_b32 s34, 49152
  s_mov_b32 s35, 0x00020000
  s_mul_i32 s16, s13, 3
  s_add_u32 s17, s16, 0
  s_sub_u32 s18, s17, 12
  s_cmp_ge_u32 s17, 12
  s_cselect_b32 s17, s18, s17
  s_lshl_b32 s17, s17, 13
  s_add_u32 s4, s17, s40
  s_add_u32 s17, s16, 1
  s_sub_u32 s18, s17, 12
  s_cmp_ge_u32 s17, 12
  s_cselect_b32 s17, s18, s17
  s_lshl_b32 s17, s17, 13
  s_add_u32 s5, s17, s40
  s_add_u32 s17, s16, 2
  s_sub_u32 s18, s17, 12
  s_cmp_ge_u32 s17, 12
  s_cselect_b32 s17, s18, s17
  s_lshl_b32 s17, s17, 13
  s_add_u32 s6, s17, s40
  s_add_u32 s17, s16, 3
  s_sub_u32 s18, s17, 12
  s_cmp_ge_u32 s17, 12
  s_cselect_b32 s17, s18, s17
  s_lshl_b32 s17, s17, 13
  s_add_u32 s7, s17, s40
  s_add_u32 s17, s16, 4
  s_sub_u32 s18, s17, 12
  s_cmp_ge_u32 s17, 12
  s_cselect_b32 s17, s18, s17
  s_lshl_b32 s17, s17, 13
  s_add_u32 s8, s17, s40
  s_add_u32 s17, s16, 5
  s_sub_u32 s18, s17, 12
  s_cmp_ge_u32 s17, 12
  s_cselect_b32 s17, s18, s17
  s_lshl_b32 s17, s17, 13
  s_add_u32 s9, s17, s40
  s_add_u32 s17, s16, 6
  s_sub_u32 s18, s17, 12
  s_cmp_ge_u32 s17, 12
  s_cselect_b32 s17, s18, s17
  s_lshl_b32 s17, s17, 13
  s_add_u32 s10, s17, s40
  s_add_u32 s17, s16, 7
  s_sub_u32 s18, s17, 12
  s_cmp_ge_u32 s17, 12
  s_cselect_b32 s17, s18, s17
  s_lshl_b32 s17, s17, 13
  s_add_u32 s11, s17, s40
  s_add_u32 s17, s16, 8
  s_sub_u32 s18, s17, 12
  s_cmp_ge_u32 s17, 12
  s_cselect_b32 s17, s18, s17
  s_lshl_b32 s17, s17, 13
  s_add_u32 s58, s17, s40
  s_add_u32 s17, s16, 9
  s_sub_u32 s18, s17, 12
  s_cmp_ge_u32 s17, 12
  s_cselect_b32 s17, s18, s17
  s_lshl_b32 s17, s17, 13
  s_add_u32 s59, s17, s40
  s_add_u32 s17, s16, 10
  s_sub_u32 s18, s17, 12
  s_cmp_ge_u32 s17, 12
  s_cselect_b32 s17, s18, s17
  s_lshl_b32 s17, s17, 13
  s_add_u32 s60, s17, s40
  s_add_u32 s17, s16, 11
  s_sub_u32 s18, s17, 12
  s_cmp_ge_u32 s17, 12
  s_cselect_b32 s17, s18, s17
  s_lshl_b32 s17, s17, 13
  s_add_u32 s61, s17, s40
  v_and_b32 v3, 15, v0
  v_lshrrev_b32 v5, 4, v0
  v_and_b32 v4, 1, v5
  v_lshlrev_b32 v6, 2, v5
  v_xor_b32 v7, v3, v6
  v_lshlrev_b32 v7, 4, v7
  v_lshlrev_b32 v8, 8, v5
  v_add_u32 v254, v7, v8
  s_lshl_b32 s41, s3, 2
  v_add_u32 v6, s41, v5
  v_xor_b32 v7, v3, v6
  v_lshlrev_b32 v7, 4, v7
  v_add_u32 v253, v7, v8
  s_add_u32 m0, s40, 0
  s_add_u32 s41, s4, 0
  buffer_load_dwordx4 v253, s[24:27], s41 offen lds
  s_add_u32 m0, s40, 4096
  s_add_u32 s41, s4, 4096
  buffer_load_dwordx4 v253, s[24:27], s41 offen lds
  s_add_u32 m0, s40, 90112
  s_add_u32 s41, s4, 0
  buffer_load_dwordx4 v254, s[28:31], s41 offen lds
  s_add_u32 m0, s40, 94208
  s_add_u32 s41, s4, 4096
  buffer_load_dwordx4 v254, s[28:31], s41 offen lds
  s_add_u32 m0, s40, 8192
  s_add_u32 s41, s5, 0
  buffer_load_dwordx4 v253, s[24:27], s41 offen lds
  s_add_u32 m0, s40, 12288
  s_add_u32 s41, s5, 4096
  buffer_load_dwordx4 v253, s[24:27], s41 offen lds
  s_add_u32 m0, s40, 98304
  s_add_u32 s41, s5, 0
  buffer_load_dwordx4 v254, s[28:31], s41 offen lds
  s_add_u32 m0, s40, 102400
  s_add_u32 s41, s5, 4096
  buffer_load_dwordx4 v254, s[28:31], s41 offen lds
  s_mov_b32 s42, 0x3e0293ee
  s_mov_b32 s43, 0xbe0293ee
  s_mov_b32 s44, 0x47800000
  s_mov_b32 s45, 0
  s_lshl_b32 s36, s3, 11
  s_add_u32 s36, s36, 155648
  v_lshlrev_b32 v6, 8, v2
  v_xor_b32 v7, v1, v3
  v_lshlrev_b32 v7, 4, v7
  v_add_u32 v208, v6, v7
  v_xor_b32 v209, 32, v208
  v_xor_b32 v210, 64, v208
  v_xor_b32 v211, 96, v208
  v_xor_b32 v212, 128, v208
  v_xor_b32 v213, 160, v208
  v_xor_b32 v214, 192, v208
  v_xor_b32 v215, 224, v208
  v_lshrrev_b32 v6, 2, v3
  v_lshlrev_b32 v7, 2, v1
  v_add_u32 v7, v7, v6
  v_lshlrev_b32 v7, 8, v7
  v_lshlrev_b32 v8, 6, v6
  v_add_u32 v7, v7, v8
  v_lshlrev_b32 v8, 5, v4
  v_add_u32 v7, v7, v8
  v_and_b32 v8, 3, v3
  v_lshlrev_b32 v8, 3, v8
  v_add_u32 v7, v7, v8
  v_xor_b32 v8, 0, v7
  v_add_u32 v216, 90112, v8
  v_xor_b32 v8, 64, v7
  v_add_u32 v217, 90112, v8
  v_xor_b32 v8, 128, v7
  v_add_u32 v218, 90112, v8
  v_xor_b32 v8, 192, v7
  v_add_u32 v219, 90112, v8
  v_lshrrev_b32 v6, 2, v2
  v_and_b32 v6, 3, v6
  v_and_b32 v7, 2, v2
  v_xor_b32 v6, v6, v7
  v_xor_b32 v6, v6, v1
  v_lshlrev_b32 v6, 4, v6
  v_lshlrev_b32 v7, 6, v2
  v_add_u32 v6, v6, v7
  v_xor_b32 v7, 0, v6
  v_add_u32 v245, s36, v7
  v_xor_b32 v7, 32, v6
  v_add_u32 v246, s36, v7
  v_lshrrev_b32 v6, 2, v0
  v_and_b32 v8, 2, v6
  v_lshlrev_b32 v6, 6, v6
  v_and_b32 v7, 3, v0
  v_xor_b32 v7, v7, v5
  v_xor_b32 v7, v7, v8
  v_lshlrev_b32 v7, 4, v7
  v_add_u32 v6, v6, v7
  v_add_u32 v250, s36, v6
  s_waitcnt vmcnt(15)
  ds_write_b128 v250, a[192:195] offset:0
  s_waitcnt vmcnt(13)
  ds_write_b128 v250, a[196:199] offset:1024
  ds_read_b128 a[128:131], v245
  ds_read_b128 a[132:135], v246
  ds_write_b128 v250, a[200:203] offset:0
  s_waitcnt vmcnt(12)
  ds_write_b128 v250, a[204:207] offset:1024
  ds_read_b128 a[136:139], v245
  ds_read_b128 a[140:143], v246
  s_waitcnt vmcnt(11)
  ds_write_b128 v250, a[208:211] offset:0
  s_waitcnt vmcnt(9)
  ds_write_b128 v250, a[212:215] offset:1024
  ds_read_b128 a[144:147], v245
  ds_read_b128 a[148:151], v246
  ds_write_b128 v250, a[216:219] offset:0
  s_waitcnt vmcnt(8)
  ds_write_b128 v250, a[220:223] offset:1024
  ds_read_b128 a[152:155], v245
  ds_read_b128 a[156:159], v246
  v_lshrrev_b32 v6, 2, v2
  v_and_b32 v6, 3, v6
  v_and_b32 v7, 2, v2
  v_xor_b32 v6, v6, v7
  v_lshlrev_b32 v6, 4, v6
  v_lshlrev_b32 v7, 6, v2
  v_add_u32 v6, v6, v7
  v_lshlrev_b32 v7, 3, v1
  v_add_u32 v6, v6, v7
  v_add_u32 v247, s36, v6
  v_xor_b32 v248, 16, v247
  v_xor_b32 v255, 32, v247
  s_waitcnt vmcnt(6)
  s_barrier
  ds_read_b128 v[192:195], v208 offset:0
  ds_read_b128 v[196:199], v209 offset:0
  ds_read_b128 v[200:203], v210 offset:0
  ds_read_b128 v[204:207], v211 offset:0
  ds_read_b128 v[144:147], v212 offset:0
  ds_read_b128 v[148:151], v213 offset:0
  ds_read_b128 v[152:155], v214 offset:0
  s_waitcnt lgkmcnt(6)
  v_mfma_f32_32x32x16_bf16 v[128:143], v[192:195], a[128:131], 0
  ds_read_b128 v[156:159], v215 offset:0
  s_add_u32 m0, s40, 16384
  s_add_u32 s41, s6, 0
  buffer_load_dwordx4 v253, s[24:27], s41 offen lds
  s_waitcnt vmcnt(3)
  s_barrier
  s_waitcnt lgkmcnt(6)
  v_mfma_f32_32x32x16_bf16 v[128:143], v[196:199], a[132:135], v[128:143]
  ds_read_b128 v[192:195], v208 offset:8192
  s_add_u32 m0, s40, 20480
  s_add_u32 s41, s6, 4096
  buffer_load_dwordx4 v253, s[24:27], s41 offen lds
  s_waitcnt lgkmcnt(6)
  v_mfma_f32_32x32x16_bf16 v[128:143], v[200:203], a[136:139], v[128:143]
  ds_read_b128 v[196:199], v209 offset:8192
  s_add_u32 m0, s40, 106496
  s_add_u32 s41, s6, 0
  buffer_load_dwordx4 v254, s[28:31], s41 offen lds
  s_waitcnt lgkmcnt(6)
  v_mfma_f32_32x32x16_bf16 v[128:143], v[204:207], a[140:143], v[128:143]
  ds_read_b128 v[200:203], v210 offset:8192
  s_add_u32 m0, s40, 110592
  s_add_u32 s41, s6, 4096
  buffer_load_dwordx4 v254, s[28:31], s41 offen lds
  s_waitcnt lgkmcnt(4)
  v_mfma_f32_32x32x16_bf16 v[128:143], v[144:147], a[144:147], v[128:143]
  ds_read_b128 v[204:207], v211 offset:8192
  v_mfma_f32_32x32x16_bf16 v[128:143], v[148:151], a[148:151], v[128:143]
  ds_read_b128 v[144:147], v212 offset:8192
  v_mfma_f32_32x32x16_bf16 v[128:143], v[152:155], a[152:155], v[128:143]
  ds_read_b128 v[148:151], v213 offset:8192
  s_waitcnt lgkmcnt(4)
  v_mfma_f32_32x32x16_bf16 v[128:143], v[156:159], a[156:159], v[128:143]
  ds_read_b128 v[152:155], v214 offset:8192
  v_mfma_f32_32x32x16_bf16 v[160:175], v[192:195], a[128:131], 0
  ds_read_b128 v[156:159], v215 offset:8192
  s_add_u32 m0, s40, 24576
  s_add_u32 s41, s7, 0
  buffer_load_dwordx4 v253, s[24:27], s41 offen lds
  v_mfma_f32_32x32x16_bf16 v[160:175], v[196:199], a[132:135], v[160:175]
  ds_read_b64_tr_b16 v[192:193], v216 offset:0
  ds_read_b64_tr_b16 v[194:195], v216 offset:2048
  s_add_u32 m0, s40, 28672
  s_add_u32 s41, s7, 4096
  buffer_load_dwordx4 v253, s[24:27], s41 offen lds
  v_max3_f32 v233, v128, v129, v130
  v_max3_f32 v234, v131, v132, v133
  v_max3_f32 v235, v134, v135, v136
  v_max3_f32 v236, v137, v138, v139
  v_max3_f32 v233, v233, v140, v141
  v_max3_f32 v234, v234, v142, v143
  v_max3_f32 v235, v235, v236, v233
  v_max_f32 v233, v234, v235
  v_mov_b32 v234, v233
  s_nop 1
  v_permlane32_swap_b32 v233, v234
  v_max_f32 v233, v233, v234
  s_waitcnt lgkmcnt(5)
  v_mfma_f32_32x32x16_bf16 v[160:175], v[200:203], a[136:139], v[160:175]
  ds_read_b64_tr_b16 v[196:197], v217 offset:0
  ds_read_b64_tr_b16 v[198:199], v217 offset:2048
  s_add_u32 m0, s40, 114688
  s_add_u32 s41, s7, 0
  buffer_load_dwordx4 v254, s[28:31], s41 offen lds
  v_mul_f32 v221, s43, v233
  v_fma_f32 v128, v128, s42, v221
  v_fma_f32 v129, v129, s42, v221
  v_fma_f32 v130, v130, s42, v221
  v_exp_f32 v128, v128
  v_fma_f32 v131, v131, s42, v221
  v_exp_f32 v129, v129
  v_fma_f32 v132, v132, s42, v221
  v_exp_f32 v130, v130
  v_mfma_f32_32x32x16_bf16 v[160:175], v[204:207], a[140:143], v[160:175]
  ds_read_b64_tr_b16 v[200:201], v218 offset:0
  ds_read_b64_tr_b16 v[202:203], v218 offset:2048
  s_add_u32 m0, s40, 118784
  s_add_u32 s41, s7, 4096
  buffer_load_dwordx4 v254, s[28:31], s41 offen lds
  v_add_f32 v225, 0, v128
  v_fma_f32 v133, v133, s42, v221
  v_exp_f32 v131, v131
  v_add_f32 v226, 0, v129
  v_fma_f32 v134, v134, s42, v221
  v_exp_f32 v132, v132
  v_add_f32 v225, v225, v130
  v_cvt_pk_bf16_f32 v128, v128, v129
  v_fma_f32 v135, v135, s42, v221
  v_exp_f32 v133, v133
  v_mfma_f32_32x32x16_bf16 v[160:175], v[144:147], a[144:147], v[160:175]
  ds_read_b64_tr_b16 v[204:205], v219 offset:0
  ds_read_b64_tr_b16 v[206:207], v219 offset:2048
  s_add_u32 m0, s40, 57344
  s_add_u32 s41, s58, 0
  buffer_load_dwordx4 v254, s[28:31], s41 offen lds
  v_add_f32 v226, v226, v131
  v_fma_f32 v136, v136, s42, v221
  v_exp_f32 v134, v134
  v_add_f32 v225, v225, v132
  v_cvt_pk_bf16_f32 v129, v130, v131
  v_fma_f32 v137, v137, s42, v221
  v_exp_f32 v135, v135
  s_add_u32 m0, s40, 61440
  s_add_u32 s41, s58, 4096
  buffer_load_dwordx4 v254, s[28:31], s41 offen lds
  s_waitcnt lgkmcnt(8)
  v_mfma_f32_32x32x16_bf16 v[160:175], v[148:151], a[148:151], v[160:175]
  ds_read_b64_tr_b16 v[144:145], v216 offset:4096
  ds_read_b64_tr_b16 v[146:147], v216 offset:6144
  s_add_u32 m0, s40, 65536
  s_add_u32 s41, s59, 0
  buffer_load_dwordx4 v254, s[28:31], s41 offen lds
  v_add_f32 v226, v226, v133
  v_fma_f32 v138, v138, s42, v221
  v_exp_f32 v136, v136
  v_add_f32 v225, v225, v134
  v_cvt_pk_bf16_f32 v130, v132, v133
  v_fma_f32 v139, v139, s42, v221
  v_exp_f32 v137, v137
  s_add_u32 m0, s40, 69632
  s_add_u32 s41, s59, 4096
  buffer_load_dwordx4 v254, s[28:31], s41 offen lds
  v_mfma_f32_32x32x16_bf16 v[160:175], v[152:155], a[152:155], v[160:175]
  ds_read_b64_tr_b16 v[148:149], v217 offset:4096
  ds_read_b64_tr_b16 v[150:151], v217 offset:6144
  s_add_u32 m0, s40, 73728
  s_add_u32 s41, s60, 0
  buffer_load_dwordx4 v254, s[28:31], s41 offen lds
  s_add_u32 m0, s40, 77824
  s_add_u32 s41, s60, 4096
  buffer_load_dwordx4 v254, s[28:31], s41 offen lds
  v_add_f32 v226, v226, v135
  v_fma_f32 v140, v140, s42, v221
  v_exp_f32 v138, v138
  v_add_f32 v225, v225, v136
  v_cvt_pk_bf16_f32 v131, v134, v135
  s_add_u32 m0, s40, 81920
  s_add_u32 s41, s61, 0
  buffer_load_dwordx4 v254, s[28:31], s41 offen lds
  v_mfma_f32_32x32x16_bf16 v[160:175], v[156:159], a[156:159], v[160:175]
  ds_read_b64_tr_b16 v[152:153], v218 offset:4096
  ds_read_b64_tr_b16 v[154:155], v218 offset:6144
  s_add_u32 m0, s40, 86016
  s_add_u32 s41, s61, 4096
  buffer_load_dwordx4 v254, s[28:31], s41 offen lds
  v_fma_f32 v141, v141, s42, v221
  v_exp_f32 v139, v139
  v_add_f32 v226, v226, v137
  v_fma_f32 v142, v142, s42, v221
  s_waitcnt lgkmcnt(8)
  v_mfma_f32_32x32x16_bf16 v[0:15], v[192:195], v[128:131], 0
  ds_read_b64_tr_b16 v[156:157], v219 offset:4096
  ds_read_b64_tr_b16 v[158:159], v219 offset:6144
  v_exp_f32 v140, v140
  v_add_f32 v225, v225, v138
  v_cvt_pk_bf16_f32 v136, v136, v137
  v_fma_f32 v143, v143, s42, v221
  s_waitcnt vmcnt(14)
  s_barrier
  s_add_u32 m0, s40, 32768
  s_add_u32 s41, s8, 0
  buffer_load_dwordx4 v253, s[24:27], s41 offen lds
  v_mfma_f32_32x32x16_bf16 v[16:31], v[196:199], v[128:131], 0
  ds_read_b128 v[192:195], v208 offset:16384
  buffer_load_dwordx4 a[192:195], v249, s[20:23], s47 offen offset:0 nt
  buffer_load_dwordx4 a[200:203], v249, s[20:23], s47 offen offset:64 nt
  v_exp_f32 v141, v141
  v_add_f32 v226, v226, v139
  v_exp_f32 v142, v142
  v_add_f32 v225, v225, v140
  v_cvt_pk_bf16_f32 v137, v138, v139
  v_mfma_f32_32x32x16_bf16 v[32:47], v[200:203], v[128:131], 0
  ds_read_b128 v[196:199], v209 offset:16384
  v_exp_f32 v143, v143
  v_add_f32 v226, v226, v141
  v_add_f32 v225, v225, v142
  v_cvt_pk_bf16_f32 v138, v140, v141
  v_add_f32 v226, v226, v143
  v_cvt_pk_bf16_f32 v139, v142, v143
  s_add_u32 m0, s40, 36864
  s_add_u32 s41, s8, 4096
  buffer_load_dwordx4 v253, s[24:27], s41 offen lds
  s_waitcnt lgkmcnt(6)
  v_mfma_f32_32x32x16_bf16 v[48:63], v[204:207], v[128:131], 0
  ds_read_b128 v[200:203], v210 offset:16384
  v_fma_f32 v160, v160, s42, v221
  v_fma_f32 v161, v161, s42, v221
  v_fma_f32 v162, v162, s42, v221
  v_exp_f32 v160, v160
  v_fma_f32 v163, v163, s42, v221
  v_mfma_f32_32x32x16_bf16 v[0:15], v[144:147], v[136:139], v[0:15]
  ds_read_b128 v[204:207], v211 offset:16384
  s_add_u32 m0, s40, 122880
  s_add_u32 s41, s8, 0
  buffer_load_dwordx4 v254, s[28:31], s41 offen lds
  v_exp_f32 v161, v161
  v_fma_f32 v164, v164, s42, v221
  v_mfma_f32_32x32x16_bf16 v[16:31], v[148:151], v[136:139], v[16:31]
  ds_read_b128 v[144:147], v212 offset:16384
  v_exp_f32 v162, v162
  v_add_f32 v225, v225, v160
  v_fma_f32 v165, v165, s42, v221
  v_exp_f32 v163, v163
  s_waitcnt lgkmcnt(4)
  v_mfma_f32_32x32x16_bf16 v[32:47], v[152:155], v[136:139], v[32:47]
  ds_read_b128 v[148:151], v213 offset:16384
  s_add_u32 m0, s40, 126976
  s_add_u32 s41, s8, 4096
  buffer_load_dwordx4 v254, s[28:31], s41 offen lds
  v_add_f32 v226, v226, v161
  v_fma_f32 v166, v166, s42, v221
  v_mfma_f32_32x32x16_bf16 v[48:63], v[156:159], v[136:139], v[48:63]
  ds_read_b128 v[152:155], v214 offset:16384
  v_exp_f32 v164, v164
  v_add_f32 v225, v225, v162
  v_cvt_pk_bf16_f32 v160, v160, v161
  v_fma_f32 v167, v167, s42, v221
  v_exp_f32 v165, v165
  v_mfma_f32_32x32x16_bf16 v[128:143], v[192:195], a[128:131], 0
  ds_read_b128 v[156:159], v215 offset:16384
  v_add_f32 v226, v226, v163
  v_fma_f32 v168, v168, s42, v221
  v_exp_f32 v166, v166
  s_waitcnt lgkmcnt(4)
  v_mfma_f32_32x32x16_bf16 v[128:143], v[196:199], a[132:135], v[128:143]
  ds_read_b64_tr_b16 v[192:193], v216 offset:8192
  ds_read_b64_tr_b16 v[194:195], v216 offset:10240
  v_add_f32 v225, v225, v164
  v_cvt_pk_bf16_f32 v161, v162, v163
  v_fma_f32 v169, v169, s42, v221
  v_exp_f32 v167, v167
  v_mfma_f32_32x32x16_bf16 v[128:143], v[200:203], a[136:139], v[128:143]
  ds_read_b64_tr_b16 v[196:197], v217 offset:8192
  ds_read_b64_tr_b16 v[198:199], v217 offset:10240
  v_add_f32 v226, v226, v165
  v_fma_f32 v170, v170, s42, v221
  v_exp_f32 v168, v168
  v_add_f32 v225, v225, v166
  v_cvt_pk_bf16_f32 v162, v164, v165
  v_mfma_f32_32x32x16_bf16 v[128:143], v[204:207], a[140:143], v[128:143]
  ds_read_b64_tr_b16 v[200:201], v218 offset:8192
  ds_read_b64_tr_b16 v[202:203], v218 offset:10240
  v_fma_f32 v171, v171, s42, v221
  v_exp_f32 v169, v169
  v_add_f32 v226, v226, v167
  s_waitcnt lgkmcnt(7)
  v_mfma_f32_32x32x16_bf16 v[128:143], v[144:147], a[144:147], v[128:143]
  ds_read_b64_tr_b16 v[204:205], v219 offset:8192
  ds_read_b64_tr_b16 v[206:207], v219 offset:10240
  v_fma_f32 v172, v172, s42, v221
  v_exp_f32 v170, v170
  v_add_f32 v225, v225, v168
  v_cvt_pk_bf16_f32 v163, v166, v167
  v_mfma_f32_32x32x16_bf16 v[128:143], v[148:151], a[148:151], v[128:143]
  ds_read_b64_tr_b16 v[144:145], v216 offset:12288
  ds_read_b64_tr_b16 v[146:147], v216 offset:14336
  v_fma_f32 v173, v173, s42, v221
  v_exp_f32 v171, v171
  v_add_f32 v226, v226, v169
  v_fma_f32 v174, v174, s42, v221
  v_exp_f32 v172, v172
  v_mfma_f32_32x32x16_bf16 v[128:143], v[152:155], a[152:155], v[128:143]
  ds_read_b64_tr_b16 v[148:149], v217 offset:12288
  ds_read_b64_tr_b16 v[150:151], v217 offset:14336
  v_add_f32 v225, v225, v170
  v_cvt_pk_bf16_f32 v168, v168, v169
  v_fma_f32 v175, v175, s42, v221
  v_exp_f32 v173, v173
  s_waitcnt lgkmcnt(8)
  v_mfma_f32_32x32x16_bf16 v[128:143], v[156:159], a[156:159], v[128:143]
  ds_read_b64_tr_b16 v[152:153], v218 offset:12288
  ds_read_b64_tr_b16 v[154:155], v218 offset:14336
  v_add_f32 v226, v226, v171
  v_exp_f32 v174, v174
  v_add_f32 v225, v225, v172
  v_cvt_pk_bf16_f32 v169, v170, v171
  v_exp_f32 v175, v175
  v_mfma_f32_32x32x16_bf16 v[0:15], v[192:195], v[160:163], v[0:15]
  ds_read_b64_tr_b16 v[156:157], v219 offset:12288
  ds_read_b64_tr_b16 v[158:159], v219 offset:14336
  buffer_load_dwordx4 a[224:227], v249, s[20:23], s48 offen offset:0 nt
  buffer_load_dwordx4 a[232:235], v249, s[20:23], s48 offen offset:64 nt
  s_waitcnt vmcnt(8)
  s_barrier
  s_add_u32 m0, s40, 40960
  s_add_u32 s41, s9, 0
  buffer_load_dwordx4 v253, s[24:27], s41 offen lds
  v_mfma_f32_32x32x16_bf16 v[16:31], v[196:199], v[160:163], v[16:31]
  ds_read_b128 v[192:195], v208 offset:24576
  v_add_u32 v241, 4294934528, v216
  v_add_u32 v242, 4294934528, v217
  v_add_f32 v226, v226, v173
  v_fma_f32 v128, v128, s42, v221
  v_add_f32 v225, v225, v174
  v_cvt_pk_bf16_f32 v170, v172, v173
  v_add_u32 v243, 4294934528, v218
  s_waitcnt lgkmcnt(7)
  v_mfma_f32_32x32x16_bf16 v[32:47], v[200:203], v[160:163], v[32:47]
  ds_read_b128 v[196:199], v209 offset:24576
  v_add_u32 v244, 4294934528, v219
  v_add_f32 v226, v226, v175
  v_fma_f32 v129, v129, s42, v221
  v_cvt_pk_bf16_f32 v171, v174, v175
  v_fma_f32 v130, v130, s42, v221
  s_add_u32 m0, s40, 45056
  s_add_u32 s41, s9, 4096
  buffer_load_dwordx4 v253, s[24:27], s41 offen lds
  ds_read_b64_tr_b16 a[0:1], v241 offset:0
  v_mfma_f32_32x32x16_bf16 v[48:63], v[204:207], v[160:163], v[48:63]
  ds_read_b128 v[200:203], v210 offset:24576
  ds_read_b64_tr_b16 a[2:3], v241 offset:2048
  ds_read_b64_tr_b16 a[4:5], v242 offset:0
  v_exp_f32 v128, v128
  v_fma_f32 v131, v131, s42, v221
  v_exp_f32 v129, v129
  ds_read_b64_tr_b16 a[6:7], v242 offset:2048
  v_mfma_f32_32x32x16_bf16 v[0:15], v[144:147], v[168:171], v[0:15]
  ds_read_b128 v[204:207], v211 offset:24576
  ds_read_b64_tr_b16 a[8:9], v243 offset:0
  s_add_u32 m0, s40, 131072
  s_add_u32 s41, s9, 0
  buffer_load_dwordx4 v254, s[28:31], s41 offen lds
  v_fma_f32 v132, v132, s42, v221
  v_exp_f32 v130, v130
  ds_read_b64_tr_b16 a[10:11], v243 offset:2048
  s_waitcnt lgkmcnt(10)
  v_mfma_f32_32x32x16_bf16 v[16:31], v[148:151], v[168:171], v[16:31]
  ds_read_b128 v[144:147], v212 offset:24576
  ds_read_b64_tr_b16 a[12:13], v244 offset:0
  v_add_f32 v225, v225, v128
  v_fma_f32 v133, v133, s42, v221
  v_exp_f32 v131, v131
  v_add_f32 v226, v226, v129
  ds_read_b64_tr_b16 a[14:15], v244 offset:2048
  ds_read_b64_tr_b16 a[16:17], v241 offset:4096
  v_mfma_f32_32x32x16_bf16 v[32:47], v[152:155], v[168:171], v[32:47]
  ds_read_b128 v[148:151], v213 offset:24576
  s_add_u32 m0, s40, 135168
  s_add_u32 s41, s9, 4096
  buffer_load_dwordx4 v254, s[28:31], s41 offen lds
  ds_read_b64_tr_b16 a[18:19], v241 offset:6144
  v_fma_f32 v134, v134, s42, v221
  v_exp_f32 v132, v132
  v_add_f32 v225, v225, v130
  ds_read_b64_tr_b16 a[20:21], v242 offset:4096
  v_mfma_f32_32x32x16_bf16 v[48:63], v[156:159], v[168:171], v[48:63]
  ds_read_b128 v[152:155], v214 offset:24576
  ds_read_b64_tr_b16 a[22:23], v242 offset:6144
  v_cvt_pk_bf16_f32 v128, v128, v129
  v_fma_f32 v135, v135, s42, v221
  v_exp_f32 v133, v133
  v_add_f32 v226, v226, v131
  ds_read_b64_tr_b16 a[24:25], v243 offset:4096
  s_waitcnt lgkmcnt(13)
  v_mfma_f32_32x32x16_bf16 v[160:175], v[192:195], a[128:131], 0
  ds_read_b128 v[156:159], v215 offset:24576
  ds_read_b64_tr_b16 a[26:27], v243 offset:6144
  ds_read_b64_tr_b16 a[28:29], v244 offset:4096
  v_fma_f32 v136, v136, s42, v221
  v_exp_f32 v134, v134
  v_add_f32 v225, v225, v132
  ds_read_b64_tr_b16 a[30:31], v244 offset:6144
  v_mfma_f32_32x32x16_bf16 v[160:175], v[196:199], a[132:135], v[160:175]
  ds_read_b64_tr_b16 v[192:193], v216 offset:16384
  ds_read_b64_tr_b16 v[194:195], v216 offset:18432
  ds_read_b64_tr_b16 a[32:33], v241 offset:8192
  v_cvt_pk_bf16_f32 v129, v130, v131
  v_fma_f32 v137, v137, s42, v221
  v_exp_f32 v135, v135
  v_add_f32 v226, v226, v133
  v_fma_f32 v138, v138, s42, v221
  ds_read_b64_tr_b16 a[34:35], v241 offset:10240
  v_mfma_f32_32x32x16_bf16 v[160:175], v[200:203], a[136:139], v[160:175]
  ds_read_b64_tr_b16 v[196:197], v217 offset:16384
  ds_read_b64_tr_b16 v[198:199], v217 offset:18432
  ds_read_b64_tr_b16 a[36:37], v242 offset:8192
  ds_read_b64_tr_b16 a[38:39], v242 offset:10240
  v_exp_f32 v136, v136
  v_add_f32 v225, v225, v134
  ds_read_b64_tr_b16 a[40:41], v243 offset:8192
  s_waitcnt lgkmcnt(15)
  v_mfma_f32_32x32x16_bf16 v[160:175], v[204:207], a[140:143], v[160:175]
  ds_read_b64_tr_b16 v[200:201], v218 offset:16384
  ds_read_b64_tr_b16 v[202:203], v218 offset:18432
  ds_read_b64_tr_b16 a[42:43], v243 offset:10240
  v_cvt_pk_bf16_f32 v130, v132, v133
  v_fma_f32 v139, v139, s42, v221
  v_exp_f32 v137, v137
  v_add_f32 v226, v226, v135
  v_fma_f32 v140, v140, s42, v221
  ds_read_b64_tr_b16 a[44:45], v244 offset:8192
  v_mfma_f32_32x32x16_bf16 v[160:175], v[144:147], a[144:147], v[160:175]
  ds_read_b64_tr_b16 v[204:205], v219 offset:16384
  ds_read_b64_tr_b16 v[206:207], v219 offset:18432
  ds_read_b64_tr_b16 a[46:47], v244 offset:10240
  v_exp_f32 v138, v138
  v_add_f32 v225, v225, v136
  v_cvt_pk_bf16_f32 v131, v134, v135
  ds_read_b64_tr_b16 a[48:49], v241 offset:12288
  ds_read_b64_tr_b16 a[50:51], v241 offset:14336
  v_mfma_f32_32x32x16_bf16 v[160:175], v[148:151], a[148:151], v[160:175]
  ds_read_b64_tr_b16 v[144:145], v216 offset:20480
  ds_read_b64_tr_b16 v[146:147], v216 offset:22528
  ds_read_b64_tr_b16 a[52:53], v242 offset:12288
  v_fma_f32 v141, v141, s42, v221
  v_exp_f32 v139, v139
  v_add_f32 v226, v226, v137
  v_fma_f32 v142, v142, s42, v221
  v_exp_f32 v140, v140
  ds_read_b64_tr_b16 a[54:55], v242 offset:14336
  v_mfma_f32_32x32x16_bf16 v[160:175], v[152:155], a[152:155], v[160:175]
  ds_read_b64_tr_b16 v[148:149], v217 offset:20480
  ds_read_b64_tr_b16 v[150:151], v217 offset:22528
  ds_read_b64_tr_b16 a[56:57], v243 offset:12288
  v_add_f32 v225, v225, v138
  v_cvt_pk_bf16_f32 v136, v136, v137
  v_fma_f32 v143, v143, s42, v221
  v_exp_f32 v141, v141
  ds_read_b64_tr_b16 a[58:59], v243 offset:14336
  s_waitcnt lgkmcnt(15)
  v_mfma_f32_32x32x16_bf16 v[160:175], v[156:159], a[156:159], v[160:175]
  ds_read_b64_tr_b16 v[152:153], v218 offset:20480
  ds_read_b64_tr_b16 v[154:155], v218 offset:22528
  ds_read_b64_tr_b16 a[60:61], v244 offset:12288
  buffer_load_dwordx4 a[196:199], v249, s[20:23], s53 offen offset:0 nt
  buffer_load_dwordx4 a[204:207], v249, s[20:23], s53 offen offset:64 nt
  ds_read_b64_tr_b16 a[62:63], v244 offset:14336
  v_add_f32 v226, v226, v139
  v_exp_f32 v142, v142
  ds_read_b64_tr_b16 a[64:65], v241 offset:16384
  v_mfma_f32_32x32x16_bf16 v[0:15], v[192:195], v[128:131], v[0:15]
  ds_read_b64_tr_b16 v[156:157], v219 offset:20480
  ds_read_b64_tr_b16 v[158:159], v219 offset:22528
  ds_read_b64_tr_b16 a[66:67], v241 offset:18432
  ds_read_b64_tr_b16 a[68:69], v242 offset:16384
  s_waitcnt vmcnt(10)
  s_barrier
  s_add_u32 m0, s40, 49152
  s_add_u32 s41, s10, 0
  buffer_load_dwordx4 v253, s[24:27], s41 offen lds
  v_mfma_f32_32x32x16_bf16 v[16:31], v[196:199], v[128:131], v[16:31]
  ds_read_b128 v[192:195], v208 offset:32768
  ds_read_b64_tr_b16 a[70:71], v242 offset:18432
  ds_read_b64_tr_b16 a[72:73], v243 offset:16384
  v_add_f32 v225, v225, v140
  v_cvt_pk_bf16_f32 v137, v138, v139
  v_exp_f32 v143, v143
  v_add_f32 v226, v226, v141
  v_add_f32 v225, v225, v142
  ds_read_b64_tr_b16 a[74:75], v243 offset:18432
  v_mfma_f32_32x32x16_bf16 v[32:47], v[200:203], v[128:131], v[32:47]
  ds_read_b128 v[196:199], v209 offset:32768
  ds_read_b64_tr_b16 a[76:77], v244 offset:16384
  v_cvt_pk_bf16_f32 v138, v140, v141
  v_add_f32 v226, v226, v143
  v_cvt_pk_bf16_f32 v139, v142, v143
  s_add_u32 m0, s40, 53248
  s_add_u32 s41, s10, 4096
  buffer_load_dwordx4 v253, s[24:27], s41 offen lds
  ds_read_b64_tr_b16 a[78:79], v244 offset:18432
  s_waitcnt lgkmcnt(15)
  v_mfma_f32_32x32x16_bf16 v[48:63], v[204:207], v[128:131], v[48:63]
  ds_read_b128 v[200:203], v210 offset:32768
  ds_read_b64_tr_b16 a[80:81], v241 offset:20480
  v_fma_f32 v160, v160, s42, v221
  v_fma_f32 v161, v161, s42, v221
  v_fma_f32 v162, v162, s42, v221
  v_exp_f32 v160, v160
  v_fma_f32 v163, v163, s42, v221
  ds_read_b64_tr_b16 a[82:83], v241 offset:22528
  ds_read_b64_tr_b16 a[84:85], v242 offset:20480
  v_mfma_f32_32x32x16_bf16 v[0:15], v[144:147], v[136:139], v[0:15]
  ds_read_b128 v[204:207], v211 offset:32768
  ds_read_b64_tr_b16 a[86:87], v242 offset:22528
  s_add_u32 m0, s40, 139264
  s_add_u32 s41, s10, 0
  buffer_load_dwordx4 v254, s[28:31], s41 offen lds
  v_exp_f32 v161, v161
  v_fma_f32 v164, v164, s42, v221
  ds_read_b64_tr_b16 a[88:89], v243 offset:20480
  v_mfma_f32_32x32x16_bf16 v[16:31], v[148:151], v[136:139], v[16:31]
  ds_read_b128 v[144:147], v212 offset:32768
  ds_read_b64_tr_b16 a[90:91], v243 offset:22528
  v_exp_f32 v162, v162
  v_add_f32 v225, v225, v160
  v_fma_f32 v165, v165, s42, v221
  v_exp_f32 v163, v163
  ds_read_b64_tr_b16 a[92:93], v244 offset:20480
  s_waitcnt lgkmcnt(13)
  v_mfma_f32_32x32x16_bf16 v[32:47], v[152:155], v[136:139], v[32:47]
  ds_read_b128 v[148:151], v213 offset:32768
  ds_read_b64_tr_b16 a[94:95], v244 offset:22528
  s_add_u32 m0, s40, 143360
  s_add_u32 s41, s10, 4096
  buffer_load_dwordx4 v254, s[28:31], s41 offen lds
  ds_read_b64_tr_b16 a[96:97], v241 offset:24576
  v_add_f32 v226, v226, v161
  v_fma_f32 v166, v166, s42, v221
  ds_read_b64_tr_b16 a[98:99], v241 offset:26624
  v_mfma_f32_32x32x16_bf16 v[48:63], v[156:159], v[136:139], v[48:63]
  ds_read_b128 v[152:155], v214 offset:32768
  ds_read_b64_tr_b16 a[100:101], v242 offset:24576
  v_exp_f32 v164, v164
  v_add_f32 v225, v225, v162
  v_cvt_pk_bf16_f32 v160, v160, v161
  v_fma_f32 v167, v167, s42, v221
  v_exp_f32 v165, v165
  ds_read_b64_tr_b16 a[102:103], v242 offset:26624
  v_mfma_f32_32x32x16_bf16 v[128:143], v[192:195], a[128:131], 0
  ds_read_b128 v[156:159], v215 offset:32768
  ds_read_b64_tr_b16 a[104:105], v243 offset:24576
  ds_read_b64_tr_b16 a[106:107], v243 offset:26624
  v_add_f32 v226, v226, v163
  v_fma_f32 v168, v168, s42, v221
  v_exp_f32 v166, v166
  ds_read_b64_tr_b16 a[108:109], v244 offset:24576
  s_waitcnt lgkmcnt(14)
  v_mfma_f32_32x32x16_bf16 v[128:143], v[196:199], a[132:135], v[128:143]
  ds_read_b64_tr_b16 v[192:193], v216 offset:24576
  ds_read_b64_tr_b16 v[194:195], v216 offset:26624
  ds_read_b64_tr_b16 a[110:111], v244 offset:26624
  v_add_f32 v225, v225, v164
  v_cvt_pk_bf16_f32 v161, v162, v163
  v_fma_f32 v169, v169, s42, v221
  v_exp_f32 v167, v167
  ds_read_b64_tr_b16 a[112:113], v241 offset:28672
  v_mfma_f32_32x32x16_bf16 v[128:143], v[200:203], a[136:139], v[128:143]
  ds_read_b64_tr_b16 v[196:197], v217 offset:24576
  ds_read_b64_tr_b16 v[198:199], v217 offset:26624
  ds_read_b64_tr_b16 a[114:115], v241 offset:30720
  v_add_f32 v226, v226, v165
  v_fma_f32 v170, v170, s42, v221
  v_exp_f32 v168, v168
  v_add_f32 v225, v225, v166
  ds_read_b64_tr_b16 a[116:117], v242 offset:28672
  ds_read_b64_tr_b16 a[118:119], v242 offset:30720
  v_mfma_f32_32x32x16_bf16 v[128:143], v[204:207], a[140:143], v[128:143]
  ds_read_b64_tr_b16 v[200:201], v218 offset:24576
  ds_read_b64_tr_b16 v[202:203], v218 offset:26624
  ds_read_b64_tr_b16 a[120:121], v243 offset:28672
  v_cvt_pk_bf16_f32 v162, v164, v165
  v_fma_f32 v171, v171, s42, v221
  v_exp_f32 v169, v169
  ds_read_b64_tr_b16 a[122:123], v243 offset:30720
  s_waitcnt lgkmcnt(15)
  v_mfma_f32_32x32x16_bf16 v[128:143], v[144:147], a[144:147], v[128:143]
  ds_read_b64_tr_b16 v[204:205], v219 offset:24576
  ds_read_b64_tr_b16 v[206:207], v219 offset:26624
  ds_read_b64_tr_b16 a[124:125], v244 offset:28672
  v_add_f32 v226, v226, v167
  v_fma_f32 v172, v172, s42, v221
  v_exp_f32 v170, v170
  v_add_f32 v225, v225, v168
  v_cvt_pk_bf16_f32 v163, v166, v167
  ds_read_b64_tr_b16 a[126:127], v244 offset:30720
  v_mfma_f32_32x32x16_bf16 v[128:143], v[148:151], a[148:151], v[128:143]
  ds_read_b64_tr_b16 v[144:145], v216 offset:28672
  ds_read_b64_tr_b16 v[146:147], v216 offset:30720
  v_fma_f32 v173, v173, s42, v221
  v_exp_f32 v171, v171
  v_add_f32 v226, v226, v169
  v_fma_f32 v174, v174, s42, v221
  v_mfma_f32_32x32x16_bf16 v[128:143], v[152:155], a[152:155], v[128:143]
  ds_read_b64_tr_b16 v[148:149], v217 offset:28672
  ds_read_b64_tr_b16 v[150:151], v217 offset:30720
  s_waitcnt lgkmcnt(0)
  s_barrier
  buffer_load_dwordx4 a[228:231], v249, s[20:23], s54 offen offset:0 nt
  buffer_load_dwordx4 a[236:239], v249, s[20:23], s54 offen offset:64 nt
  v_exp_f32 v172, v172
  v_mfma_f32_32x32x16_bf16 v[128:143], v[156:159], a[156:159], v[128:143]
  ds_read_b64_tr_b16 v[152:153], v218 offset:28672
  ds_read_b64_tr_b16 v[154:155], v218 offset:30720
  v_add_f32 v225, v225, v170
  v_cvt_pk_bf16_f32 v168, v168, v169
  v_fma_f32 v175, v175, s42, v221
  v_exp_f32 v173, v173
  v_mfma_f32_32x32x16_bf16 v[0:15], v[192:195], v[160:163], v[0:15]
  ds_read_b64_tr_b16 v[156:157], v219 offset:28672
  ds_read_b64_tr_b16 v[158:159], v219 offset:30720
  s_waitcnt vmcnt(10)
  s_barrier
  s_add_u32 m0, s40, 147456
  s_add_u32 s41, s11, 0
  buffer_load_dwordx4 v254, s[28:31], s41 offen lds
  v_mfma_f32_32x32x16_bf16 v[16:31], v[196:199], v[160:163], v[16:31]
  ds_read_b128 v[192:195], v208 offset:40960
  v_add_f32 v226, v226, v171
  v_exp_f32 v174, v174
  v_add_f32 v225, v225, v172
  v_cvt_pk_bf16_f32 v169, v170, v171
  v_exp_f32 v175, v175
  v_mfma_f32_32x32x16_bf16 v[32:47], v[200:203], v[160:163], v[32:47]
  ds_read_b128 v[196:199], v209 offset:40960
  v_add_f32 v226, v226, v173
  v_fma_f32 v128, v128, s42, v221
  v_add_f32 v225, v225, v174
  v_fma_f32 v129, v129, s42, v221
  v_cvt_pk_bf16_f32 v170, v172, v173
  v_fma_f32 v130, v130, s42, v221
  v_add_f32 v226, v226, v175
  v_cvt_pk_bf16_f32 v171, v174, v175
  v_mfma_f32_32x32x16_bf16 v[48:63], v[204:207], v[160:163], v[48:63]
  ds_read_b128 v[200:203], v210 offset:40960
  v_exp_f32 v128, v128
  v_fma_f32 v131, v131, s42, v221
  v_exp_f32 v129, v129
  v_fma_f32 v132, v132, s42, v221
  v_exp_f32 v130, v130
  v_mfma_f32_32x32x16_bf16 v[0:15], v[144:147], v[168:171], v[0:15]
  ds_read_b128 v[204:207], v211 offset:40960
  s_add_u32 m0, s40, 151552
  s_add_u32 s41, s11, 4096
  buffer_load_dwordx4 v254, s[28:31], s41 offen lds
  v_add_f32 v225, v225, v128
  v_fma_f32 v133, v133, s42, v221
  v_exp_f32 v131, v131
  v_mfma_f32_32x32x16_bf16 v[16:31], v[148:151], v[168:171], v[16:31]
  ds_read_b128 v[144:147], v212 offset:40960
  v_add_f32 v226, v226, v129
  v_fma_f32 v134, v134, s42, v221
  v_exp_f32 v132, v132
  v_add_f32 v225, v225, v130
  v_cvt_pk_bf16_f32 v128, v128, v129
  s_waitcnt lgkmcnt(4)
  v_mfma_f32_32x32x16_bf16 v[32:47], v[152:155], v[168:171], v[32:47]
  ds_read_b128 v[148:151], v213 offset:40960
  v_fma_f32 v135, v135, s42, v221
  v_exp_f32 v133, v133
  v_add_f32 v226, v226, v131
  v_fma_f32 v136, v136, s42, v221
  v_exp_f32 v134, v134
  v_mfma_f32_32x32x16_bf16 v[48:63], v[156:159], v[168:171], v[48:63]
  ds_read_b128 v[152:155], v214 offset:40960
  v_add_f32 v225, v225, v132
  v_cvt_pk_bf16_f32 v129, v130, v131
  v_fma_f32 v137, v137, s42, v221
  v_exp_f32 v135, v135
  v_add_f32 v226, v226, v133
  v_fma_f32 v138, v138, s42, v221
  v_mfma_f32_32x32x16_bf16 v[160:175], v[192:195], a[128:131], 0
  ds_read_b128 v[156:159], v215 offset:40960
  s_add_u32 m0, s40, 57344
  s_add_u32 s41, s11, 0
  buffer_load_dwordx4 v253, s[24:27], s41 offen lds
  v_exp_f32 v136, v136
  v_add_f32 v225, v225, v134
  s_waitcnt lgkmcnt(4)
  v_mfma_f32_32x32x16_bf16 v[160:175], v[196:199], a[132:135], v[160:175]
  ds_read_b64_tr_b16 v[192:193], v216 offset:32768
  ds_read_b64_tr_b16 v[194:195], v216 offset:34816
  s_add_u32 m0, s40, 61440
  s_add_u32 s41, s11, 4096
  buffer_load_dwordx4 v253, s[24:27], s41 offen lds
  v_cvt_pk_bf16_f32 v130, v132, v133
  v_fma_f32 v139, v139, s42, v221
  v_exp_f32 v137, v137
  v_mfma_f32_32x32x16_bf16 v[160:175], v[200:203], a[136:139], v[160:175]
  ds_read_b64_tr_b16 v[196:197], v217 offset:32768
  ds_read_b64_tr_b16 v[198:199], v217 offset:34816
  s_add_u32 m0, s40, 65536
  s_add_u32 s41, s58, 0
  buffer_load_dwordx4 v253, s[24:27], s41 offen lds
  v_add_f32 v226, v226, v135
  v_fma_f32 v140, v140, s42, v221
  v_exp_f32 v138, v138
  v_mfma_f32_32x32x16_bf16 v[160:175], v[204:207], a[140:143], v[160:175]
  ds_read_b64_tr_b16 v[200:201], v218 offset:32768
  ds_read_b64_tr_b16 v[202:203], v218 offset:34816
  s_add_u32 m0, s40, 69632
  s_add_u32 s41, s58, 4096
  buffer_load_dwordx4 v253, s[24:27], s41 offen lds
  v_add_f32 v225, v225, v136
  v_cvt_pk_bf16_f32 v131, v134, v135
  s_waitcnt lgkmcnt(7)
  v_mfma_f32_32x32x16_bf16 v[160:175], v[144:147], a[144:147], v[160:175]
  ds_read_b64_tr_b16 v[204:205], v219 offset:32768
  ds_read_b64_tr_b16 v[206:207], v219 offset:34816
  s_add_u32 m0, s40, 73728
  s_add_u32 s41, s60, 0
  buffer_load_dwordx4 v253, s[24:27], s41 offen lds
  s_add_u32 m0, s40, 77824
  s_add_u32 s41, s60, 4096
  buffer_load_dwordx4 v253, s[24:27], s41 offen lds
  v_mfma_f32_32x32x16_bf16 v[160:175], v[148:151], a[148:151], v[160:175]
  ds_read_b64_tr_b16 v[144:145], v216 offset:36864
  ds_read_b64_tr_b16 v[146:147], v216 offset:38912
  buffer_load_dwordx4 a[208:211], v249, s[20:23], s47 offen offset:128 nt
  buffer_load_dwordx4 a[216:219], v249, s[20:23], s47 offen offset:192 nt
  v_fma_f32 v141, v141, s42, v221
  s_add_u32 m0, s40, 81920
  s_add_u32 s41, s61, 0
  buffer_load_dwordx4 v253, s[24:27], s41 offen lds
  v_mfma_f32_32x32x16_bf16 v[160:175], v[152:155], a[152:155], v[160:175]
  ds_read_b64_tr_b16 v[148:149], v217 offset:36864
  ds_read_b64_tr_b16 v[150:151], v217 offset:38912
  v_exp_f32 v139, v139
  v_add_f32 v226, v226, v137
  s_add_u32 m0, s40, 86016
  s_add_u32 s41, s61, 4096
  buffer_load_dwordx4 v253, s[24:27], s41 offen lds
  s_waitcnt lgkmcnt(8)
  v_mfma_f32_32x32x16_bf16 v[160:175], v[156:159], a[156:159], v[160:175]
  ds_read_b64_tr_b16 v[152:153], v218 offset:36864
  ds_read_b64_tr_b16 v[154:155], v218 offset:38912
  v_fma_f32 v142, v142, s42, v221
  v_exp_f32 v140, v140
  v_add_f32 v225, v225, v138
  v_cvt_pk_bf16_f32 v136, v136, v137
  v_fma_f32 v143, v143, s42, v221
  v_mfma_f32_32x32x16_bf16 v[0:15], v[192:195], v[128:131], v[0:15]
  ds_read_b64_tr_b16 v[156:157], v219 offset:36864
  ds_read_b64_tr_b16 v[158:159], v219 offset:38912
  v_exp_f32 v141, v141
  v_add_f32 v226, v226, v139
  s_waitcnt vmcnt(16)
  s_barrier
  s_barrier
  v_mfma_f32_32x32x16_bf16 v[16:31], v[196:199], v[128:131], v[16:31]
  ds_read_b128 v[192:195], v208 offset:49152
  v_exp_f32 v142, v142
  v_add_f32 v225, v225, v140
  v_cvt_pk_bf16_f32 v137, v138, v139
  v_exp_f32 v143, v143
  v_add_f32 v226, v226, v141
  s_waitcnt lgkmcnt(7)
  v_mfma_f32_32x32x16_bf16 v[32:47], v[200:203], v[128:131], v[32:47]
  s_add_u32 m0, s40, 32768
  s_add_u32 s41, s59, 0
  buffer_load_dwordx4 v253, s[24:27], s41 offen lds
  ds_read_b128 v[196:199], v209 offset:49152
  v_add_f32 v225, v225, v142
  v_cvt_pk_bf16_f32 v138, v140, v141
  v_add_f32 v226, v226, v143
  v_cvt_pk_bf16_f32 v139, v142, v143
  v_mfma_f32_32x32x16_bf16 v[48:63], v[204:207], v[128:131], v[48:63]
  ds_read_b128 v[200:203], v210 offset:49152
  v_fma_f32 v160, v160, s42, v221
  v_fma_f32 v161, v161, s42, v221
  v_fma_f32 v162, v162, s42, v221
  v_exp_f32 v160, v160
  v_fma_f32 v163, v163, s42, v221
  v_mfma_f32_32x32x16_bf16 v[0:15], v[144:147], v[136:139], v[0:15]
  s_add_u32 m0, s40, 36864
  s_add_u32 s41, s59, 4096
  buffer_load_dwordx4 v253, s[24:27], s41 offen lds
  ds_read_b128 v[204:207], v211 offset:49152
  v_exp_f32 v161, v161
  s_waitcnt lgkmcnt(4)
  v_mfma_f32_32x32x16_bf16 v[16:31], v[148:151], v[136:139], v[16:31]
  ds_read_b128 v[144:147], v212 offset:49152
  v_fma_f32 v164, v164, s42, v221
  v_exp_f32 v162, v162
  v_add_f32 v225, v225, v160
  v_fma_f32 v165, v165, s42, v221
  v_exp_f32 v163, v163
  v_mfma_f32_32x32x16_bf16 v[32:47], v[152:155], v[136:139], v[32:47]
  ds_read_b128 v[148:151], v213 offset:49152
  v_add_f32 v226, v226, v161
  v_fma_f32 v166, v166, s42, v221
  v_exp_f32 v164, v164
  v_add_f32 v225, v225, v162
  v_mfma_f32_32x32x16_bf16 v[48:63], v[156:159], v[136:139], v[48:63]
  ds_read_b128 v[152:155], v214 offset:49152
  v_cvt_pk_bf16_f32 v160, v160, v161
  v_fma_f32 v167, v167, s42, v221
  v_exp_f32 v165, v165
  v_add_f32 v226, v226, v163
  s_waitcnt lgkmcnt(4)
  v_mfma_f32_32x32x16_bf16 v[128:143], v[192:195], a[128:131], 0
  ds_read_b128 v[156:159], v215 offset:49152
  v_fma_f32 v168, v168, s42, v221
  v_exp_f32 v166, v166
  v_add_f32 v225, v225, v164
  v_cvt_pk_bf16_f32 v161, v162, v163
  v_mfma_f32_32x32x16_bf16 v[128:143], v[196:199], a[132:135], v[128:143]
  ds_read_b64_tr_b16 v[192:193], v216 offset:40960
  ds_read_b64_tr_b16 v[194:195], v216 offset:43008
  v_fma_f32 v169, v169, s42, v221
  v_exp_f32 v167, v167
  v_add_f32 v226, v226, v165
  v_fma_f32 v170, v170, s42, v221
  v_mfma_f32_32x32x16_bf16 v[128:143], v[200:203], a[136:139], v[128:143]
  ds_read_b64_tr_b16 v[196:197], v217 offset:40960
  ds_read_b64_tr_b16 v[198:199], v217 offset:43008
  v_exp_f32 v168, v168
  v_add_f32 v225, v225, v166
  v_cvt_pk_bf16_f32 v162, v164, v165
  v_fma_f32 v171, v171, s42, v221
  s_waitcnt lgkmcnt(6)
  v_mfma_f32_32x32x16_bf16 v[128:143], v[204:207], a[140:143], v[128:143]
  ds_read_b64_tr_b16 v[200:201], v218 offset:40960
  ds_read_b64_tr_b16 v[202:203], v218 offset:43008
  v_exp_f32 v169, v169
  v_add_f32 v226, v226, v167
  v_fma_f32 v172, v172, s42, v221
  v_mfma_f32_32x32x16_bf16 v[128:143], v[144:147], a[144:147], v[128:143]
  ds_read_b64_tr_b16 v[204:205], v219 offset:40960
  ds_read_b64_tr_b16 v[206:207], v219 offset:43008
  buffer_load_dwordx4 a[240:243], v249, s[20:23], s48 offen offset:128 nt
  buffer_load_dwordx4 a[248:251], v249, s[20:23], s48 offen offset:192 nt
  v_exp_f32 v170, v170
  v_add_f32 v225, v225, v168
  v_cvt_pk_bf16_f32 v163, v166, v167
  v_mfma_f32_32x32x16_bf16 v[128:143], v[148:151], a[148:151], v[128:143]
  ds_read_b64_tr_b16 v[144:145], v216 offset:45056
  ds_read_b64_tr_b16 v[146:147], v216 offset:47104
  v_fma_f32 v173, v173, s42, v221
  v_exp_f32 v171, v171
  s_waitcnt lgkmcnt(8)
  v_mfma_f32_32x32x16_bf16 v[128:143], v[152:155], a[152:155], v[128:143]
  ds_read_b64_tr_b16 v[148:149], v217 offset:45056
  ds_read_b64_tr_b16 v[150:151], v217 offset:47104
  v_add_f32 v226, v226, v169
  v_fma_f32 v174, v174, s42, v221
  v_exp_f32 v172, v172
  v_add_f32 v225, v225, v170
  v_mfma_f32_32x32x16_bf16 v[128:143], v[156:159], a[156:159], v[128:143]
  ds_read_b64_tr_b16 v[152:153], v218 offset:45056
  ds_read_b64_tr_b16 v[154:155], v218 offset:47104
  v_cvt_pk_bf16_f32 v168, v168, v169
  v_fma_f32 v175, v175, s42, v221
  v_exp_f32 v173, v173
  v_mfma_f32_32x32x16_bf16 v[0:15], v[192:195], v[160:163], v[0:15]
  ds_read_b64_tr_b16 v[156:157], v219 offset:45056
  ds_read_b64_tr_b16 v[158:159], v219 offset:47104
  v_add_f32 v226, v226, v171
  s_waitcnt vmcnt(12)
  s_barrier
  s_waitcnt lgkmcnt(8)
  v_mfma_f32_32x32x16_bf16 v[16:31], v[196:199], v[160:163], v[16:31]
  ds_read_b128 v[192:195], v208 offset:57344
  v_exp_f32 v174, v174
  v_add_f32 v225, v225, v172
  v_cvt_pk_bf16_f32 v169, v170, v171
  v_exp_f32 v175, v175
  v_mfma_f32_32x32x16_bf16 v[32:47], v[200:203], v[160:163], v[32:47]
  ds_read_b128 v[196:199], v209 offset:57344
  v_add_f32 v226, v226, v173
  v_fma_f32 v128, v128, s42, v221
  v_add_f32 v225, v225, v174
  v_cvt_pk_bf16_f32 v170, v172, v173
  v_add_f32 v226, v226, v175
  v_cvt_pk_bf16_f32 v171, v174, v175
  v_mfma_f32_32x32x16_bf16 v[48:63], v[204:207], v[160:163], v[48:63]
  ds_read_b128 v[200:203], v210 offset:57344
  v_fma_f32 v129, v129, s42, v221
  v_fma_f32 v130, v130, s42, v221
  v_exp_f32 v128, v128
  v_fma_f32 v131, v131, s42, v221
  s_waitcnt lgkmcnt(5)
  v_mfma_f32_32x32x16_bf16 v[0:15], v[144:147], v[168:171], v[0:15]
  ds_read_b128 v[204:207], v211 offset:57344
  v_exp_f32 v129, v129
  v_fma_f32 v132, v132, s42, v221
  v_exp_f32 v130, v130
  v_add_f32 v225, v225, v128
  v_mfma_f32_32x32x16_bf16 v[16:31], v[148:151], v[168:171], v[16:31]
  ds_read_b128 v[144:147], v212 offset:57344
  v_fma_f32 v133, v133, s42, v221
  v_exp_f32 v131, v131
  v_add_f32 v226, v226, v129
  v_fma_f32 v134, v134, s42, v221
  v_mfma_f32_32x32x16_bf16 v[32:47], v[152:155], v[168:171], v[32:47]
  ds_read_b128 v[148:151], v213 offset:57344
  v_exp_f32 v132, v132
  v_add_f32 v225, v225, v130
  v_cvt_pk_bf16_f32 v128, v128, v129
  v_fma_f32 v135, v135, s42, v221
  s_waitcnt lgkmcnt(4)
  v_mfma_f32_32x32x16_bf16 v[48:63], v[156:159], v[168:171], v[48:63]
  ds_read_b128 v[152:155], v214 offset:57344
  v_exp_f32 v133, v133
  v_add_f32 v226, v226, v131
  v_fma_f32 v136, v136, s42, v221
  v_exp_f32 v134, v134
  v_mfma_f32_32x32x16_bf16 v[160:175], v[192:195], a[128:131], 0
  ds_read_b128 v[156:159], v215 offset:57344
  v_add_f32 v225, v225, v132
  v_cvt_pk_bf16_f32 v129, v130, v131
  v_fma_f32 v137, v137, s42, v221
  v_exp_f32 v135, v135
  v_mfma_f32_32x32x16_bf16 v[160:175], v[196:199], a[132:135], v[160:175]
  ds_read_b64_tr_b16 v[192:193], v216 offset:49152
  ds_read_b64_tr_b16 v[194:195], v216 offset:51200
  v_add_f32 v226, v226, v133
  v_fma_f32 v138, v138, s42, v221
  v_exp_f32 v136, v136
  s_waitcnt lgkmcnt(5)
  v_mfma_f32_32x32x16_bf16 v[160:175], v[200:203], a[136:139], v[160:175]
  ds_read_b64_tr_b16 v[196:197], v217 offset:49152
  ds_read_b64_tr_b16 v[198:199], v217 offset:51200
  v_add_f32 v225, v225, v134
  v_cvt_pk_bf16_f32 v130, v132, v133
  v_fma_f32 v139, v139, s42, v221
  v_exp_f32 v137, v137
  v_mfma_f32_32x32x16_bf16 v[160:175], v[204:207], a[140:143], v[160:175]
  ds_read_b64_tr_b16 v[200:201], v218 offset:49152
  ds_read_b64_tr_b16 v[202:203], v218 offset:51200
  buffer_load_dwordx4 a[212:215], v249, s[20:23], s53 offen offset:128 nt
  buffer_load_dwordx4 a[220:223], v249, s[20:23], s53 offen offset:192 nt
  v_add_f32 v226, v226, v135
  v_fma_f32 v140, v140, s42, v221
  v_mfma_f32_32x32x16_bf16 v[160:175], v[144:147], a[144:147], v[160:175]
  ds_read_b64_tr_b16 v[204:205], v219 offset:49152
  ds_read_b64_tr_b16 v[206:207], v219 offset:51200
  v_exp_f32 v138, v138
  v_add_f32 v225, v225, v136
  v_cvt_pk_bf16_f32 v131, v134, v135
  s_waitcnt lgkmcnt(8)
  v_mfma_f32_32x32x16_bf16 v[160:175], v[148:151], a[148:151], v[160:175]
  ds_read_b64_tr_b16 v[144:145], v216 offset:53248
  ds_read_b64_tr_b16 v[146:147], v216 offset:55296
  v_fma_f32 v141, v141, s42, v221
  v_exp_f32 v139, v139
  v_add_f32 v226, v226, v137
  v_fma_f32 v142, v142, s42, v221
  v_mfma_f32_32x32x16_bf16 v[160:175], v[152:155], a[152:155], v[160:175]
  ds_read_b64_tr_b16 v[148:149], v217 offset:53248
  ds_read_b64_tr_b16 v[150:151], v217 offset:55296
  v_exp_f32 v140, v140
  v_add_f32 v225, v225, v138
  v_cvt_pk_bf16_f32 v136, v136, v137
  v_fma_f32 v143, v143, s42, v221
  v_mfma_f32_32x32x16_bf16 v[160:175], v[156:159], a[156:159], v[160:175]
  ds_read_b64_tr_b16 v[152:153], v218 offset:53248
  ds_read_b64_tr_b16 v[154:155], v218 offset:55296
  v_exp_f32 v141, v141
  v_add_f32 v226, v226, v139
  s_waitcnt lgkmcnt(8)
  v_mfma_f32_32x32x16_bf16 v[0:15], v[192:195], v[128:131], v[0:15]
  ds_read_b64_tr_b16 v[156:157], v219 offset:53248
  ds_read_b64_tr_b16 v[158:159], v219 offset:55296
  v_exp_f32 v142, v142
  s_waitcnt vmcnt(12)
  s_barrier
  v_xor_b32 v208, 0x10000, v208
  v_mfma_f32_32x32x16_bf16 v[16:31], v[196:199], v[128:131], v[16:31]
  ds_read_b128 v[192:195], v208 offset:0
  v_add_f32 v225, v225, v140
  v_cvt_pk_bf16_f32 v137, v138, v139
  v_exp_f32 v143, v143
  v_add_f32 v226, v226, v141
  v_xor_b32 v209, 0x10000, v209
  v_mfma_f32_32x32x16_bf16 v[32:47], v[200:203], v[128:131], v[32:47]
  ds_read_b128 v[196:199], v209 offset:0
  v_add_f32 v225, v225, v142
  v_fma_f32 v160, v160, s42, v221
  v_cvt_pk_bf16_f32 v138, v140, v141
  v_add_f32 v226, v226, v143
  v_cvt_pk_bf16_f32 v139, v142, v143
  v_xor_b32 v210, 0x10000, v210
  s_waitcnt lgkmcnt(6)
  v_mfma_f32_32x32x16_bf16 v[48:63], v[204:207], v[128:131], v[48:63]
  ds_read_b128 v[200:203], v210 offset:0
  v_fma_f32 v161, v161, s42, v221
  v_fma_f32 v162, v162, s42, v221
  v_exp_f32 v160, v160
  v_fma_f32 v163, v163, s42, v221
  v_xor_b32 v211, 0x10000, v211
  v_mfma_f32_32x32x16_bf16 v[0:15], v[144:147], v[136:139], v[0:15]
  ds_read_b128 v[204:207], v211 offset:0
  v_exp_f32 v161, v161
  v_fma_f32 v164, v164, s42, v221
  v_exp_f32 v162, v162
  v_xor_b32 v212, 0x10000, v212
  v_mfma_f32_32x32x16_bf16 v[16:31], v[148:151], v[136:139], v[16:31]
  ds_read_b128 v[144:147], v212 offset:0
  v_add_f32 v225, v225, v160
  v_fma_f32 v165, v165, s42, v221
  v_exp_f32 v163, v163
  v_add_f32 v226, v226, v161
  v_xor_b32 v213, 0x10000, v213
  s_waitcnt lgkmcnt(4)
  v_mfma_f32_32x32x16_bf16 v[32:47], v[152:155], v[136:139], v[32:47]
  ds_read_b128 v[148:151], v213 offset:0
  v_fma_f32 v166, v166, s42, v221
  v_exp_f32 v164, v164
  v_add_f32 v225, v225, v162
  v_cvt_pk_bf16_f32 v160, v160, v161
  v_xor_b32 v214, 0x10000, v214
  v_mfma_f32_32x32x16_bf16 v[48:63], v[156:159], v[136:139], v[48:63]
  ds_read_b128 v[152:155], v214 offset:0
  v_fma_f32 v167, v167, s42, v221
  v_exp_f32 v165, v165
  v_add_f32 v226, v226, v163
  v_fma_f32 v168, v168, s42, v221
  v_xor_b32 v215, 0x10000, v215
  v_mfma_f32_32x32x16_bf16 v[128:143], v[192:195], a[128:131], 0
  ds_read_b128 v[156:159], v215 offset:0
  v_exp_f32 v166, v166
  v_add_f32 v225, v225, v164
  v_cvt_pk_bf16_f32 v161, v162, v163
  s_waitcnt lgkmcnt(4)
  v_mfma_f32_32x32x16_bf16 v[128:143], v[196:199], a[132:135], v[128:143]
  ds_read_b64_tr_b16 v[192:193], v216 offset:57344
  ds_read_b64_tr_b16 v[194:195], v216 offset:59392
  v_fma_f32 v169, v169, s42, v221
  v_exp_f32 v167, v167
  v_add_f32 v226, v226, v165
  v_fma_f32 v170, v170, s42, v221
  v_mfma_f32_32x32x16_bf16 v[128:143], v[200:203], a[136:139], v[128:143]
  ds_read_b64_tr_b16 v[196:197], v217 offset:57344
  ds_read_b64_tr_b16 v[198:199], v217 offset:59392
  buffer_load_dwordx4 a[244:247], v249, s[20:23], s54 offen offset:128 nt
  buffer_load_dwordx4 a[252:255], v249, s[20:23], s54 offen offset:192 nt
  v_exp_f32 v168, v168
  v_add_f32 v225, v225, v166
  v_cvt_pk_bf16_f32 v162, v164, v165
  v_mfma_f32_32x32x16_bf16 v[128:143], v[204:207], a[140:143], v[128:143]
  ds_read_b64_tr_b16 v[200:201], v218 offset:57344
  ds_read_b64_tr_b16 v[202:203], v218 offset:59392
  v_fma_f32 v171, v171, s42, v221
  v_exp_f32 v169, v169
  v_add_f32 v226, v226, v167
  s_waitcnt lgkmcnt(7)
  v_mfma_f32_32x32x16_bf16 v[128:143], v[144:147], a[144:147], v[128:143]
  ds_read_b64_tr_b16 v[204:205], v219 offset:57344
  ds_read_b64_tr_b16 v[206:207], v219 offset:59392
  v_fma_f32 v172, v172, s42, v221
  v_exp_f32 v170, v170
  v_add_f32 v225, v225, v168
  v_cvt_pk_bf16_f32 v163, v166, v167
  v_mfma_f32_32x32x16_bf16 v[128:143], v[148:151], a[148:151], v[128:143]
  ds_read_b64_tr_b16 v[144:145], v216 offset:61440
  ds_read_b64_tr_b16 v[146:147], v216 offset:63488
  v_fma_f32 v173, v173, s42, v221
  v_exp_f32 v171, v171
  v_add_f32 v226, v226, v169
  v_fma_f32 v174, v174, s42, v221
  v_mfma_f32_32x32x16_bf16 v[128:143], v[152:155], a[152:155], v[128:143]
  ds_read_b64_tr_b16 v[148:149], v217 offset:61440
  ds_read_b64_tr_b16 v[150:151], v217 offset:63488
  v_exp_f32 v172, v172
  v_add_f32 v225, v225, v170
  v_cvt_pk_bf16_f32 v168, v168, v169
  s_waitcnt lgkmcnt(8)
  v_mfma_f32_32x32x16_bf16 v[128:143], v[156:159], a[156:159], v[128:143]
  ds_read_b64_tr_b16 v[152:153], v218 offset:61440
  ds_read_b64_tr_b16 v[154:155], v218 offset:63488
  v_fma_f32 v175, v175, s42, v221
  v_exp_f32 v173, v173
  v_add_f32 v226, v226, v171
  v_mfma_f32_32x32x16_bf16 v[0:15], v[192:195], v[160:163], v[0:15]
  ds_read_b64_tr_b16 v[156:157], v219 offset:61440
  ds_read_b64_tr_b16 v[158:159], v219 offset:63488
  v_exp_f32 v174, v174
  s_waitcnt vmcnt(6)
  s_barrier
  v_xor_b32 v208, 0x10000, v208
  v_mfma_f32_32x32x16_bf16 v[16:31], v[196:199], v[160:163], v[16:31]
  ds_read_b128 v[192:195], v208 offset:32768
  v_add_f32 v225, v225, v172
  v_cvt_pk_bf16_f32 v169, v170, v171
  v_exp_f32 v175, v175
  v_xor_b32 v209, 0x10000, v209
  s_waitcnt lgkmcnt(7)
  v_mfma_f32_32x32x16_bf16 v[32:47], v[200:203], v[160:163], v[32:47]
  ds_read_b128 v[196:199], v209 offset:32768
  v_add_f32 v226, v226, v173
  v_add_f32 v225, v225, v174
  v_cvt_pk_bf16_f32 v170, v172, v173
  v_add_f32 v226, v226, v175
  v_cvt_pk_bf16_f32 v171, v174, v175
  v_xor_b32 v210, 0x10000, v210
  v_mfma_f32_32x32x16_bf16 v[48:63], v[204:207], v[160:163], v[48:63]
  ds_read_b128 v[200:203], v210 offset:32768
  v_fma_f32 v128, v128, s42, v221
  v_fma_f32 v129, v129, s42, v221
  v_fma_f32 v130, v130, s42, v221
  v_exp_f32 v128, v128
  v_xor_b32 v211, 0x10000, v211
  v_mfma_f32_32x32x16_bf16 v[0:15], v[144:147], v[168:171], v[0:15]
  ds_read_b128 v[204:207], v211 offset:32768
  v_fma_f32 v131, v131, s42, v221
  v_exp_f32 v129, v129
  v_xor_b32 v212, 0x10000, v212
  s_waitcnt lgkmcnt(4)
  v_mfma_f32_32x32x16_bf16 v[16:31], v[148:151], v[168:171], v[16:31]
  ds_read_b128 v[144:147], v212 offset:32768
  v_fma_f32 v132, v132, s42, v221
  v_exp_f32 v130, v130
  v_add_f32 v225, v225, v128
  v_xor_b32 v213, 0x10000, v213
  v_mfma_f32_32x32x16_bf16 v[32:47], v[152:155], v[168:171], v[32:47]
  ds_read_b128 v[148:151], v213 offset:32768
  v_fma_f32 v133, v133, s42, v221
  v_exp_f32 v131, v131
  v_add_f32 v226, v226, v129
  v_xor_b32 v214, 0x10000, v214
  v_mfma_f32_32x32x16_bf16 v[48:63], v[156:159], v[168:171], v[48:63]
  ds_read_b128 v[152:155], v214 offset:32768
  v_fma_f32 v134, v134, s42, v221
  v_exp_f32 v132, v132
  v_xor_b32 v215, 0x10000, v215
  s_waitcnt lgkmcnt(4)
  v_mfma_f32_32x32x16_bf16 v[160:175], v[192:195], a[128:131], 0
  ds_read_b128 v[156:159], v215 offset:32768
  v_add_f32 v225, v225, v130
  v_cvt_pk_bf16_f32 v128, v128, v129
  v_fma_f32 v135, v135, s42, v221
  v_exp_f32 v133, v133
  v_mfma_f32_32x32x16_bf16 v[160:175], v[196:199], a[132:135], v[160:175]
  v_add_f32 v226, v226, v131
  v_fma_f32 v136, v136, s42, v221
  v_exp_f32 v134, v134
  v_add_f32 v225, v225, v132
  v_cvt_pk_bf16_f32 v129, v130, v131
  v_fma_f32 v137, v137, s42, v221
  v_mfma_f32_32x32x16_bf16 v[160:175], v[200:203], a[136:139], v[160:175]
  v_exp_f32 v135, v135
  v_add_f32 v226, v226, v133
  v_fma_f32 v138, v138, s42, v221
  s_waitcnt lgkmcnt(2)
  v_mfma_f32_32x32x16_bf16 v[160:175], v[204:207], a[140:143], v[160:175]
  v_exp_f32 v136, v136
  v_add_f32 v225, v225, v134
  v_cvt_pk_bf16_f32 v130, v132, v133
  v_fma_f32 v139, v139, s42, v221
  v_exp_f32 v137, v137
  v_mfma_f32_32x32x16_bf16 v[160:175], v[144:147], a[144:147], v[160:175]
  v_add_f32 v226, v226, v135
  v_fma_f32 v140, v140, s42, v221
  v_exp_f32 v138, v138
  v_add_f32 v225, v225, v136
  v_cvt_pk_bf16_f32 v131, v134, v135
  v_mfma_f32_32x32x16_bf16 v[160:175], v[148:151], a[148:151], v[160:175]
  v_fma_f32 v141, v141, s42, v221
  v_exp_f32 v139, v139
  v_add_f32 v226, v226, v137
  s_waitcnt lgkmcnt(0)
  v_mfma_f32_32x32x16_bf16 v[160:175], v[152:155], a[152:155], v[160:175]
  v_fma_f32 v142, v142, s42, v221
  v_exp_f32 v140, v140
  v_add_f32 v225, v225, v138
  v_cvt_pk_bf16_f32 v136, v136, v137
  v_mfma_f32_32x32x16_bf16 v[160:175], v[156:159], a[156:159], v[160:175]
  v_fma_f32 v143, v143, s42, v221
  v_exp_f32 v141, v141
  v_add_f32 v226, v226, v139
  v_exp_f32 v142, v142
  v_mfma_f32_32x32x16_bf16 v[0:15], a[0:3], v[128:131], v[0:15]
  v_xor_b32 v254, 48, v247
  v_add_f32 v225, v225, v140
  v_cvt_pk_bf16_f32 v137, v138, v139
  v_xor_b32 v208, 0x10000, v208
  v_mfma_f32_32x32x16_bf16 v[16:31], a[4:7], v[128:131], v[16:31]
  ds_read_b128 v[192:195], v208 offset:8192
  v_exp_f32 v143, v143
  v_add_f32 v226, v226, v141
  v_add_f32 v225, v225, v142
  v_xor_b32 v209, 0x10000, v209
  v_mfma_f32_32x32x16_bf16 v[32:47], a[8:11], v[128:131], v[32:47]
  ds_read_b128 v[196:199], v209 offset:8192
  v_cvt_pk_bf16_f32 v138, v140, v141
  v_fma_f32 v160, v160, s42, v221
  v_add_f32 v226, v226, v143
  v_cvt_pk_bf16_f32 v139, v142, v143
  v_xor_b32 v210, 0x10000, v210
  v_mfma_f32_32x32x16_bf16 v[48:63], a[12:15], v[128:131], v[48:63]
  ds_read_b128 v[200:203], v210 offset:8192
  v_fma_f32 v161, v161, s42, v221
  v_fma_f32 v162, v162, s42, v221
  v_exp_f32 v160, v160
  v_xor_b32 v211, 0x10000, v211
  v_mfma_f32_32x32x16_bf16 v[0:15], a[16:19], v[136:139], v[0:15]
  ds_read_b128 v[204:207], v211 offset:8192
  v_fma_f32 v163, v163, s42, v221
  v_exp_f32 v161, v161
  v_fma_f32 v164, v164, s42, v221
  v_xor_b32 v212, 0x10000, v212
  v_mfma_f32_32x32x16_bf16 v[16:31], a[20:23], v[136:139], v[16:31]
  ds_read_b128 v[144:147], v212 offset:8192
  v_exp_f32 v162, v162
  v_add_f32 v225, v225, v160
  v_fma_f32 v165, v165, s42, v221
  v_xor_b32 v213, 0x10000, v213
  v_mfma_f32_32x32x16_bf16 v[32:47], a[24:27], v[136:139], v[32:47]
  ds_read_b128 v[148:151], v213 offset:8192
  v_exp_f32 v163, v163
  v_add_f32 v226, v226, v161
  v_fma_f32 v166, v166, s42, v221
  v_xor_b32 v214, 0x10000, v214
  v_mfma_f32_32x32x16_bf16 v[48:63], a[28:31], v[136:139], v[48:63]
  ds_read_b128 v[152:155], v214 offset:8192
  v_exp_f32 v164, v164
  v_add_f32 v225, v225, v162
  v_xor_b32 v215, 0x10000, v215
  s_waitcnt lgkmcnt(4)
  v_mfma_f32_32x32x16_bf16 v[128:143], v[192:195], a[128:131], 0
  ds_read_b128 v[156:159], v215 offset:8192
  v_cvt_pk_bf16_f32 v160, v160, v161
  v_fma_f32 v167, v167, s42, v221
  v_exp_f32 v165, v165
  v_add_f32 v226, v226, v163
  v_mfma_f32_32x32x16_bf16 v[128:143], v[196:199], a[132:135], v[128:143]
  v_fma_f32 v168, v168, s42, v221
  v_exp_f32 v166, v166
  v_add_f32 v225, v225, v164
  v_cvt_pk_bf16_f32 v161, v162, v163
  v_fma_f32 v169, v169, s42, v221
  v_mfma_f32_32x32x16_bf16 v[128:143], v[200:203], a[136:139], v[128:143]
  v_exp_f32 v167, v167
  v_add_f32 v226, v226, v165
  v_fma_f32 v170, v170, s42, v221
  v_exp_f32 v168, v168
  s_waitcnt lgkmcnt(2)
  v_mfma_f32_32x32x16_bf16 v[128:143], v[204:207], a[140:143], v[128:143]
  v_add_f32 v225, v225, v166
  v_cvt_pk_bf16_f32 v162, v164, v165
  v_fma_f32 v171, v171, s42, v221
  v_exp_f32 v169, v169
  v_mfma_f32_32x32x16_bf16 v[128:143], v[144:147], a[144:147], v[128:143]
  v_add_f32 v226, v226, v167
  v_fma_f32 v172, v172, s42, v221
  v_exp_f32 v170, v170
  v_add_f32 v225, v225, v168
  v_cvt_pk_bf16_f32 v163, v166, v167
  v_mfma_f32_32x32x16_bf16 v[128:143], v[148:151], a[148:151], v[128:143]
  v_fma_f32 v173, v173, s42, v221
  v_exp_f32 v171, v171
  v_add_f32 v226, v226, v169
  v_fma_f32 v174, v174, s42, v221
  s_waitcnt lgkmcnt(0)
  v_mfma_f32_32x32x16_bf16 v[128:143], v[152:155], a[152:155], v[128:143]
  v_exp_f32 v172, v172
  v_add_f32 v225, v225, v170
  v_cvt_pk_bf16_f32 v168, v168, v169
  v_fma_f32 v175, v175, s42, v221
  v_exp_f32 v173, v173
  v_mfma_f32_32x32x16_bf16 v[128:143], v[156:159], a[156:159], v[128:143]
  v_add_f32 v226, v226, v171
  v_exp_f32 v174, v174
  v_add_f32 v225, v225, v172
  v_cvt_pk_bf16_f32 v169, v170, v171
  v_mfma_f32_32x32x16_bf16 v[0:15], a[32:35], v[160:163], v[0:15]
  v_exp_f32 v175, v175
  v_add_f32 v226, v226, v173
  v_add_f32 v225, v225, v174
  v_cvt_pk_bf16_f32 v170, v172, v173
  s_barrier
  v_mfma_f32_32x32x16_bf16 v[16:31], a[36:39], v[160:163], v[16:31]
  ds_read_b128 v[192:195], v208 offset:16384
  ds_write_b128 v250, a[224:227] offset:0
  ds_write_b128 v250, a[228:231] offset:1024
  v_mfma_f32_32x32x16_bf16 v[32:47], a[40:43], v[160:163], v[32:47]
  s_add_u32 m0, s40, 32768
  s_add_u32 s41, s8, 0
  buffer_load_dwordx4 v253, s[24:27], s41 offen lds
  ds_read_b128 v[196:199], v209 offset:16384
  v_add_f32 v226, v226, v175
  v_fma_f32 v128, v128, s42, v221
  v_cvt_pk_bf16_f32 v171, v174, v175
  v_fma_f32 v129, v129, s42, v221
  v_fma_f32 v130, v130, s42, v221
  v_mfma_f32_32x32x16_bf16 v[48:63], a[44:47], v[160:163], v[48:63]
  ds_read_b128 v[200:203], v210 offset:16384
  ds_read_b128 a[160:163], v245
  ds_read_b128 a[164:167], v246
  v_exp_f32 v128, v128
  v_fma_f32 v131, v131, s42, v221
  v_exp_f32 v129, v129
  v_mfma_f32_32x32x16_bf16 v[0:15], a[48:51], v[168:171], v[0:15]
  s_add_u32 m0, s40, 36864
  s_add_u32 s41, s8, 4096
  buffer_load_dwordx4 v253, s[24:27], s41 offen lds
  ds_read_b128 v[204:207], v211 offset:16384
  ds_write_b128 v250, a[232:235] offset:0
  ds_write_b128 v250, a[236:239] offset:1024
  v_mfma_f32_32x32x16_bf16 v[16:31], a[52:55], v[168:171], v[16:31]
  ds_read_b128 v[144:147], v212 offset:16384
  v_fma_f32 v132, v132, s42, v221
  v_exp_f32 v130, v130
  v_add_f32 v225, v225, v128
  v_fma_f32 v133, v133, s42, v221
  v_exp_f32 v131, v131
  v_mfma_f32_32x32x16_bf16 v[32:47], a[56:59], v[168:171], v[32:47]
  ds_read_b128 v[148:151], v213 offset:16384
  ds_read_b128 a[168:171], v245
  ds_read_b128 a[172:175], v246
  v_add_f32 v226, v226, v129
  v_fma_f32 v134, v134, s42, v221
  v_exp_f32 v132, v132
  v_add_f32 v225, v225, v130
  v_mfma_f32_32x32x16_bf16 v[48:63], a[60:63], v[168:171], v[48:63]
  ds_read_b128 v[152:155], v214 offset:16384
  s_waitcnt vmcnt(7)
  ds_write_b128 v250, a[240:243] offset:0
  s_waitcnt vmcnt(3)
  ds_write_b128 v250, a[244:247] offset:1024
  s_waitcnt lgkmcnt(10)
  v_mfma_f32_32x32x16_bf16 v[160:175], v[192:195], a[128:131], 0
  ds_read_b128 v[156:159], v215 offset:16384
  v_cvt_pk_bf16_f32 v128, v128, v129
  v_fma_f32 v135, v135, s42, v221
  v_exp_f32 v133, v133
  v_add_f32 v226, v226, v131
  v_fma_f32 v136, v136, s42, v221
  v_exp_f32 v134, v134
  v_mfma_f32_32x32x16_bf16 v[160:175], v[196:199], a[132:135], v[160:175]
  ds_read_b128 a[176:179], v245
  ds_read_b128 a[180:183], v246
  v_add_f32 v225, v225, v132
  v_cvt_pk_bf16_f32 v129, v130, v131
  v_fma_f32 v137, v137, s42, v221
  v_exp_f32 v135, v135
  v_add_f32 v226, v226, v133
  v_mfma_f32_32x32x16_bf16 v[160:175], v[200:203], a[136:139], v[160:175]
  ds_write_b128 v250, a[248:251] offset:0
  s_waitcnt vmcnt(2)
  ds_write_b128 v250, a[252:255] offset:1024
  s_waitcnt lgkmcnt(8)
  v_mfma_f32_32x32x16_bf16 v[160:175], v[204:207], a[140:143], v[160:175]
  v_fma_f32 v138, v138, s42, v221
  v_exp_f32 v136, v136
  v_add_f32 v225, v225, v134
  v_cvt_pk_bf16_f32 v130, v132, v133
  v_fma_f32 v139, v139, s42, v221
  v_exp_f32 v137, v137
  v_mfma_f32_32x32x16_bf16 v[160:175], v[144:147], a[144:147], v[160:175]
  ds_read_b128 a[184:187], v245
  ds_read_b128 a[188:191], v246
  v_add_f32 v226, v226, v135
  v_fma_f32 v140, v140, s42, v221
  v_exp_f32 v138, v138
  v_add_f32 v225, v225, v136
  v_cvt_pk_bf16_f32 v131, v134, v135
  v_mfma_f32_32x32x16_bf16 v[160:175], v[148:151], a[148:151], v[160:175]
  ds_write_b128 v250, a[192:195] offset:0
  ds_write_b128 v250, a[196:199] offset:1024
  s_waitcnt lgkmcnt(6)
  v_mfma_f32_32x32x16_bf16 v[160:175], v[152:155], a[152:155], v[160:175]
  v_fma_f32 v141, v141, s42, v221
  v_exp_f32 v139, v139
  v_add_f32 v226, v226, v137
  v_fma_f32 v142, v142, s42, v221
  v_exp_f32 v140, v140
  v_add_f32 v225, v225, v138
  v_mfma_f32_32x32x16_bf16 v[160:175], v[156:159], a[156:159], v[160:175]
  ds_read_b128 a[128:131], v245
  ds_read_b128 a[132:135], v246
  v_cvt_pk_bf16_f32 v136, v136, v137
  v_fma_f32 v143, v143, s42, v221
  v_exp_f32 v141, v141
  v_add_f32 v226, v226, v139
  v_mfma_f32_32x32x16_bf16 v[0:15], a[64:67], v[128:131], v[0:15]
  ds_write_b128 v250, a[200:203] offset:0
  ds_write_b128 v250, a[204:207] offset:1024
  v_xor_b32 v208, 0x10000, v208
  v_mfma_f32_32x32x16_bf16 v[16:31], a[68:71], v[128:131], v[16:31]
  ds_read_b128 v[192:195], v208 offset:0
  v_exp_f32 v142, v142
  v_add_f32 v225, v225, v140
  v_cvt_pk_bf16_f32 v137, v138, v139
  v_exp_f32 v143, v143
  v_add_f32 v226, v226, v141
  v_mfma_f32_32x32x16_bf16 v[32:47], a[72:75], v[128:131], v[32:47]
  ds_read_b128 a[136:139], v245
  ds_read_b128 a[140:143], v246
  v_add_f32 v225, v225, v142
  v_cvt_pk_bf16_f32 v138, v140, v141
  v_add_f32 v226, v226, v143
  v_cvt_pk_bf16_f32 v139, v142, v143
  v_xor_b32 v209, 0x10000, v209
  v_mfma_f32_32x32x16_bf16 v[48:63], a[76:79], v[128:131], v[48:63]
  ds_read_b128 v[196:199], v209 offset:0
  ds_write_b128 v250, a[208:211] offset:0
  ds_write_b128 v250, a[212:215] offset:1024
  v_mfma_f32_32x32x16_bf16 v[0:15], a[80:83], v[136:139], v[0:15]
  v_fma_f32 v160, v160, s42, v221
  v_fma_f32 v161, v161, s42, v221
  v_fma_f32 v162, v162, s42, v221
  v_exp_f32 v160, v160
  v_xor_b32 v210, 0x10000, v210
  v_mfma_f32_32x32x16_bf16 v[16:31], a[84:87], v[136:139], v[16:31]
  ds_read_b128 v[200:203], v210 offset:0
  ds_read_b128 a[144:147], v245
  ds_read_b128 a[148:151], v246
  v_fma_f32 v163, v163, s42, v221
  v_mfma_f32_32x32x16_bf16 v[32:47], a[88:91], v[136:139], v[32:47]
  ds_write_b128 v250, a[216:219] offset:0
  ds_write_b128 v250, a[220:223] offset:1024
  v_xor_b32 v211, 0x10000, v211
  v_mfma_f32_32x32x16_bf16 v[48:63], a[92:95], v[136:139], v[48:63]
  ds_read_b128 v[204:207], v211 offset:0
  v_exp_f32 v161, v161
  v_fma_f32 v164, v164, s42, v221
  s_waitcnt lgkmcnt(6)
  v_mfma_f32_32x32x16_bf16 v[128:143], v[192:195], a[128:131], 0
  ds_read_b128 a[152:155], v245
  ds_read_b128 a[156:159], v246
  v_exp_f32 v162, v162
  v_add_f32 v225, v225, v160
  v_xor_b32 v212, 0x10000, v212
  v_mfma_f32_32x32x16_bf16 v[144:159], v[192:195], a[160:163], 0
  ds_read_b128 v[192:195], v212 offset:0
  v_fma_f32 v165, v165, s42, v221
  v_exp_f32 v163, v163
  v_add_f32 v226, v226, v161
  v_mfma_f32_32x32x16_bf16 v[128:143], v[196:199], a[132:135], v[128:143]
  v_fma_f32 v166, v166, s42, v221
  v_exp_f32 v164, v164
  v_add_f32 v225, v225, v162
  v_xor_b32 v213, 0x10000, v213
  v_mfma_f32_32x32x16_bf16 v[144:159], v[196:199], a[164:167], v[144:159]
  ds_read_b128 v[196:199], v213 offset:0
  v_cvt_pk_bf16_f32 v160, v160, v161
  v_fma_f32 v167, v167, s42, v221
  v_exp_f32 v165, v165
  s_waitcnt lgkmcnt(4)
  v_mfma_f32_32x32x16_bf16 v[128:143], v[200:203], a[136:139], v[128:143]
  v_add_f32 v226, v226, v163
  v_fma_f32 v168, v168, s42, v221
  v_exp_f32 v166, v166
  v_xor_b32 v214, 0x10000, v214
  v_mfma_f32_32x32x16_bf16 v[144:159], v[200:203], a[168:171], v[144:159]
  ds_read_b128 v[200:203], v214 offset:0
  v_add_f32 v225, v225, v164
  v_cvt_pk_bf16_f32 v161, v162, v163
  v_fma_f32 v169, v169, s42, v221
  v_mfma_f32_32x32x16_bf16 v[128:143], v[204:207], a[140:143], v[128:143]
  v_exp_f32 v167, v167
  v_add_f32 v226, v226, v165
  v_fma_f32 v170, v170, s42, v221
  v_xor_b32 v215, 0x10000, v215
  v_mfma_f32_32x32x16_bf16 v[144:159], v[204:207], a[172:175], v[144:159]
  ds_read_b128 v[204:207], v215 offset:0
  v_exp_f32 v168, v168
  v_add_f32 v225, v225, v166
  s_waitcnt lgkmcnt(2)
  v_mfma_f32_32x32x16_bf16 v[128:143], v[192:195], a[144:147], v[128:143]
  v_cvt_pk_bf16_f32 v162, v164, v165
  v_fma_f32 v171, v171, s42, v221
  v_exp_f32 v169, v169
  v_add_f32 v226, v226, v167
  v_mfma_f32_32x32x16_bf16 v[144:159], v[192:195], a[176:179], v[144:159]
  v_fma_f32 v172, v172, s42, v221
  v_exp_f32 v170, v170
  v_add_f32 v225, v225, v168
  v_cvt_pk_bf16_f32 v163, v166, v167
  v_mfma_f32_32x32x16_bf16 v[128:143], v[196:199], a[148:151], v[128:143]
  v_fma_f32 v173, v173, s42, v221
  v_exp_f32 v171, v171
  v_mfma_f32_32x32x16_bf16 v[144:159], v[196:199], a[180:183], v[144:159]
  v_add_f32 v226, v226, v169
  v_fma_f32 v174, v174, s42, v221
  s_waitcnt lgkmcnt(0)
  v_mfma_f32_32x32x16_bf16 v[128:143], v[200:203], a[152:155], v[128:143]
  v_exp_f32 v172, v172
  v_add_f32 v225, v225, v170
  v_mfma_f32_32x32x16_bf16 v[144:159], v[200:203], a[184:187], v[144:159]
  v_cvt_pk_bf16_f32 v168, v168, v169
  v_fma_f32 v175, v175, s42, v221
  v_mfma_f32_32x32x16_bf16 v[128:143], v[204:207], a[156:159], v[128:143]
  v_exp_f32 v173, v173
  v_add_f32 v226, v226, v171
  v_mfma_f32_32x32x16_bf16 v[144:159], v[204:207], a[188:191], v[144:159]
  v_exp_f32 v174, v174
  v_add_f32 v225, v225, v172
  v_mfma_f32_32x32x16_bf16 v[0:15], a[96:99], v[160:163], v[0:15]
  v_cvt_pk_bf16_f32 v169, v170, v171
  v_exp_f32 v175, v175
  v_mfma_f32_32x32x16_bf16 v[16:31], a[100:103], v[160:163], v[16:31]
  ds_read_b128 v[192:195], v208 offset:8192
  v_add_f32 v226, v226, v173
  s_nop 0
  v_max3_f32 v233, v128, v129, v130
  v_add_f32 v225, v225, v174
  v_max3_f32 v234, v131, v132, v133
  v_max3_f32 v235, v134, v135, v136
  v_max3_f32 v236, v137, v138, v139
  v_max3_f32 v237, v144, v145, v146
  v_mfma_f32_32x32x16_bf16 v[32:47], a[104:107], v[160:163], v[32:47]
  v_cvt_pk_bf16_f32 v170, v172, v173
  v_max3_f32 v238, v147, v148, v149
  v_add_f32 v226, v226, v175
  v_max3_f32 v239, v150, v151, v152
  v_cvt_pk_bf16_f32 v171, v174, v175
  v_max3_f32 v240, v153, v154, v155
  v_max3_f32 v233, v233, v140, v141
  v_mfma_f32_32x32x16_bf16 v[48:63], a[108:111], v[160:163], v[48:63]
  ds_read_b128 v[196:199], v209 offset:8192
  v_add_f32 v225, v225, v226
  v_mov_b32 v226, v225
  v_max3_f32 v234, v234, v142, v143
  v_max3_f32 v237, v237, v156, v157
  v_max3_f32 v238, v238, v158, v159
  v_permlane32_swap_b32 v225, v226
  v_mfma_f32_32x32x16_bf16 v[0:15], a[112:115], v[168:171], v[0:15]
  v_add_f32 v225, v225, v226
  v_max3_f32 v235, v235, v236, v233
  v_max3_f32 v239, v239, v240, v237
  v_max_f32 v233, v234, v235
  v_max_f32 v237, v238, v239
  v_mov_b32 v234, v233
  v_rcp_f32 v251, v225
  v_mfma_f32_32x32x16_bf16 v[16:31], a[116:119], v[168:171], v[16:31]
  ds_read_b128 v[200:203], v210 offset:8192
  v_cmp_ngt_f32 s[38:39], s44, v225
  v_mov_b32 v238, v237
  v_permlane32_swap_b32 v233, v234
  s_nop 0
  v_permlane32_swap_b32 v237, v238
  s_nop 3
  v_mfma_f32_32x32x16_bf16 v[32:47], a[120:123], v[168:171], v[32:47]
  s_cmp_lg_u64 s[38:39], 0
  s_cselect_b32 s38, 1, 0
  s_or_b32 s45, s45, s38
  v_max_f32 v233, v233, v234
  v_max_f32 v237, v237, v238
  v_mul_f32 v223, s43, v233
  v_mul_f32 v224, s43, v237
  v_mfma_f32_32x32x16_bf16 v[48:63], a[124:127], v[168:171], v[48:63]
  ds_read_b128 v[204:207], v211 offset:8192
  v_fma_f32 v128, v128, s42, v223
  v_mul_f32 v0, v0, v251
  v_fma_f32 v129, v129, s42, v223
  v_mul_f32 v1, v1, v251
  v_fma_f32 v130, v130, s42, v223
  v_mul_f32 v2, v2, v251
  v_exp_f32 v128, v128
  v_mul_f32 v3, v3, v251
  v_mul_f32 v4, v4, v251
  v_mul_f32 v5, v5, v251
  s_waitcnt lgkmcnt(2)
  v_mfma_f32_32x32x16_bf16 v[160:175], v[192:195], a[128:131], 0
  v_fma_f32 v131, v131, s42, v223
  v_mul_f32 v6, v6, v251
  v_exp_f32 v129, v129
  v_mul_f32 v7, v7, v251
  v_fma_f32 v132, v132, s42, v223
  v_mul_f32 v8, v8, v251
  v_exp_f32 v130, v130
  v_mul_f32 v9, v9, v251
  v_add_f32 v229, 0, v128
  v_mul_f32 v10, v10, v251
  v_fma_f32 v133, v133, s42, v223
  v_mfma_f32_32x32x16_bf16 v[176:191], v[192:195], a[160:163], 0
  ds_read_b128 v[192:195], v212 offset:8192
  v_exp_f32 v131, v131
  v_mul_f32 v11, v11, v251
  v_add_f32 v230, 0, v129
  v_mul_f32 v12, v12, v251
  v_fma_f32 v134, v134, s42, v223
  v_mul_f32 v13, v13, v251
  v_exp_f32 v132, v132
  v_mul_f32 v14, v14, v251
  v_mul_f32 v15, v15, v251
  v_cvt_pk_bf16_f32 v0, v0, v1
  v_mfma_f32_32x32x16_bf16 v[160:175], v[196:199], a[132:135], v[160:175]
  v_add_f32 v229, v229, v130
  v_cvt_pk_bf16_f32 v1, v2, v3
  v_cvt_pk_bf16_f32 v128, v128, v129
  v_cvt_pk_bf16_f32 v2, v4, v5
  v_fma_f32 v135, v135, s42, v223
  v_cvt_pk_bf16_f32 v3, v6, v7
  v_exp_f32 v133, v133
  v_cvt_pk_bf16_f32 v8, v8, v9
  v_add_f32 v230, v230, v131
  v_cvt_pk_bf16_f32 v9, v10, v11
  v_fma_f32 v144, v144, s42, v224
  v_cvt_pk_bf16_f32 v10, v12, v13
  v_cvt_pk_bf16_f32 v11, v14, v15
  v_mfma_f32_32x32x16_bf16 v[176:191], v[196:199], a[164:167], v[176:191]
  ds_read_b128 v[196:199], v213 offset:8192
  v_exp_f32 v134, v134
  ds_write_b64 v247, v[0:1]
  v_add_f32 v229, v229, v132
  ds_write_b64 v248, v[2:3]
  v_cvt_pk_bf16_f32 v129, v130, v131
  v_fma_f32 v145, v145, s42, v224
  v_exp_f32 v135, v135
  s_waitcnt lgkmcnt(4)
  v_mfma_f32_32x32x16_bf16 v[160:175], v[200:203], a[136:139], v[160:175]
  v_add_f32 v230, v230, v133
  ds_write_b64 v255, v[8:9]
  v_fma_f32 v146, v146, s42, v224
  ds_write_b64 v254, v[10:11]
  v_exp_f32 v144, v144
  ds_read_b128 a[192:195], v250 offset:0
  v_add_f32 v229, v229, v134
  ds_read_b128 a[196:199], v250 offset:1024
  v_cvt_pk_bf16_f32 v130, v132, v133
  v_fma_f32 v147, v147, s42, v224
  v_mfma_f32_32x32x16_bf16 v[176:191], v[200:203], a[168:171], v[176:191]
  ds_read_b128 v[200:203], v214 offset:8192
  v_exp_f32 v145, v145
  v_mul_f32 v16, v16, v251
  v_add_f32 v230, v230, v135
  v_mul_f32 v17, v17, v251
  v_fma_f32 v148, v148, s42, v224
  v_mul_f32 v18, v18, v251
  v_exp_f32 v146, v146
  v_mul_f32 v19, v19, v251
  v_mul_f32 v20, v20, v251
  v_mul_f32 v21, v21, v251
  v_mfma_f32_32x32x16_bf16 v[160:175], v[204:207], a[140:143], v[160:175]
  v_add_f32 v231, 0, v144
  v_mul_f32 v22, v22, v251
  v_cvt_pk_bf16_f32 v131, v134, v135
  v_mul_f32 v23, v23, v251
  v_fma_f32 v149, v149, s42, v224
  v_mul_f32 v24, v24, v251
  v_exp_f32 v147, v147
  v_mul_f32 v25, v25, v251
  v_add_f32 v232, 0, v145
  v_mul_f32 v26, v26, v251
  v_fma_f32 v150, v150, s42, v224
  v_mul_f32 v27, v27, v251
  v_mfma_f32_32x32x16_bf16 v[176:191], v[204:207], a[172:175], v[176:191]
  ds_read_b128 v[204:207], v215 offset:8192
  v_exp_f32 v148, v148
  v_mul_f32 v28, v28, v251
  v_add_f32 v231, v231, v146
  v_mul_f32 v29, v29, v251
  v_cvt_pk_bf16_f32 v144, v144, v145
  v_mul_f32 v30, v30, v251
  v_fma_f32 v151, v151, s42, v224
  v_mul_f32 v31, v31, v251
  v_exp_f32 v149, v149
  s_waitcnt lgkmcnt(6)
  v_mfma_f32_32x32x16_bf16 v[160:175], v[192:195], a[144:147], v[160:175]
  v_add_f32 v232, v232, v147
  v_cvt_pk_bf16_f32 v16, v16, v17
  v_fma_f32 v136, v136, s42, v223
  v_cvt_pk_bf16_f32 v17, v18, v19
  v_exp_f32 v150, v150
  v_cvt_pk_bf16_f32 v18, v20, v21
  v_add_f32 v231, v231, v148
  v_cvt_pk_bf16_f32 v19, v22, v23
  v_cvt_pk_bf16_f32 v145, v146, v147
  v_cvt_pk_bf16_f32 v24, v24, v25
  v_cvt_pk_bf16_f32 v25, v26, v27
  v_cvt_pk_bf16_f32 v26, v28, v29
  v_mfma_f32_32x32x16_bf16 v[176:191], v[192:195], a[176:179], v[176:191]
  ds_read_b64_tr_b16 v[192:193], v216 offset:0
  ds_read_b64_tr_b16 v[194:195], v216 offset:2048
  v_fma_f32 v137, v137, s42, v223
  v_cvt_pk_bf16_f32 v27, v30, v31
  v_exp_f32 v151, v151
  ds_write_b64 v247, v[16:17]
  v_add_f32 v232, v232, v149
  ds_write_b64 v248, v[18:19]
  v_fma_f32 v138, v138, s42, v223
  ds_write_b64 v255, v[24:25]
  v_mfma_f32_32x32x16_bf16 v[160:175], v[196:199], a[148:151], v[160:175]
  v_exp_f32 v136, v136
  ds_write_b64 v254, v[26:27]
  v_add_f32 v231, v231, v150
  ds_read_b128 a[200:203], v250 offset:0
  v_cvt_pk_bf16_f32 v146, v148, v149
  ds_read_b128 a[204:207], v250 offset:1024
  v_fma_f32 v139, v139, s42, v223
  v_exp_f32 v137, v137
  v_add_f32 v232, v232, v151
  v_mfma_f32_32x32x16_bf16 v[176:191], v[196:199], a[180:183], v[176:191]
  ds_read_b64_tr_b16 v[196:197], v217 offset:0
  ds_read_b64_tr_b16 v[198:199], v217 offset:2048
  v_fma_f32 v140, v140, s42, v223
  v_mul_f32 v32, v32, v251
  v_exp_f32 v138, v138
  v_mul_f32 v33, v33, v251
  v_add_f32 v229, v229, v136
  v_mul_f32 v34, v34, v251
  v_cvt_pk_bf16_f32 v147, v150, v151
  v_mul_f32 v35, v35, v251
  v_mul_f32 v36, v36, v251
  s_waitcnt lgkmcnt(10)
  v_mfma_f32_32x32x16_bf16 v[160:175], v[200:203], a[152:155], v[160:175]
  v_fma_f32 v141, v141, s42, v223
  v_mul_f32 v37, v37, v251
  v_exp_f32 v139, v139
  v_mul_f32 v38, v38, v251
  v_add_f32 v230, v230, v137
  v_mul_f32 v39, v39, v251
  v_fma_f32 v142, v142, s42, v223
  v_mul_f32 v40, v40, v251
  v_exp_f32 v140, v140
  v_mul_f32 v41, v41, v251
  v_mul_f32 v42, v42, v251
  v_mfma_f32_32x32x16_bf16 v[176:191], v[200:203], a[184:187], v[176:191]
  ds_read_b64_tr_b16 v[200:201], v218 offset:0
  ds_read_b64_tr_b16 v[202:203], v218 offset:2048
  v_add_f32 v229, v229, v138
  v_mul_f32 v43, v43, v251
  v_cvt_pk_bf16_f32 v136, v136, v137
  v_mul_f32 v44, v44, v251
  v_fma_f32 v143, v143, s42, v223
  v_mul_f32 v45, v45, v251
  v_exp_f32 v141, v141
  v_mul_f32 v46, v46, v251
  v_mul_f32 v47, v47, v251
  v_cvt_pk_bf16_f32 v32, v32, v33
  v_mfma_f32_32x32x16_bf16 v[160:175], v[204:207], a[156:159], v[160:175]
  v_add_f32 v230, v230, v139
  v_cvt_pk_bf16_f32 v33, v34, v35
  v_fma_f32 v152, v152, s42, v224
  v_cvt_pk_bf16_f32 v34, v36, v37
  v_exp_f32 v142, v142
  v_cvt_pk_bf16_f32 v35, v38, v39
  v_add_f32 v229, v229, v140
  v_cvt_pk_bf16_f32 v40, v40, v41
  v_cvt_pk_bf16_f32 v137, v138, v139
  v_cvt_pk_bf16_f32 v41, v42, v43
  v_fma_f32 v153, v153, s42, v224
  v_cvt_pk_bf16_f32 v42, v44, v45
  v_mfma_f32_32x32x16_bf16 v[176:191], v[204:207], a[188:191], v[176:191]
  ds_read_b64_tr_b16 v[204:205], v219 offset:0
  ds_read_b64_tr_b16 v[206:207], v219 offset:2048
  v_exp_f32 v143, v143
  v_cvt_pk_bf16_f32 v43, v46, v47
  v_add_f32 v230, v230, v141
  ds_write_b64 v247, v[32:33]
  v_fma_f32 v154, v154, s42, v224
  ds_write_b64 v248, v[34:35]
  ds_write_b64 v255, v[40:41]
  s_waitcnt lgkmcnt(7)
  v_mfma_f32_32x32x16_bf16 v[0:15], v[192:195], v[128:131], 0
  v_exp_f32 v152, v152
  ds_write_b64 v254, v[42:43]
  v_add_f32 v229, v229, v142
  ds_read_b128 a[208:211], v250 offset:0
  v_cvt_pk_bf16_f32 v138, v140, v141
  ds_read_b128 a[212:215], v250 offset:1024
  v_fma_f32 v155, v155, s42, v224
  v_exp_f32 v153, v153
  v_add_f32 v230, v230, v143
  v_mfma_f32_32x32x16_bf16 v[64:79], v[192:195], v[144:147], 0
  ds_read_b64_tr_b16 v[192:193], v216 offset:4096
  ds_read_b64_tr_b16 v[194:195], v216 offset:6144
  v_fma_f32 v156, v156, s42, v224
  v_mul_f32 v48, v48, v251
  v_exp_f32 v154, v154
  v_mul_f32 v49, v49, v251
  v_add_f32 v231, v231, v152
  v_mul_f32 v50, v50, v251
  v_cvt_pk_bf16_f32 v139, v142, v143
  v_mul_f32 v51, v51, v251
  v_mul_f32 v52, v52, v251
  v_mul_f32 v53, v53, v251
  v_mul_f32 v54, v54, v251
  v_mul_f32 v55, v55, v251
  v_mul_f32 v56, v56, v251
  v_mfma_f32_32x32x16_bf16 v[16:31], v[196:199], v[128:131], 0
  v_fma_f32 v157, v157, s42, v224
  v_mul_f32 v57, v57, v251
  v_exp_f32 v155, v155
  v_mul_f32 v58, v58, v251
  v_add_f32 v232, v232, v153
  v_mul_f32 v59, v59, v251
  v_fma_f32 v158, v158, s42, v224
  v_mul_f32 v60, v60, v251
  v_exp_f32 v156, v156
  v_mul_f32 v61, v61, v251
  v_mul_f32 v62, v62, v251
  v_mul_f32 v63, v63, v251
  v_cvt_pk_bf16_f32 v48, v48, v49
  v_mfma_f32_32x32x16_bf16 v[80:95], v[196:199], v[144:147], 0
  ds_read_b64_tr_b16 v[196:197], v217 offset:4096
  ds_read_b64_tr_b16 v[198:199], v217 offset:6144
  v_add_f32 v231, v231, v154
  v_cvt_pk_bf16_f32 v49, v50, v51
  v_cvt_pk_bf16_f32 v152, v152, v153
  v_cvt_pk_bf16_f32 v50, v52, v53
  v_fma_f32 v159, v159, s42, v224
  v_cvt_pk_bf16_f32 v51, v54, v55
  v_exp_f32 v157, v157
  v_cvt_pk_bf16_f32 v56, v56, v57
  v_cvt_pk_bf16_f32 v57, v58, v59
  v_cvt_pk_bf16_f32 v58, v60, v61
  v_cvt_pk_bf16_f32 v59, v62, v63
  ds_write_b64 v247, v[48:49]
  s_waitcnt lgkmcnt(8)
  v_mfma_f32_32x32x16_bf16 v[32:47], v[200:203], v[128:131], 0
  v_add_f32 v232, v232, v155
  ds_write_b64 v248, v[50:51]
  v_exp_f32 v158, v158
  ds_write_b64 v255, v[56:57]
  v_add_f32 v231, v231, v156
  ds_write_b64 v254, v[58:59]
  v_cvt_pk_bf16_f32 v153, v154, v155
  ds_read_b128 a[216:219], v250 offset:0
  v_exp_f32 v159, v159
  ds_read_b128 a[220:223], v250 offset:1024
  v_mfma_f32_32x32x16_bf16 v[96:111], v[200:203], v[144:147], 0
  ds_read_b64_tr_b16 v[200:201], v218 offset:4096
  ds_read_b64_tr_b16 v[202:203], v218 offset:6144
  v_add_f32 v232, v232, v157
  v_add_f32 v231, v231, v158
  v_cvt_pk_bf16_f32 v154, v156, v157
  v_add_f32 v232, v232, v159
  v_cvt_pk_bf16_f32 v155, v158, v159
  v_mfma_f32_32x32x16_bf16 v[48:63], v[204:207], v[128:131], 0
  v_fma_f32 v160, v160, s42, v223
  v_fma_f32 v161, v161, s42, v223
  v_fma_f32 v162, v162, s42, v223
  v_exp_f32 v160, v160
  v_fma_f32 v163, v163, s42, v223
  v_mfma_f32_32x32x16_bf16 v[112:127], v[204:207], v[144:147], 0
  ds_read_b64_tr_b16 v[204:205], v219 offset:4096
  ds_read_b64_tr_b16 v[206:207], v219 offset:6144
  v_exp_f32 v161, v161
  v_fma_f32 v164, v164, s42, v223
  s_waitcnt lgkmcnt(9)
  v_mfma_f32_32x32x16_bf16 v[0:15], v[192:195], v[136:139], v[0:15]
  v_exp_f32 v162, v162
  v_add_f32 v229, v229, v160
  v_fma_f32 v165, v165, s42, v223
  v_exp_f32 v163, v163
  v_mfma_f32_32x32x16_bf16 v[64:79], v[192:195], v[152:155], v[64:79]
  ds_read_b128 v[192:195], v208 offset:16384
  v_add_f32 v230, v230, v161
  v_fma_f32 v166, v166, s42, v223
  v_exp_f32 v164, v164
  v_mfma_f32_32x32x16_bf16 v[16:31], v[196:199], v[136:139], v[16:31]
  buffer_store_dwordx4 a[192:195], v249, s[32:35], s46 offen offset:0 sc1
  v_add_f32 v229, v229, v162
  v_cvt_pk_bf16_f32 v160, v160, v161
  v_fma_f32 v167, v167, s42, v223
  v_exp_f32 v165, v165
  v_mfma_f32_32x32x16_bf16 v[80:95], v[196:199], v[152:155], v[80:95]
  ds_read_b128 v[196:199], v209 offset:16384
  v_add_f32 v230, v230, v163
  v_fma_f32 v176, v176, s42, v224
  v_exp_f32 v166, v166
  s_waitcnt lgkmcnt(2)
  v_mfma_f32_32x32x16_bf16 v[32:47], v[200:203], v[136:139], v[32:47]
  v_add_f32 v229, v229, v164
  v_cvt_pk_bf16_f32 v161, v162, v163
  v_fma_f32 v177, v177, s42, v224
  v_exp_f32 v167, v167
  v_add_f32 v230, v230, v165
  v_mfma_f32_32x32x16_bf16 v[96:111], v[200:203], v[152:155], v[96:111]
  ds_read_b128 v[200:203], v210 offset:16384
  v_fma_f32 v178, v178, s42, v224
  v_exp_f32 v176, v176
  v_add_f32 v229, v229, v166
  v_cvt_pk_bf16_f32 v162, v164, v165
  v_mfma_f32_32x32x16_bf16 v[48:63], v[204:207], v[136:139], v[48:63]
  v_fma_f32 v179, v179, s42, v224
  v_exp_f32 v177, v177
  v_add_f32 v230, v230, v167
  v_fma_f32 v180, v180, s42, v224
  v_mfma_f32_32x32x16_bf16 v[112:127], v[204:207], v[152:155], v[112:127]
  ds_read_b128 v[204:207], v211 offset:16384
  v_exp_f32 v178, v178
  v_add_f32 v231, v231, v176
  v_cvt_pk_bf16_f32 v163, v166, v167
  s_waitcnt lgkmcnt(2)
  v_mfma_f32_32x32x16_bf16 v[128:143], v[192:195], a[128:131], 0
  v_fma_f32 v181, v181, s42, v224
  v_exp_f32 v179, v179
  v_add_f32 v232, v232, v177
  v_fma_f32 v182, v182, s42, v224
  v_exp_f32 v180, v180
  v_mfma_f32_32x32x16_bf16 v[144:159], v[192:195], a[160:163], 0
  ds_read_b128 v[192:195], v212 offset:16384
  v_add_f32 v231, v231, v178
  v_cvt_pk_bf16_f32 v176, v176, v177
  v_fma_f32 v183, v183, s42, v224
  v_mfma_f32_32x32x16_bf16 v[128:143], v[196:199], a[132:135], v[128:143]
  v_exp_f32 v181, v181
  v_add_f32 v232, v232, v179
  v_fma_f32 v168, v168, s42, v223
  v_exp_f32 v182, v182
  v_add_f32 v231, v231, v180
  v_mfma_f32_32x32x16_bf16 v[144:159], v[196:199], a[164:167], v[144:159]
  ds_read_b128 v[196:199], v213 offset:16384
  v_cvt_pk_bf16_f32 v177, v178, v179
  v_fma_f32 v169, v169, s42, v223
  v_exp_f32 v183, v183
  s_waitcnt lgkmcnt(2)
  v_mfma_f32_32x32x16_bf16 v[128:143], v[200:203], a[136:139], v[128:143]
  buffer_store_dwordx4 a[200:203], v249, s[32:35], s46 offen offset:64 sc1
  v_add_f32 v232, v232, v181
  v_fma_f32 v170, v170, s42, v223
  v_exp_f32 v168, v168
  v_mfma_f32_32x32x16_bf16 v[144:159], v[200:203], a[168:171], v[144:159]
  ds_read_b128 v[200:203], v214 offset:16384
  v_add_f32 v231, v231, v182
  v_cvt_pk_bf16_f32 v178, v180, v181
  v_fma_f32 v171, v171, s42, v223
  v_exp_f32 v169, v169
  v_mfma_f32_32x32x16_bf16 v[128:143], v[204:207], a[140:143], v[128:143]
  v_add_f32 v232, v232, v183
  v_fma_f32 v172, v172, s42, v223
  v_exp_f32 v170, v170
  v_add_f32 v229, v229, v168
  v_cvt_pk_bf16_f32 v179, v182, v183
  v_mfma_f32_32x32x16_bf16 v[144:159], v[204:207], a[172:175], v[144:159]
  ds_read_b128 v[204:207], v215 offset:16384
  v_fma_f32 v173, v173, s42, v223
  v_exp_f32 v171, v171
  s_waitcnt lgkmcnt(2)
  v_mfma_f32_32x32x16_bf16 v[128:143], v[192:195], a[144:147], v[128:143]
  v_add_f32 v230, v230, v169
  v_fma_f32 v174, v174, s42, v223
  v_exp_f32 v172, v172
  v_add_f32 v229, v229, v170
  v_cvt_pk_bf16_f32 v168, v168, v169
  v_mfma_f32_32x32x16_bf16 v[144:159], v[192:195], a[176:179], v[144:159]
  ds_read_b64_tr_b16 v[192:193], v216 offset:8192
  ds_read_b64_tr_b16 v[194:195], v216 offset:10240
  v_fma_f32 v175, v175, s42, v223
  v_exp_f32 v173, v173
  v_mfma_f32_32x32x16_bf16 v[128:143], v[196:199], a[148:151], v[128:143]
  v_add_f32 v230, v230, v171
  v_fma_f32 v184, v184, s42, v224
  v_exp_f32 v174, v174
  v_add_f32 v229, v229, v172
  v_mfma_f32_32x32x16_bf16 v[144:159], v[196:199], a[180:183], v[144:159]
  ds_read_b64_tr_b16 v[196:197], v217 offset:8192
  ds_read_b64_tr_b16 v[198:199], v217 offset:10240
  v_cvt_pk_bf16_f32 v169, v170, v171
  v_fma_f32 v185, v185, s42, v224
  s_waitcnt lgkmcnt(4)
  v_mfma_f32_32x32x16_bf16 v[128:143], v[200:203], a[152:155], v[128:143]
  v_exp_f32 v175, v175
  v_add_f32 v230, v230, v173
  v_fma_f32 v186, v186, s42, v224
  v_exp_f32 v184, v184
  v_mfma_f32_32x32x16_bf16 v[144:159], v[200:203], a[184:187], v[144:159]
  ds_read_b64_tr_b16 v[200:201], v218 offset:8192
  ds_read_b64_tr_b16 v[202:203], v218 offset:10240
  v_add_f32 v229, v229, v174
  v_cvt_pk_bf16_f32 v170, v172, v173
  v_fma_f32 v187, v187, s42, v224
  v_mfma_f32_32x32x16_bf16 v[128:143], v[204:207], a[156:159], v[128:143]
  buffer_store_dwordx4 a[196:199], v249, s[32:35], s52 offen offset:0 sc1
  v_exp_f32 v185, v185
  v_add_f32 v230, v230, v175
  v_fma_f32 v188, v188, s42, v224
  v_mfma_f32_32x32x16_bf16 v[144:159], v[204:207], a[188:191], v[144:159]
  ds_read_b64_tr_b16 v[204:205], v219 offset:8192
  ds_read_b64_tr_b16 v[206:207], v219 offset:10240
  v_exp_f32 v186, v186
  v_add_f32 v231, v231, v184
  s_waitcnt lgkmcnt(4)
  v_mfma_f32_32x32x16_bf16 v[0:15], v[192:195], v[160:163], v[0:15]
  v_cvt_pk_bf16_f32 v171, v174, v175
  v_fma_f32 v189, v189, s42, v224
  v_exp_f32 v187, v187
  v_add_f32 v232, v232, v185
  v_mfma_f32_32x32x16_bf16 v[64:79], v[192:195], v[176:179], v[64:79]
  ds_read_b64_tr_b16 v[192:193], v216 offset:12288
  ds_read_b64_tr_b16 v[194:195], v216 offset:14336
  v_fma_f32 v190, v190, s42, v224
  v_exp_f32 v188, v188
  v_add_f32 v231, v231, v186
  v_mfma_f32_32x32x16_bf16 v[16:31], v[196:199], v[160:163], v[16:31]
  v_cvt_pk_bf16_f32 v184, v184, v185
  v_fma_f32 v128, v128, s42, v223
  v_fma_f32 v191, v191, s42, v224
  v_exp_f32 v189, v189
  v_add_f32 v232, v232, v187
  v_mfma_f32_32x32x16_bf16 v[80:95], v[196:199], v[176:179], v[80:95]
  ds_read_b64_tr_b16 v[196:197], v217 offset:12288
  ds_read_b64_tr_b16 v[198:199], v217 offset:14336
  v_exp_f32 v190, v190
  v_fma_f32 v129, v129, s42, v223
  s_waitcnt lgkmcnt(4)
  v_mfma_f32_32x32x16_bf16 v[32:47], v[200:203], v[160:163], v[32:47]
  v_add_f32 v231, v231, v188
  v_cvt_pk_bf16_f32 v185, v186, v187
  v_exp_f32 v191, v191
  v_add_f32 v232, v232, v189
  v_add_f32 v231, v231, v190
  v_mfma_f32_32x32x16_bf16 v[96:111], v[200:203], v[176:179], v[96:111]
  ds_read_b64_tr_b16 v[200:201], v218 offset:12288
  ds_read_b64_tr_b16 v[202:203], v218 offset:14336
  v_cvt_pk_bf16_f32 v186, v188, v189
  v_fma_f32 v130, v130, s42, v223
  v_add_f32 v232, v232, v191
  v_cvt_pk_bf16_f32 v187, v190, v191
  v_mfma_f32_32x32x16_bf16 v[48:63], v[204:207], v[160:163], v[48:63]
  v_exp_f32 v128, v128
  v_fma_f32 v131, v131, s42, v223
  v_exp_f32 v129, v129
  v_mfma_f32_32x32x16_bf16 v[112:127], v[204:207], v[176:179], v[112:127]
  ds_read_b64_tr_b16 v[204:205], v219 offset:12288
  ds_read_b64_tr_b16 v[206:207], v219 offset:14336
  v_fma_f32 v132, v132, s42, v223
  v_exp_f32 v130, v130
  s_waitcnt lgkmcnt(4)
  v_mfma_f32_32x32x16_bf16 v[0:15], v[192:195], v[168:171], v[0:15]
  buffer_store_dwordx4 a[204:207], v249, s[32:35], s52 offen offset:64 sc1
  v_add_f32 v229, v229, v128
  v_fma_f32 v133, v133, s42, v223
  v_exp_f32 v131, v131
  v_add_f32 v230, v230, v129
  v_mfma_f32_32x32x16_bf16 v[64:79], v[192:195], v[184:187], v[64:79]
  ds_read_b128 v[192:195], v208 offset:24576
  v_fma_f32 v134, v134, s42, v223
  v_exp_f32 v132, v132
  v_add_f32 v229, v229, v130
  v_cvt_pk_bf16_f32 v128, v128, v129
  v_mfma_f32_32x32x16_bf16 v[16:31], v[196:199], v[168:171], v[16:31]
  v_fma_f32 v135, v135, s42, v223
  v_exp_f32 v133, v133
  v_add_f32 v230, v230, v131
  v_fma_f32 v144, v144, s42, v224
  v_mfma_f32_32x32x16_bf16 v[80:95], v[196:199], v[184:187], v[80:95]
  ds_read_b128 v[196:199], v209 offset:24576
  v_exp_f32 v134, v134
  v_add_f32 v229, v229, v132
  v_cvt_pk_bf16_f32 v129, v130, v131
  s_waitcnt lgkmcnt(2)
  v_mfma_f32_32x32x16_bf16 v[32:47], v[200:203], v[168:171], v[32:47]
  v_fma_f32 v145, v145, s42, v224
  v_exp_f32 v135, v135
  v_add_f32 v230, v230, v133
  v_fma_f32 v146, v146, s42, v224
  v_mfma_f32_32x32x16_bf16 v[96:111], v[200:203], v[184:187], v[96:111]
  ds_read_b128 v[200:203], v210 offset:24576
  v_exp_f32 v144, v144
  v_add_f32 v229, v229, v134
  v_cvt_pk_bf16_f32 v130, v132, v133
  v_fma_f32 v147, v147, s42, v224
  v_mfma_f32_32x32x16_bf16 v[48:63], v[204:207], v[168:171], v[48:63]
  v_exp_f32 v145, v145
  v_add_f32 v230, v230, v135
  v_fma_f32 v148, v148, s42, v224
  v_exp_f32 v146, v146
  v_mfma_f32_32x32x16_bf16 v[112:127], v[204:207], v[184:187], v[112:127]
  ds_read_b128 v[204:207], v211 offset:24576
  v_add_f32 v231, v231, v144
  v_cvt_pk_bf16_f32 v131, v134, v135
  v_fma_f32 v149, v149, s42, v224
  s_waitcnt lgkmcnt(2)
  v_mfma_f32_32x32x16_bf16 v[160:175], v[192:195], a[128:131], 0
  v_exp_f32 v147, v147
  v_add_f32 v232, v232, v145
  v_fma_f32 v150, v150, s42, v224
  v_exp_f32 v148, v148
  v_mfma_f32_32x32x16_bf16 v[176:191], v[192:195], a[160:163], 0
  ds_read_b128 v[192:195], v212 offset:24576
  v_add_f32 v231, v231, v146
  v_cvt_pk_bf16_f32 v144, v144, v145
  v_fma_f32 v151, v151, s42, v224
  v_exp_f32 v149, v149
  v_mfma_f32_32x32x16_bf16 v[160:175], v[196:199], a[132:135], v[160:175]
  buffer_store_dwordx4 a[208:211], v249, s[32:35], s46 offen offset:128 sc1
  v_add_f32 v232, v232, v147
  v_fma_f32 v136, v136, s42, v223
  v_exp_f32 v150, v150
  v_mfma_f32_32x32x16_bf16 v[176:191], v[196:199], a[164:167], v[176:191]
  ds_read_b128 v[196:199], v213 offset:24576
  v_add_f32 v231, v231, v148
  v_cvt_pk_bf16_f32 v145, v146, v147
  v_fma_f32 v137, v137, s42, v223
  v_exp_f32 v151, v151
  s_waitcnt lgkmcnt(2)
  v_mfma_f32_32x32x16_bf16 v[160:175], v[200:203], a[136:139], v[160:175]
  v_add_f32 v232, v232, v149
  v_fma_f32 v138, v138, s42, v223
  v_exp_f32 v136, v136
  v_add_f32 v231, v231, v150
  v_mfma_f32_32x32x16_bf16 v[176:191], v[200:203], a[168:171], v[176:191]
  ds_read_b128 v[200:203], v214 offset:24576
  v_cvt_pk_bf16_f32 v146, v148, v149
  v_fma_f32 v139, v139, s42, v223
  v_exp_f32 v137, v137
  v_mfma_f32_32x32x16_bf16 v[160:175], v[204:207], a[140:143], v[160:175]
  v_add_f32 v232, v232, v151
  v_fma_f32 v140, v140, s42, v223
  v_exp_f32 v138, v138
  v_add_f32 v229, v229, v136
  v_cvt_pk_bf16_f32 v147, v150, v151
  v_mfma_f32_32x32x16_bf16 v[176:191], v[204:207], a[172:175], v[176:191]
  ds_read_b128 v[204:207], v215 offset:24576
  v_fma_f32 v141, v141, s42, v223
  v_exp_f32 v139, v139
  s_waitcnt lgkmcnt(2)
  v_mfma_f32_32x32x16_bf16 v[160:175], v[192:195], a[144:147], v[160:175]
  v_add_f32 v230, v230, v137
  v_fma_f32 v142, v142, s42, v223
  v_exp_f32 v140, v140
  v_add_f32 v229, v229, v138
  v_cvt_pk_bf16_f32 v136, v136, v137
  v_mfma_f32_32x32x16_bf16 v[176:191], v[192:195], a[176:179], v[176:191]
  ds_read_b64_tr_b16 v[192:193], v216 offset:16384
  ds_read_b64_tr_b16 v[194:195], v216 offset:18432
  v_fma_f32 v143, v143, s42, v223
  v_exp_f32 v141, v141
  v_mfma_f32_32x32x16_bf16 v[160:175], v[196:199], a[148:151], v[160:175]
  v_add_f32 v230, v230, v139
  v_fma_f32 v152, v152, s42, v224
  v_exp_f32 v142, v142
  v_add_f32 v229, v229, v140
  v_mfma_f32_32x32x16_bf16 v[176:191], v[196:199], a[180:183], v[176:191]
  ds_read_b64_tr_b16 v[196:197], v217 offset:16384
  ds_read_b64_tr_b16 v[198:199], v217 offset:18432
  v_cvt_pk_bf16_f32 v137, v138, v139
  v_fma_f32 v153, v153, s42, v224
  s_waitcnt lgkmcnt(4)
  v_mfma_f32_32x32x16_bf16 v[160:175], v[200:203], a[152:155], v[160:175]
  buffer_store_dwordx4 a[216:219], v249, s[32:35], s46 offen offset:192 sc1
  v_exp_f32 v143, v143
  v_add_f32 v230, v230, v141
  v_fma_f32 v154, v154, s42, v224
  v_exp_f32 v152, v152
  v_mfma_f32_32x32x16_bf16 v[176:191], v[200:203], a[184:187], v[176:191]
  ds_read_b64_tr_b16 v[200:201], v218 offset:16384
  ds_read_b64_tr_b16 v[202:203], v218 offset:18432
  v_add_f32 v229, v229, v142
  v_cvt_pk_bf16_f32 v138, v140, v141
  v_mfma_f32_32x32x16_bf16 v[160:175], v[204:207], a[156:159], v[160:175]
  v_fma_f32 v155, v155, s42, v224
  v_exp_f32 v153, v153
  v_add_f32 v230, v230, v143
  v_fma_f32 v156, v156, s42, v224
  v_mfma_f32_32x32x16_bf16 v[176:191], v[204:207], a[188:191], v[176:191]
  ds_read_b64_tr_b16 v[204:205], v219 offset:16384
  ds_read_b64_tr_b16 v[206:207], v219 offset:18432
  v_exp_f32 v154, v154
  v_add_f32 v231, v231, v152
  s_waitcnt lgkmcnt(4)
  v_mfma_f32_32x32x16_bf16 v[0:15], v[192:195], v[128:131], v[0:15]
  v_cvt_pk_bf16_f32 v139, v142, v143
  v_fma_f32 v157, v157, s42, v224
  v_exp_f32 v155, v155
  v_add_f32 v232, v232, v153
  v_mfma_f32_32x32x16_bf16 v[64:79], v[192:195], v[144:147], v[64:79]
  ds_read_b64_tr_b16 v[192:193], v216 offset:20480
  ds_read_b64_tr_b16 v[194:195], v216 offset:22528
  v_fma_f32 v158, v158, s42, v224
  v_exp_f32 v156, v156
  v_add_f32 v231, v231, v154
  v_mfma_f32_32x32x16_bf16 v[16:31], v[196:199], v[128:131], v[16:31]
  v_cvt_pk_bf16_f32 v152, v152, v153
  v_fma_f32 v160, v160, s42, v223
  v_fma_f32 v159, v159, s42, v224
  v_exp_f32 v157, v157
  v_add_f32 v232, v232, v155
  v_mfma_f32_32x32x16_bf16 v[80:95], v[196:199], v[144:147], v[80:95]
  ds_read_b64_tr_b16 v[196:197], v217 offset:20480
  ds_read_b64_tr_b16 v[198:199], v217 offset:22528
  v_exp_f32 v158, v158
  v_fma_f32 v161, v161, s42, v223
  s_waitcnt lgkmcnt(4)
  v_mfma_f32_32x32x16_bf16 v[32:47], v[200:203], v[128:131], v[32:47]
  v_add_f32 v231, v231, v156
  v_cvt_pk_bf16_f32 v153, v154, v155
  v_exp_f32 v159, v159
  v_add_f32 v232, v232, v157
  v_add_f32 v231, v231, v158
  v_mfma_f32_32x32x16_bf16 v[96:111], v[200:203], v[144:147], v[96:111]
  ds_read_b64_tr_b16 v[200:201], v218 offset:20480
  ds_read_b64_tr_b16 v[202:203], v218 offset:22528
  v_cvt_pk_bf16_f32 v154, v156, v157
  v_fma_f32 v162, v162, s42, v223
  v_add_f32 v232, v232, v159
  v_cvt_pk_bf16_f32 v155, v158, v159
  v_mfma_f32_32x32x16_bf16 v[48:63], v[204:207], v[128:131], v[48:63]
  buffer_store_dwordx4 a[212:215], v249, s[32:35], s52 offen offset:128 sc1
  v_exp_f32 v160, v160
  v_fma_f32 v163, v163, s42, v223
  v_exp_f32 v161, v161
  v_mfma_f32_32x32x16_bf16 v[112:127], v[204:207], v[144:147], v[112:127]
  ds_read_b64_tr_b16 v[204:205], v219 offset:20480
  ds_read_b64_tr_b16 v[206:207], v219 offset:22528
  v_fma_f32 v164, v164, s42, v223
  v_exp_f32 v162, v162
  s_waitcnt lgkmcnt(4)
  v_mfma_f32_32x32x16_bf16 v[0:15], v[192:195], v[136:139], v[0:15]
  v_add_f32 v229, v229, v160
  v_fma_f32 v165, v165, s42, v223
  v_exp_f32 v163, v163
  s_waitcnt vmcnt(7)
  s_barrier
  v_mfma_f32_32x32x16_bf16 v[64:79], v[192:195], v[152:155], v[64:79]
  ds_read_b128 v[192:195], v208 offset:32768
  v_add_f32 v230, v230, v161
  v_fma_f32 v166, v166, s42, v223
  v_exp_f32 v164, v164
  v_mfma_f32_32x32x16_bf16 v[16:31], v[196:199], v[136:139], v[16:31]
  v_add_f32 v229, v229, v162
  v_cvt_pk_bf16_f32 v160, v160, v161
  v_fma_f32 v167, v167, s42, v223
  v_exp_f32 v165, v165
  v_add_f32 v230, v230, v163
  v_mfma_f32_32x32x16_bf16 v[80:95], v[196:199], v[152:155], v[80:95]
  ds_read_b128 v[196:199], v209 offset:32768
  v_fma_f32 v176, v176, s42, v224
  v_exp_f32 v166, v166
  v_add_f32 v229, v229, v164
  s_waitcnt lgkmcnt(2)
  v_mfma_f32_32x32x16_bf16 v[32:47], v[200:203], v[136:139], v[32:47]
  v_cvt_pk_bf16_f32 v161, v162, v163
  v_fma_f32 v177, v177, s42, v224
  v_exp_f32 v167, v167
  v_add_f32 v230, v230, v165
  v_mfma_f32_32x32x16_bf16 v[96:111], v[200:203], v[152:155], v[96:111]
  ds_read_b128 v[200:203], v210 offset:32768
  v_fma_f32 v178, v178, s42, v224
  v_exp_f32 v176, v176
  v_add_f32 v229, v229, v166
  v_cvt_pk_bf16_f32 v162, v164, v165
  v_mfma_f32_32x32x16_bf16 v[48:63], v[204:207], v[136:139], v[48:63]
  v_fma_f32 v179, v179, s42, v224
  v_exp_f32 v177, v177
  v_add_f32 v230, v230, v167
  v_fma_f32 v180, v180, s42, v224
  v_mfma_f32_32x32x16_bf16 v[112:127], v[204:207], v[152:155], v[112:127]
  ds_read_b128 v[204:207], v211 offset:32768
  v_exp_f32 v178, v178
  v_add_f32 v231, v231, v176
  v_cvt_pk_bf16_f32 v163, v166, v167
  v_fma_f32 v181, v181, s42, v224
  s_waitcnt lgkmcnt(2)
  v_mfma_f32_32x32x16_bf16 v[128:143], v[192:195], a[128:131], 0
  buffer_store_dwordx4 a[220:223], v249, s[32:35], s52 offen offset:192 sc1
  v_exp_f32 v179, v179
  v_add_f32 v232, v232, v177
  v_fma_f32 v182, v182, s42, v224
  v_mfma_f32_32x32x16_bf16 v[144:159], v[192:195], a[160:163], 0
  ds_read_b128 v[192:195], v212 offset:32768
  v_exp_f32 v180, v180
  v_add_f32 v231, v231, v178
  v_cvt_pk_bf16_f32 v176, v176, v177
  v_fma_f32 v183, v183, s42, v224
  v_mfma_f32_32x32x16_bf16 v[128:143], v[196:199], a[132:135], v[128:143]
  v_exp_f32 v181, v181
  v_add_f32 v232, v232, v179
  v_fma_f32 v168, v168, s42, v223
  v_exp_f32 v182, v182
  v_mfma_f32_32x32x16_bf16 v[144:159], v[196:199], a[164:167], v[144:159]
  ds_read_b128 v[196:199], v213 offset:32768
  v_add_f32 v231, v231, v180
  v_cvt_pk_bf16_f32 v177, v178, v179
  v_fma_f32 v169, v169, s42, v223
  s_waitcnt lgkmcnt(2)
  v_mfma_f32_32x32x16_bf16 v[128:143], v[200:203], a[136:139], v[128:143]
  v_exp_f32 v183, v183
  v_add_f32 v232, v232, v181
  v_fma_f32 v170, v170, s42, v223
  v_exp_f32 v168, v168
  v_add_f32 v231, v231, v182
  v_mfma_f32_32x32x16_bf16 v[144:159], v[200:203], a[168:171], v[144:159]
  ds_read_b128 v[200:203], v214 offset:32768
  v_cvt_pk_bf16_f32 v178, v180, v181
  v_fma_f32 v171, v171, s42, v223
  v_exp_f32 v169, v169
  v_mfma_f32_32x32x16_bf16 v[128:143], v[204:207], a[140:143], v[128:143]
  v_add_f32 v232, v232, v183
  v_fma_f32 v172, v172, s42, v223
  v_exp_f32 v170, v170
  v_add_f32 v229, v229, v168
  v_cvt_pk_bf16_f32 v179, v182, v183
  v_mfma_f32_32x32x16_bf16 v[144:159], v[204:207], a[172:175], v[144:159]
  ds_read_b128 v[204:207], v215 offset:32768
  v_fma_f32 v173, v173, s42, v223
  v_exp_f32 v171, v171
  s_waitcnt lgkmcnt(2)
  v_mfma_f32_32x32x16_bf16 v[128:143], v[192:195], a[144:147], v[128:143]
  v_add_f32 v230, v230, v169
  v_fma_f32 v174, v174, s42, v223
  v_exp_f32 v172, v172
  v_add_f32 v229, v229, v170
  v_cvt_pk_bf16_f32 v168, v168, v169
  v_mfma_f32_32x32x16_bf16 v[144:159], v[192:195], a[176:179], v[144:159]
  ds_read_b64_tr_b16 v[192:193], v216 offset:24576
  ds_read_b64_tr_b16 v[194:195], v216 offset:26624
  v_fma_f32 v175, v175, s42, v223
  v_exp_f32 v173, v173
  v_mfma_f32_32x32x16_bf16 v[128:143], v[196:199], a[148:151], v[128:143]
  v_add_f32 v230, v230, v171
  v_fma_f32 v184, v184, s42, v224
  v_exp_f32 v174, v174
  v_add_f32 v229, v229, v172
  v_mfma_f32_32x32x16_bf16 v[144:159], v[196:199], a[180:183], v[144:159]
  ds_read_b64_tr_b16 v[196:197], v217 offset:24576
  ds_read_b64_tr_b16 v[198:199], v217 offset:26624
  v_cvt_pk_bf16_f32 v169, v170, v171
  v_fma_f32 v185, v185, s42, v224
  v_exp_f32 v175, v175
  s_waitcnt lgkmcnt(4)
  v_mfma_f32_32x32x16_bf16 v[128:143], v[200:203], a[152:155], v[128:143]
  v_add_f32 v230, v230, v173
  v_fma_f32 v186, v186, s42, v224
  v_exp_f32 v184, v184
  v_mfma_f32_32x32x16_bf16 v[144:159], v[200:203], a[184:187], v[144:159]
  ds_read_b64_tr_b16 v[200:201], v218 offset:24576
  ds_read_b64_tr_b16 v[202:203], v218 offset:26624
  v_add_f32 v229, v229, v174
  v_cvt_pk_bf16_f32 v170, v172, v173
  v_fma_f32 v187, v187, s42, v224
  v_mfma_f32_32x32x16_bf16 v[128:143], v[204:207], a[156:159], v[128:143]
  buffer_load_dwordx4 a[192:195], v249, s[20:23], s49 offen offset:0 nt
  buffer_load_dwordx4 a[200:203], v249, s[20:23], s49 offen offset:64 nt
  v_exp_f32 v185, v185
  v_add_f32 v230, v230, v175
  v_fma_f32 v188, v188, s42, v224
  v_mfma_f32_32x32x16_bf16 v[144:159], v[204:207], a[188:191], v[144:159]
  ds_read_b64_tr_b16 v[204:205], v219 offset:24576
  ds_read_b64_tr_b16 v[206:207], v219 offset:26624
  v_exp_f32 v186, v186
  v_add_f32 v231, v231, v184
  s_waitcnt lgkmcnt(4)
  v_mfma_f32_32x32x16_bf16 v[0:15], v[192:195], v[160:163], v[0:15]
  v_cvt_pk_bf16_f32 v171, v174, v175
  v_fma_f32 v189, v189, s42, v224
  v_exp_f32 v187, v187
  v_add_f32 v232, v232, v185
  v_mfma_f32_32x32x16_bf16 v[64:79], v[192:195], v[176:179], v[64:79]
  ds_read_b64_tr_b16 v[192:193], v216 offset:28672
  ds_read_b64_tr_b16 v[194:195], v216 offset:30720
  v_fma_f32 v190, v190, s42, v224
  v_fma_f32 v128, v128, s42, v223
  v_exp_f32 v188, v188
  v_mfma_f32_32x32x16_bf16 v[16:31], v[196:199], v[160:163], v[16:31]
  v_add_f32 v231, v231, v186
  v_cvt_pk_bf16_f32 v184, v184, v185
  v_fma_f32 v191, v191, s42, v224
  v_exp_f32 v189, v189
  v_add_f32 v232, v232, v187
  v_mfma_f32_32x32x16_bf16 v[80:95], v[196:199], v[176:179], v[80:95]
  ds_read_b64_tr_b16 v[196:197], v217 offset:28672
  ds_read_b64_tr_b16 v[198:199], v217 offset:30720
  v_exp_f32 v190, v190
  v_fma_f32 v129, v129, s42, v223
  s_waitcnt lgkmcnt(4)
  v_mfma_f32_32x32x16_bf16 v[32:47], v[200:203], v[160:163], v[32:47]
  v_add_f32 v231, v231, v188
  v_cvt_pk_bf16_f32 v185, v186, v187
  v_exp_f32 v191, v191
  v_add_f32 v232, v232, v189
  v_add_f32 v231, v231, v190
  v_mfma_f32_32x32x16_bf16 v[96:111], v[200:203], v[176:179], v[96:111]
  ds_read_b64_tr_b16 v[200:201], v218 offset:28672
  ds_read_b64_tr_b16 v[202:203], v218 offset:30720
  v_cvt_pk_bf16_f32 v186, v188, v189
  v_fma_f32 v130, v130, s42, v223
  v_add_f32 v232, v232, v191
  v_cvt_pk_bf16_f32 v187, v190, v191
  v_mfma_f32_32x32x16_bf16 v[48:63], v[204:207], v[160:163], v[48:63]
  v_exp_f32 v128, v128
  v_fma_f32 v131, v131, s42, v223
  v_exp_f32 v129, v129
  v_mfma_f32_32x32x16_bf16 v[112:127], v[204:207], v[176:179], v[112:127]
  ds_read_b64_tr_b16 v[204:205], v219 offset:28672
  ds_read_b64_tr_b16 v[206:207], v219 offset:30720
  v_fma_f32 v132, v132, s42, v223
  v_exp_f32 v130, v130
  s_waitcnt lgkmcnt(4)
  v_mfma_f32_32x32x16_bf16 v[0:15], v[192:195], v[168:171], v[0:15]
  v_add_f32 v229, v229, v128
  v_fma_f32 v133, v133, s42, v223
  v_exp_f32 v131, v131
  v_add_f32 v230, v230, v129
  v_fma_f32 v134, v134, s42, v223
  v_mfma_f32_32x32x16_bf16 v[64:79], v[192:195], v[184:187], v[64:79]
  ds_read_b128 v[192:195], v208 offset:40960
  v_exp_f32 v132, v132
  v_add_f32 v229, v229, v130
  v_cvt_pk_bf16_f32 v128, v128, v129
  v_mfma_f32_32x32x16_bf16 v[16:31], v[196:199], v[168:171], v[16:31]
  v_fma_f32 v135, v135, s42, v223
  v_exp_f32 v133, v133
  v_add_f32 v230, v230, v131
  v_fma_f32 v144, v144, s42, v224
  v_exp_f32 v134, v134
  v_mfma_f32_32x32x16_bf16 v[80:95], v[196:199], v[184:187], v[80:95]
  ds_read_b128 v[196:199], v209 offset:40960
  v_add_f32 v229, v229, v132
  v_cvt_pk_bf16_f32 v129, v130, v131
  v_fma_f32 v145, v145, s42, v224
  s_waitcnt lgkmcnt(2)
  v_mfma_f32_32x32x16_bf16 v[32:47], v[200:203], v[168:171], v[32:47]
  v_exp_f32 v135, v135
  v_add_f32 v230, v230, v133
  v_fma_f32 v146, v146, s42, v224
  v_exp_f32 v144, v144
  v_mfma_f32_32x32x16_bf16 v[96:111], v[200:203], v[184:187], v[96:111]
  ds_read_b128 v[200:203], v210 offset:40960
  v_add_f32 v229, v229, v134
  v_cvt_pk_bf16_f32 v130, v132, v133
  v_fma_f32 v147, v147, s42, v224
  v_exp_f32 v145, v145
  v_mfma_f32_32x32x16_bf16 v[48:63], v[204:207], v[168:171], v[48:63]
  v_add_f32 v230, v230, v135
  v_fma_f32 v148, v148, s42, v224
  v_exp_f32 v146, v146
  v_add_f32 v231, v231, v144
  v_mfma_f32_32x32x16_bf16 v[112:127], v[204:207], v[184:187], v[112:127]
  ds_read_b128 v[204:207], v211 offset:40960
  v_cvt_pk_bf16_f32 v131, v134, v135
  v_fma_f32 v149, v149, s42, v224
  v_exp_f32 v147, v147
  s_waitcnt lgkmcnt(2)
  v_mfma_f32_32x32x16_bf16 v[160:175], v[192:195], a[128:131], 0
  v_add_f32 v232, v232, v145
  v_fma_f32 v150, v150, s42, v224
  v_exp_f32 v148, v148
  v_add_f32 v231, v231, v146
  v_mfma_f32_32x32x16_bf16 v[176:191], v[192:195], a[160:163], 0
  ds_read_b128 v[192:195], v212 offset:40960
  v_cvt_pk_bf16_f32 v144, v144, v145
  v_fma_f32 v151, v151, s42, v224
  v_exp_f32 v149, v149
  v_add_f32 v232, v232, v147
  v_mfma_f32_32x32x16_bf16 v[160:175], v[196:199], a[132:135], v[160:175]
  buffer_load_dwordx4 a[224:227], v249, s[20:23], s50 offen offset:0 nt
  buffer_load_dwordx4 a[232:235], v249, s[20:23], s50 offen offset:64 nt
  v_fma_f32 v136, v136, s42, v223
  v_exp_f32 v150, v150
  v_mfma_f32_32x32x16_bf16 v[176:191], v[196:199], a[164:167], v[176:191]
  ds_read_b128 v[196:199], v213 offset:40960
  v_add_f32 v231, v231, v148
  v_cvt_pk_bf16_f32 v145, v146, v147
  v_fma_f32 v137, v137, s42, v223
  v_exp_f32 v151, v151
  s_waitcnt lgkmcnt(2)
  v_mfma_f32_32x32x16_bf16 v[160:175], v[200:203], a[136:139], v[160:175]
  v_add_f32 v232, v232, v149
  v_fma_f32 v138, v138, s42, v223
  v_exp_f32 v136, v136
  v_add_f32 v231, v231, v150
  v_mfma_f32_32x32x16_bf16 v[176:191], v[200:203], a[168:171], v[176:191]
  ds_read_b128 v[200:203], v214 offset:40960
  v_cvt_pk_bf16_f32 v146, v148, v149
  v_fma_f32 v139, v139, s42, v223
  v_exp_f32 v137, v137
  v_mfma_f32_32x32x16_bf16 v[160:175], v[204:207], a[140:143], v[160:175]
  v_add_f32 v232, v232, v151
  v_fma_f32 v140, v140, s42, v223
  v_exp_f32 v138, v138
  v_add_f32 v229, v229, v136
  v_cvt_pk_bf16_f32 v147, v150, v151
  v_mfma_f32_32x32x16_bf16 v[176:191], v[204:207], a[172:175], v[176:191]
  ds_read_b128 v[204:207], v215 offset:40960
  v_fma_f32 v141, v141, s42, v223
  v_exp_f32 v139, v139
  s_waitcnt lgkmcnt(2)
  v_mfma_f32_32x32x16_bf16 v[160:175], v[192:195], a[144:147], v[160:175]
  v_add_f32 v230, v230, v137
  v_fma_f32 v142, v142, s42, v223
  v_exp_f32 v140, v140
  v_add_f32 v229, v229, v138
  v_mfma_f32_32x32x16_bf16 v[176:191], v[192:195], a[176:179], v[176:191]
  ds_read_b64_tr_b16 v[192:193], v216 offset:32768
  ds_read_b64_tr_b16 v[194:195], v216 offset:34816
  v_cvt_pk_bf16_f32 v136, v136, v137
  v_fma_f32 v143, v143, s42, v223
  v_exp_f32 v141, v141
  v_mfma_f32_32x32x16_bf16 v[160:175], v[196:199], a[148:151], v[160:175]
  v_add_f32 v230, v230, v139
  v_fma_f32 v152, v152, s42, v224
  v_exp_f32 v142, v142
  v_add_f32 v229, v229, v140
  v_mfma_f32_32x32x16_bf16 v[176:191], v[196:199], a[180:183], v[176:191]
  ds_read_b64_tr_b16 v[196:197], v217 offset:32768
  ds_read_b64_tr_b16 v[198:199], v217 offset:34816
  v_cvt_pk_bf16_f32 v137, v138, v139
  v_fma_f32 v153, v153, s42, v224
  s_waitcnt lgkmcnt(4)
  v_mfma_f32_32x32x16_bf16 v[160:175], v[200:203], a[152:155], v[160:175]
  v_exp_f32 v143, v143
  v_add_f32 v230, v230, v141
  v_fma_f32 v154, v154, s42, v224
  v_exp_f32 v152, v152
  v_mfma_f32_32x32x16_bf16 v[176:191], v[200:203], a[184:187], v[176:191]
  ds_read_b64_tr_b16 v[200:201], v218 offset:32768
  ds_read_b64_tr_b16 v[202:203], v218 offset:34816
  v_add_f32 v229, v229, v142
  v_cvt_pk_bf16_f32 v138, v140, v141
  v_fma_f32 v155, v155, s42, v224
  v_mfma_f32_32x32x16_bf16 v[160:175], v[204:207], a[156:159], v[160:175]
  v_exp_f32 v153, v153
  v_add_f32 v230, v230, v143
  v_fma_f32 v156, v156, s42, v224
  v_mfma_f32_32x32x16_bf16 v[176:191], v[204:207], a[188:191], v[176:191]
  ds_read_b64_tr_b16 v[204:205], v219 offset:32768
  ds_read_b64_tr_b16 v[206:207], v219 offset:34816
  v_exp_f32 v154, v154
  v_add_f32 v231, v231, v152
  s_waitcnt lgkmcnt(4)
  v_mfma_f32_32x32x16_bf16 v[0:15], v[192:195], v[128:131], v[0:15]
  v_cvt_pk_bf16_f32 v139, v142, v143
  v_fma_f32 v157, v157, s42, v224
  v_exp_f32 v155, v155
  v_add_f32 v232, v232, v153
  v_fma_f32 v158, v158, s42, v224
  v_mfma_f32_32x32x16_bf16 v[64:79], v[192:195], v[144:147], v[64:79]
  ds_read_b64_tr_b16 v[192:193], v216 offset:36864
  ds_read_b64_tr_b16 v[194:195], v216 offset:38912
  v_exp_f32 v156, v156
  v_fma_f32 v160, v160, s42, v223
  v_add_f32 v231, v231, v154
  v_mfma_f32_32x32x16_bf16 v[16:31], v[196:199], v[128:131], v[16:31]
  v_cvt_pk_bf16_f32 v152, v152, v153
  v_fma_f32 v161, v161, s42, v223
  v_fma_f32 v159, v159, s42, v224
  v_exp_f32 v157, v157
  v_add_f32 v232, v232, v155
  v_mfma_f32_32x32x16_bf16 v[80:95], v[196:199], v[144:147], v[80:95]
  ds_read_b64_tr_b16 v[196:197], v217 offset:36864
  ds_read_b64_tr_b16 v[198:199], v217 offset:38912
  v_exp_f32 v158, v158
  v_add_f32 v231, v231, v156
  s_waitcnt lgkmcnt(4)
  v_mfma_f32_32x32x16_bf16 v[32:47], v[200:203], v[128:131], v[32:47]
  v_cvt_pk_bf16_f32 v153, v154, v155
  v_fma_f32 v162, v162, s42, v223
  v_exp_f32 v159, v159
  v_add_f32 v232, v232, v157
  v_add_f32 v231, v231, v158
  v_mfma_f32_32x32x16_bf16 v[96:111], v[200:203], v[144:147], v[96:111]
  ds_read_b64_tr_b16 v[200:201], v218 offset:36864
  ds_read_b64_tr_b16 v[202:203], v218 offset:38912
  v_cvt_pk_bf16_f32 v154, v156, v157
  v_exp_f32 v160, v160
  v_add_f32 v232, v232, v159
  v_cvt_pk_bf16_f32 v155, v158, v159
  v_mfma_f32_32x32x16_bf16 v[48:63], v[204:207], v[128:131], v[48:63]
  buffer_load_dwordx4 a[196:199], v249, s[20:23], s55 offen offset:0 nt
  buffer_load_dwordx4 a[204:207], v249, s[20:23], s55 offen offset:64 nt
  v_fma_f32 v163, v163, s42, v223
  v_exp_f32 v161, v161
  v_mfma_f32_32x32x16_bf16 v[112:127], v[204:207], v[144:147], v[112:127]
  ds_read_b64_tr_b16 v[204:205], v219 offset:36864
  ds_read_b64_tr_b16 v[206:207], v219 offset:38912
  v_fma_f32 v164, v164, s42, v223
  v_exp_f32 v162, v162
  s_waitcnt lgkmcnt(4)
  v_mfma_f32_32x32x16_bf16 v[0:15], v[192:195], v[136:139], v[0:15]
  v_add_f32 v229, v229, v160
  v_fma_f32 v165, v165, s42, v223
  v_exp_f32 v163, v163
  v_add_f32 v230, v230, v161
  s_barrier
  v_mfma_f32_32x32x16_bf16 v[64:79], v[192:195], v[152:155], v[64:79]
  ds_read_b128 v[192:195], v208 offset:49152
  v_fma_f32 v166, v166, s42, v223
  v_exp_f32 v164, v164
  v_add_f32 v229, v229, v162
  v_cvt_pk_bf16_f32 v160, v160, v161
  v_mfma_f32_32x32x16_bf16 v[16:31], v[196:199], v[136:139], v[16:31]
  s_add_u32 m0, s40, 32768
  s_add_u32 s41, s59, 0
  buffer_load_dwordx4 v253, s[24:27], s41 offen lds
  v_fma_f32 v167, v167, s42, v223
  v_exp_f32 v165, v165
  v_mfma_f32_32x32x16_bf16 v[80:95], v[196:199], v[152:155], v[80:95]
  ds_read_b128 v[196:199], v209 offset:49152
  v_add_f32 v230, v230, v163
  v_fma_f32 v176, v176, s42, v224
  v_exp_f32 v166, v166
  s_waitcnt lgkmcnt(2)
  v_mfma_f32_32x32x16_bf16 v[32:47], v[200:203], v[136:139], v[32:47]
  s_add_u32 m0, s40, 36864
  s_add_u32 s41, s59, 4096
  buffer_load_dwordx4 v253, s[24:27], s41 offen lds
  v_add_f32 v229, v229, v164
  v_cvt_pk_bf16_f32 v161, v162, v163
  v_fma_f32 v177, v177, s42, v224
  v_mfma_f32_32x32x16_bf16 v[96:111], v[200:203], v[152:155], v[96:111]
  ds_read_b128 v[200:203], v210 offset:49152
  v_exp_f32 v167, v167
  v_add_f32 v230, v230, v165
  v_fma_f32 v178, v178, s42, v224
  v_exp_f32 v176, v176
  v_mfma_f32_32x32x16_bf16 v[48:63], v[204:207], v[136:139], v[48:63]
  v_add_f32 v229, v229, v166
  v_cvt_pk_bf16_f32 v162, v164, v165
  v_fma_f32 v179, v179, s42, v224
  v_exp_f32 v177, v177
  v_mfma_f32_32x32x16_bf16 v[112:127], v[204:207], v[152:155], v[112:127]
  ds_read_b128 v[204:207], v211 offset:49152
  v_add_f32 v230, v230, v167
  v_fma_f32 v180, v180, s42, v224
  v_exp_f32 v178, v178
  s_waitcnt lgkmcnt(2)
  v_mfma_f32_32x32x16_bf16 v[128:143], v[192:195], a[128:131], 0
  v_add_f32 v231, v231, v176
  v_cvt_pk_bf16_f32 v163, v166, v167
  v_fma_f32 v181, v181, s42, v224
  v_exp_f32 v179, v179
  v_add_f32 v232, v232, v177
  v_mfma_f32_32x32x16_bf16 v[144:159], v[192:195], a[160:163], 0
  ds_read_b128 v[192:195], v212 offset:49152
  v_fma_f32 v182, v182, s42, v224
  v_exp_f32 v180, v180
  v_add_f32 v231, v231, v178
  v_cvt_pk_bf16_f32 v176, v176, v177
  v_mfma_f32_32x32x16_bf16 v[128:143], v[196:199], a[132:135], v[128:143]
  v_fma_f32 v183, v183, s42, v224
  v_exp_f32 v181, v181
  v_add_f32 v232, v232, v179
  v_fma_f32 v168, v168, s42, v223
  v_exp_f32 v182, v182
  v_mfma_f32_32x32x16_bf16 v[144:159], v[196:199], a[164:167], v[144:159]
  ds_read_b128 v[196:199], v213 offset:49152
  v_add_f32 v231, v231, v180
  v_cvt_pk_bf16_f32 v177, v178, v179
  v_fma_f32 v169, v169, s42, v223
  s_waitcnt lgkmcnt(2)
  v_mfma_f32_32x32x16_bf16 v[128:143], v[200:203], a[136:139], v[128:143]
  v_exp_f32 v183, v183
  v_add_f32 v232, v232, v181
  v_fma_f32 v170, v170, s42, v223
  v_exp_f32 v168, v168
  v_mfma_f32_32x32x16_bf16 v[144:159], v[200:203], a[168:171], v[144:159]
  ds_read_b128 v[200:203], v214 offset:49152
  v_add_f32 v231, v231, v182
  v_cvt_pk_bf16_f32 v178, v180, v181
  v_fma_f32 v171, v171, s42, v223
  v_exp_f32 v169, v169
  v_mfma_f32_32x32x16_bf16 v[128:143], v[204:207], a[140:143], v[128:143]
  v_add_f32 v232, v232, v183
  v_fma_f32 v172, v172, s42, v223
  v_exp_f32 v170, v170
  v_add_f32 v229, v229, v168
  v_cvt_pk_bf16_f32 v179, v182, v183
  v_mfma_f32_32x32x16_bf16 v[144:159], v[204:207], a[172:175], v[144:159]
  ds_read_b128 v[204:207], v215 offset:49152
  v_fma_f32 v173, v173, s42, v223
  v_exp_f32 v171, v171
  s_waitcnt lgkmcnt(2)
  v_mfma_f32_32x32x16_bf16 v[128:143], v[192:195], a[144:147], v[128:143]
  v_add_f32 v230, v230, v169
  v_fma_f32 v174, v174, s42, v223
  v_exp_f32 v172, v172
  v_add_f32 v229, v229, v170
  v_cvt_pk_bf16_f32 v168, v168, v169
  v_mfma_f32_32x32x16_bf16 v[144:159], v[192:195], a[176:179], v[144:159]
  ds_read_b64_tr_b16 v[192:193], v216 offset:40960
  ds_read_b64_tr_b16 v[194:195], v216 offset:43008
  v_fma_f32 v175, v175, s42, v223
  v_exp_f32 v173, v173
  v_mfma_f32_32x32x16_bf16 v[128:143], v[196:199], a[148:151], v[128:143]
  buffer_load_dwordx4 a[228:231], v249, s[20:23], s56 offen offset:0 nt
  buffer_load_dwordx4 a[236:239], v249, s[20:23], s56 offen offset:64 nt
  v_add_f32 v230, v230, v171
  v_fma_f32 v184, v184, s42, v224
  v_exp_f32 v174, v174
  v_mfma_f32_32x32x16_bf16 v[144:159], v[196:199], a[180:183], v[144:159]
  ds_read_b64_tr_b16 v[196:197], v217 offset:40960
  ds_read_b64_tr_b16 v[198:199], v217 offset:43008
  v_add_f32 v229, v229, v172
  v_cvt_pk_bf16_f32 v169, v170, v171
  s_waitcnt lgkmcnt(4)
  v_mfma_f32_32x32x16_bf16 v[128:143], v[200:203], a[152:155], v[128:143]
  v_fma_f32 v185, v185, s42, v224
  v_exp_f32 v175, v175
  v_add_f32 v230, v230, v173
  v_fma_f32 v186, v186, s42, v224
  v_mfma_f32_32x32x16_bf16 v[144:159], v[200:203], a[184:187], v[144:159]
  ds_read_b64_tr_b16 v[200:201], v218 offset:40960
  ds_read_b64_tr_b16 v[202:203], v218 offset:43008
  v_exp_f32 v184, v184
  v_add_f32 v229, v229, v174
  v_cvt_pk_bf16_f32 v170, v172, v173
  v_mfma_f32_32x32x16_bf16 v[128:143], v[204:207], a[156:159], v[128:143]
  v_fma_f32 v187, v187, s42, v224
  v_exp_f32 v185, v185
  v_add_f32 v230, v230, v175
  v_fma_f32 v188, v188, s42, v224
  v_mfma_f32_32x32x16_bf16 v[144:159], v[204:207], a[188:191], v[144:159]
  ds_read_b64_tr_b16 v[204:205], v219 offset:40960
  ds_read_b64_tr_b16 v[206:207], v219 offset:43008
  v_exp_f32 v186, v186
  v_add_f32 v231, v231, v184
  s_waitcnt lgkmcnt(4)
  v_mfma_f32_32x32x16_bf16 v[0:15], v[192:195], v[160:163], v[0:15]
  v_cvt_pk_bf16_f32 v171, v174, v175
  v_fma_f32 v189, v189, s42, v224
  v_exp_f32 v187, v187
  v_add_f32 v232, v232, v185
  v_mfma_f32_32x32x16_bf16 v[64:79], v[192:195], v[176:179], v[64:79]
  ds_read_b64_tr_b16 v[192:193], v216 offset:45056
  ds_read_b64_tr_b16 v[194:195], v216 offset:47104
  v_fma_f32 v190, v190, s42, v224
  v_fma_f32 v128, v128, s42, v223
  v_exp_f32 v188, v188
  v_mfma_f32_32x32x16_bf16 v[16:31], v[196:199], v[160:163], v[16:31]
  v_add_f32 v231, v231, v186
  v_cvt_pk_bf16_f32 v184, v184, v185
  v_fma_f32 v191, v191, s42, v224
  v_exp_f32 v189, v189
  v_add_f32 v232, v232, v187
  v_mfma_f32_32x32x16_bf16 v[80:95], v[196:199], v[176:179], v[80:95]
  ds_read_b64_tr_b16 v[196:197], v217 offset:45056
  ds_read_b64_tr_b16 v[198:199], v217 offset:47104
  v_exp_f32 v190, v190
  v_fma_f32 v129, v129, s42, v223
  s_waitcnt lgkmcnt(4)
  v_mfma_f32_32x32x16_bf16 v[32:47], v[200:203], v[160:163], v[32:47]
  v_add_f32 v231, v231, v188
  v_cvt_pk_bf16_f32 v185, v186, v187
  v_exp_f32 v191, v191
  v_add_f32 v232, v232, v189
  v_add_f32 v231, v231, v190
  v_mfma_f32_32x32x16_bf16 v[96:111], v[200:203], v[176:179], v[96:111]
  ds_read_b64_tr_b16 v[200:201], v218 offset:45056
  ds_read_b64_tr_b16 v[202:203], v218 offset:47104
  v_cvt_pk_bf16_f32 v186, v188, v189
  v_fma_f32 v130, v130, s42, v223
  v_add_f32 v232, v232, v191
  v_cvt_pk_bf16_f32 v187, v190, v191
  v_mfma_f32_32x32x16_bf16 v[48:63], v[204:207], v[160:163], v[48:63]
  v_exp_f32 v128, v128
  v_fma_f32 v131, v131, s42, v223
  v_exp_f32 v129, v129
  v_mfma_f32_32x32x16_bf16 v[112:127], v[204:207], v[176:179], v[112:127]
  ds_read_b64_tr_b16 v[204:205], v219 offset:45056
  ds_read_b64_tr_b16 v[206:207], v219 offset:47104
  v_fma_f32 v132, v132, s42, v223
  v_exp_f32 v130, v130
  s_waitcnt lgkmcnt(4)
  v_mfma_f32_32x32x16_bf16 v[0:15], v[192:195], v[168:171], v[0:15]
  v_add_f32 v229, v229, v128
  v_fma_f32 v133, v133, s42, v223
  v_exp_f32 v131, v131
  v_add_f32 v230, v230, v129
  v_fma_f32 v134, v134, s42, v223
  v_mfma_f32_32x32x16_bf16 v[64:79], v[192:195], v[184:187], v[64:79]
  ds_read_b128 v[192:195], v208 offset:57344
  v_exp_f32 v132, v132
  v_add_f32 v229, v229, v130
  v_cvt_pk_bf16_f32 v128, v128, v129
  v_mfma_f32_32x32x16_bf16 v[16:31], v[196:199], v[168:171], v[16:31]
  v_fma_f32 v135, v135, s42, v223
  v_exp_f32 v133, v133
  v_add_f32 v230, v230, v131
  v_fma_f32 v144, v144, s42, v224
  v_exp_f32 v134, v134
  v_mfma_f32_32x32x16_bf16 v[80:95], v[196:199], v[184:187], v[80:95]
  ds_read_b128 v[196:199], v209 offset:57344
  v_add_f32 v229, v229, v132
  v_cvt_pk_bf16_f32 v129, v130, v131
  v_fma_f32 v145, v145, s42, v224
  s_waitcnt lgkmcnt(2)
  v_mfma_f32_32x32x16_bf16 v[32:47], v[200:203], v[168:171], v[32:47]
  v_exp_f32 v135, v135
  v_add_f32 v230, v230, v133
  v_fma_f32 v146, v146, s42, v224
  v_exp_f32 v144, v144
  v_mfma_f32_32x32x16_bf16 v[96:111], v[200:203], v[184:187], v[96:111]
  ds_read_b128 v[200:203], v210 offset:57344
  v_add_f32 v229, v229, v134
  v_cvt_pk_bf16_f32 v130, v132, v133
  v_fma_f32 v147, v147, s42, v224
  v_exp_f32 v145, v145
  v_mfma_f32_32x32x16_bf16 v[48:63], v[204:207], v[168:171], v[48:63]
  buffer_load_dwordx4 a[208:211], v249, s[20:23], s49 offen offset:128 nt
  buffer_load_dwordx4 a[216:219], v249, s[20:23], s49 offen offset:192 nt
  v_add_f32 v230, v230, v135
  v_fma_f32 v148, v148, s42, v224
  v_mfma_f32_32x32x16_bf16 v[112:127], v[204:207], v[184:187], v[112:127]
  ds_read_b128 v[204:207], v211 offset:57344
  v_exp_f32 v146, v146
  v_add_f32 v231, v231, v144
  v_cvt_pk_bf16_f32 v131, v134, v135
  v_fma_f32 v149, v149, s42, v224
  s_waitcnt lgkmcnt(2)
  v_mfma_f32_32x32x16_bf16 v[160:175], v[192:195], a[128:131], 0
  v_exp_f32 v147, v147
  v_add_f32 v232, v232, v145
  v_fma_f32 v150, v150, s42, v224
  v_exp_f32 v148, v148
  v_mfma_f32_32x32x16_bf16 v[176:191], v[192:195], a[160:163], 0
  ds_read_b128 v[192:195], v212 offset:57344
  v_add_f32 v231, v231, v146
  v_cvt_pk_bf16_f32 v144, v144, v145
  v_fma_f32 v151, v151, s42, v224
  v_mfma_f32_32x32x16_bf16 v[160:175], v[196:199], a[132:135], v[160:175]
  v_exp_f32 v149, v149
  v_add_f32 v232, v232, v147
  v_fma_f32 v136, v136, s42, v223
  v_exp_f32 v150, v150
  v_mfma_f32_32x32x16_bf16 v[176:191], v[196:199], a[164:167], v[176:191]
  ds_read_b128 v[196:199], v213 offset:57344
  v_add_f32 v231, v231, v148
  v_cvt_pk_bf16_f32 v145, v146, v147
  v_fma_f32 v137, v137, s42, v223
  v_exp_f32 v151, v151
  s_waitcnt lgkmcnt(2)
  v_mfma_f32_32x32x16_bf16 v[160:175], v[200:203], a[136:139], v[160:175]
  v_add_f32 v232, v232, v149
  v_fma_f32 v138, v138, s42, v223
  v_exp_f32 v136, v136
  v_add_f32 v231, v231, v150
  v_mfma_f32_32x32x16_bf16 v[176:191], v[200:203], a[168:171], v[176:191]
  ds_read_b128 v[200:203], v214 offset:57344
  v_cvt_pk_bf16_f32 v146, v148, v149
  v_fma_f32 v139, v139, s42, v223
  v_exp_f32 v137, v137
  v_mfma_f32_32x32x16_bf16 v[160:175], v[204:207], a[140:143], v[160:175]
  v_add_f32 v232, v232, v151
  v_fma_f32 v140, v140, s42, v223
  v_exp_f32 v138, v138
  v_add_f32 v229, v229, v136
  v_cvt_pk_bf16_f32 v147, v150, v151
  v_mfma_f32_32x32x16_bf16 v[176:191], v[204:207], a[172:175], v[176:191]
  ds_read_b128 v[204:207], v215 offset:57344
  v_fma_f32 v141, v141, s42, v223
  v_exp_f32 v139, v139
  s_waitcnt lgkmcnt(2)
  v_mfma_f32_32x32x16_bf16 v[160:175], v[192:195], a[144:147], v[160:175]
  v_add_f32 v230, v230, v137
  v_fma_f32 v142, v142, s42, v223
  v_exp_f32 v140, v140
  v_add_f32 v229, v229, v138
  v_cvt_pk_bf16_f32 v136, v136, v137
  v_mfma_f32_32x32x16_bf16 v[176:191], v[192:195], a[176:179], v[176:191]
  ds_read_b64_tr_b16 v[192:193], v216 offset:49152
  ds_read_b64_tr_b16 v[194:195], v216 offset:51200
  v_fma_f32 v143, v143, s42, v223
  v_exp_f32 v141, v141
  v_mfma_f32_32x32x16_bf16 v[160:175], v[196:199], a[148:151], v[160:175]
  v_add_f32 v230, v230, v139
  v_fma_f32 v152, v152, s42, v224
  v_exp_f32 v142, v142
  v_add_f32 v229, v229, v140
  v_mfma_f32_32x32x16_bf16 v[176:191], v[196:199], a[180:183], v[176:191]
  ds_read_b64_tr_b16 v[196:197], v217 offset:49152
  ds_read_b64_tr_b16 v[198:199], v217 offset:51200
  v_cvt_pk_bf16_f32 v137, v138, v139
  v_fma_f32 v153, v153, s42, v224
  v_exp_f32 v143, v143
  s_waitcnt lgkmcnt(4)
  v_mfma_f32_32x32x16_bf16 v[160:175], v[200:203], a[152:155], v[160:175]
  v_add_f32 v230, v230, v141
  v_fma_f32 v154, v154, s42, v224
  v_exp_f32 v152, v152
  v_mfma_f32_32x32x16_bf16 v[176:191], v[200:203], a[184:187], v[176:191]
  ds_read_b64_tr_b16 v[200:201], v218 offset:49152
  ds_read_b64_tr_b16 v[202:203], v218 offset:51200
  v_add_f32 v229, v229, v142
  v_cvt_pk_bf16_f32 v138, v140, v141
  v_fma_f32 v155, v155, s42, v224
  v_mfma_f32_32x32x16_bf16 v[160:175], v[204:207], a[156:159], v[160:175]
  v_exp_f32 v153, v153
  v_add_f32 v230, v230, v143
  v_fma_f32 v156, v156, s42, v224
  v_exp_f32 v154, v154
  v_mfma_f32_32x32x16_bf16 v[176:191], v[204:207], a[188:191], v[176:191]
  ds_read_b64_tr_b16 v[204:205], v219 offset:49152
  ds_read_b64_tr_b16 v[206:207], v219 offset:51200
  v_add_f32 v231, v231, v152
  v_cvt_pk_bf16_f32 v139, v142, v143
  v_fma_f32 v157, v157, s42, v224
  s_waitcnt lgkmcnt(4)
  v_mfma_f32_32x32x16_bf16 v[0:15], v[192:195], v[128:131], v[0:15]
  v_exp_f32 v155, v155
  v_add_f32 v232, v232, v153
  v_fma_f32 v158, v158, s42, v224
  v_mfma_f32_32x32x16_bf16 v[64:79], v[192:195], v[144:147], v[64:79]
  ds_read_b64_tr_b16 v[192:193], v216 offset:53248
  ds_read_b64_tr_b16 v[194:195], v216 offset:55296
  v_exp_f32 v156, v156
  v_add_f32 v231, v231, v154
  v_cvt_pk_bf16_f32 v152, v152, v153
  v_mfma_f32_32x32x16_bf16 v[16:31], v[196:199], v[128:131], v[16:31]
  buffer_load_dwordx4 a[240:243], v249, s[20:23], s50 offen offset:128 nt
  buffer_load_dwordx4 a[248:251], v249, s[20:23], s50 offen offset:192 nt
  v_fma_f32 v159, v159, s42, v224
  v_fma_f32 v160, v160, s42, v223
  v_exp_f32 v157, v157
  v_add_f32 v232, v232, v155
  v_mfma_f32_32x32x16_bf16 v[80:95], v[196:199], v[144:147], v[80:95]
  ds_read_b64_tr_b16 v[196:197], v217 offset:53248
  ds_read_b64_tr_b16 v[198:199], v217 offset:55296
  v_exp_f32 v158, v158
  v_fma_f32 v161, v161, s42, v223
  s_waitcnt lgkmcnt(4)
  v_mfma_f32_32x32x16_bf16 v[32:47], v[200:203], v[128:131], v[32:47]
  v_add_f32 v231, v231, v156
  v_fma_f32 v162, v162, s42, v223
  v_cvt_pk_bf16_f32 v153, v154, v155
  v_exp_f32 v159, v159
  v_add_f32 v232, v232, v157
  v_add_f32 v231, v231, v158
  v_mfma_f32_32x32x16_bf16 v[96:111], v[200:203], v[144:147], v[96:111]
  ds_read_b64_tr_b16 v[200:201], v218 offset:53248
  ds_read_b64_tr_b16 v[202:203], v218 offset:55296
  v_cvt_pk_bf16_f32 v154, v156, v157
  v_exp_f32 v160, v160
  v_add_f32 v232, v232, v159
  v_cvt_pk_bf16_f32 v155, v158, v159
  v_mfma_f32_32x32x16_bf16 v[48:63], v[204:207], v[128:131], v[48:63]
  v_fma_f32 v163, v163, s42, v223
  v_exp_f32 v161, v161
  v_fma_f32 v164, v164, s42, v223
  v_exp_f32 v162, v162
  v_mfma_f32_32x32x16_bf16 v[112:127], v[204:207], v[144:147], v[112:127]
  ds_read_b64_tr_b16 v[204:205], v219 offset:53248
  ds_read_b64_tr_b16 v[206:207], v219 offset:55296
  v_add_f32 v229, v229, v160
  v_fma_f32 v165, v165, s42, v223
  s_waitcnt lgkmcnt(4)
  v_mfma_f32_32x32x16_bf16 v[0:15], v[192:195], v[136:139], v[0:15]
  v_exp_f32 v163, v163
  v_add_f32 v230, v230, v161
  v_fma_f32 v166, v166, s42, v223
  v_exp_f32 v164, v164
  v_xor_b32 v208, 0x10000, v208
  v_mfma_f32_32x32x16_bf16 v[64:79], v[192:195], v[152:155], v[64:79]
  ds_read_b128 v[192:195], v208 offset:0
  v_add_f32 v229, v229, v162
  v_cvt_pk_bf16_f32 v160, v160, v161
  v_fma_f32 v167, v167, s42, v223
  v_exp_f32 v165, v165
  v_mfma_f32_32x32x16_bf16 v[16:31], v[196:199], v[136:139], v[16:31]
  v_add_f32 v230, v230, v163
  v_fma_f32 v176, v176, s42, v224
  v_exp_f32 v166, v166
  v_xor_b32 v209, 0x10000, v209
  v_mfma_f32_32x32x16_bf16 v[80:95], v[196:199], v[152:155], v[80:95]
  ds_read_b128 v[196:199], v209 offset:0
  v_add_f32 v229, v229, v164
  v_cvt_pk_bf16_f32 v161, v162, v163
  v_fma_f32 v177, v177, s42, v224
  v_exp_f32 v167, v167
  s_waitcnt lgkmcnt(2)
  v_mfma_f32_32x32x16_bf16 v[32:47], v[200:203], v[136:139], v[32:47]
  v_add_f32 v230, v230, v165
  v_fma_f32 v178, v178, s42, v224
  v_exp_f32 v176, v176
  v_xor_b32 v210, 0x10000, v210
  v_mfma_f32_32x32x16_bf16 v[96:111], v[200:203], v[152:155], v[96:111]
  ds_read_b128 v[200:203], v210 offset:0
  v_add_f32 v229, v229, v166
  v_cvt_pk_bf16_f32 v162, v164, v165
  v_fma_f32 v179, v179, s42, v224
  v_exp_f32 v177, v177
  v_mfma_f32_32x32x16_bf16 v[48:63], v[204:207], v[136:139], v[48:63]
  v_add_f32 v230, v230, v167
  v_fma_f32 v180, v180, s42, v224
  v_exp_f32 v178, v178
  v_add_f32 v231, v231, v176
  v_xor_b32 v211, 0x10000, v211
  v_mfma_f32_32x32x16_bf16 v[112:127], v[204:207], v[152:155], v[112:127]
  ds_read_b128 v[204:207], v211 offset:0
  v_cvt_pk_bf16_f32 v163, v166, v167
  v_fma_f32 v181, v181, s42, v224
  v_exp_f32 v179, v179
  v_add_f32 v232, v232, v177
  s_waitcnt lgkmcnt(2)
  v_mfma_f32_32x32x16_bf16 v[128:143], v[192:195], a[128:131], 0
  v_fma_f32 v182, v182, s42, v224
  v_exp_f32 v180, v180
  v_add_f32 v231, v231, v178
  v_cvt_pk_bf16_f32 v176, v176, v177
  v_xor_b32 v212, 0x10000, v212
  v_mfma_f32_32x32x16_bf16 v[144:159], v[192:195], a[160:163], 0
  ds_read_b128 v[192:195], v212 offset:0
  v_fma_f32 v183, v183, s42, v224
  v_exp_f32 v181, v181
  v_add_f32 v232, v232, v179
  v_fma_f32 v168, v168, s42, v223
  v_mfma_f32_32x32x16_bf16 v[128:143], v[196:199], a[132:135], v[128:143]
  v_exp_f32 v182, v182
  v_add_f32 v231, v231, v180
  v_cvt_pk_bf16_f32 v177, v178, v179
  v_fma_f32 v169, v169, s42, v223
  v_xor_b32 v213, 0x10000, v213
  v_mfma_f32_32x32x16_bf16 v[144:159], v[196:199], a[164:167], v[144:159]
  ds_read_b128 v[196:199], v213 offset:0
  v_exp_f32 v183, v183
  v_add_f32 v232, v232, v181
  v_fma_f32 v170, v170, s42, v223
  s_waitcnt lgkmcnt(2)
  v_mfma_f32_32x32x16_bf16 v[128:143], v[200:203], a[136:139], v[128:143]
  v_exp_f32 v168, v168
  v_add_f32 v231, v231, v182
  v_cvt_pk_bf16_f32 v178, v180, v181
  v_fma_f32 v171, v171, s42, v223
  v_xor_b32 v214, 0x10000, v214
  v_mfma_f32_32x32x16_bf16 v[144:159], v[200:203], a[168:171], v[144:159]
  ds_read_b128 v[200:203], v214 offset:0
  v_exp_f32 v169, v169
  v_add_f32 v232, v232, v183
  v_fma_f32 v172, v172, s42, v223
  v_mfma_f32_32x32x16_bf16 v[128:143], v[204:207], a[140:143], v[128:143]
  buffer_load_dwordx4 a[212:215], v249, s[20:23], s55 offen offset:128 nt
  buffer_load_dwordx4 a[220:223], v249, s[20:23], s55 offen offset:192 nt
  v_exp_f32 v170, v170
  v_add_f32 v229, v229, v168
  v_cvt_pk_bf16_f32 v179, v182, v183
  v_xor_b32 v215, 0x10000, v215
  v_mfma_f32_32x32x16_bf16 v[144:159], v[204:207], a[172:175], v[144:159]
  ds_read_b128 v[204:207], v215 offset:0
  v_fma_f32 v173, v173, s42, v223
  v_exp_f32 v171, v171
  s_waitcnt lgkmcnt(2)
  v_mfma_f32_32x32x16_bf16 v[128:143], v[192:195], a[144:147], v[128:143]
  v_add_f32 v230, v230, v169
  v_fma_f32 v174, v174, s42, v223
  v_exp_f32 v172, v172
  v_add_f32 v229, v229, v170
  v_mfma_f32_32x32x16_bf16 v[144:159], v[192:195], a[176:179], v[144:159]
  ds_read_b64_tr_b16 v[192:193], v216 offset:57344
  ds_read_b64_tr_b16 v[194:195], v216 offset:59392
  v_cvt_pk_bf16_f32 v168, v168, v169
  v_fma_f32 v175, v175, s42, v223
  v_exp_f32 v173, v173
  v_mfma_f32_32x32x16_bf16 v[128:143], v[196:199], a[148:151], v[128:143]
  v_add_f32 v230, v230, v171
  v_fma_f32 v184, v184, s42, v224
  v_exp_f32 v174, v174
  v_add_f32 v229, v229, v172
  v_mfma_f32_32x32x16_bf16 v[144:159], v[196:199], a[180:183], v[144:159]
  ds_read_b64_tr_b16 v[196:197], v217 offset:57344
  ds_read_b64_tr_b16 v[198:199], v217 offset:59392
  v_cvt_pk_bf16_f32 v169, v170, v171
  v_fma_f32 v185, v185, s42, v224
  s_waitcnt lgkmcnt(4)
  v_mfma_f32_32x32x16_bf16 v[128:143], v[200:203], a[152:155], v[128:143]
  v_exp_f32 v175, v175
  v_add_f32 v230, v230, v173
  v_fma_f32 v186, v186, s42, v224
  v_exp_f32 v184, v184
  v_mfma_f32_32x32x16_bf16 v[144:159], v[200:203], a[184:187], v[144:159]
  ds_read_b64_tr_b16 v[200:201], v218 offset:57344
  ds_read_b64_tr_b16 v[202:203], v218 offset:59392
  v_add_f32 v229, v229, v174
  v_cvt_pk_bf16_f32 v170, v172, v173
  v_fma_f32 v187, v187, s42, v224
  v_mfma_f32_32x32x16_bf16 v[128:143], v[204:207], a[156:159], v[128:143]
  v_exp_f32 v185, v185
  v_add_f32 v230, v230, v175
  v_fma_f32 v188, v188, s42, v224
  v_mfma_f32_32x32x16_bf16 v[144:159], v[204:207], a[188:191], v[144:159]
  ds_read_b64_tr_b16 v[204:205], v219 offset:57344
  ds_read_b64_tr_b16 v[206:207], v219 offset:59392
  v_exp_f32 v186, v186
  v_add_f32 v231, v231, v184
  s_waitcnt lgkmcnt(4)
  v_mfma_f32_32x32x16_bf16 v[0:15], v[192:195], v[160:163], v[0:15]
  v_cvt_pk_bf16_f32 v171, v174, v175
  v_fma_f32 v189, v189, s42, v224
  v_exp_f32 v187, v187
  v_add_f32 v232, v232, v185
  v_fma_f32 v190, v190, s42, v224
  v_mfma_f32_32x32x16_bf16 v[64:79], v[192:195], v[176:179], v[64:79]
  ds_read_b64_tr_b16 v[192:193], v216 offset:61440
  ds_read_b64_tr_b16 v[194:195], v216 offset:63488
  v_exp_f32 v188, v188
  v_fma_f32 v128, v128, s42, v223
  v_add_f32 v231, v231, v186
  v_mfma_f32_32x32x16_bf16 v[16:31], v[196:199], v[160:163], v[16:31]
  v_cvt_pk_bf16_f32 v184, v184, v185
  v_fma_f32 v129, v129, s42, v223
  v_fma_f32 v191, v191, s42, v224
  v_fma_f32 v130, v130, s42, v223
  v_exp_f32 v189, v189
  v_add_f32 v232, v232, v187
  v_mfma_f32_32x32x16_bf16 v[80:95], v[196:199], v[176:179], v[80:95]
  ds_read_b64_tr_b16 v[196:197], v217 offset:61440
  ds_read_b64_tr_b16 v[198:199], v217 offset:63488
  v_exp_f32 v190, v190
  v_add_f32 v231, v231, v188
  s_waitcnt lgkmcnt(4)
  v_mfma_f32_32x32x16_bf16 v[32:47], v[200:203], v[160:163], v[32:47]
  v_cvt_pk_bf16_f32 v185, v186, v187
  v_exp_f32 v128, v128
  v_exp_f32 v191, v191
  v_add_f32 v232, v232, v189
  v_add_f32 v231, v231, v190
  v_mfma_f32_32x32x16_bf16 v[96:111], v[200:203], v[176:179], v[96:111]
  ds_read_b64_tr_b16 v[200:201], v218 offset:61440
  ds_read_b64_tr_b16 v[202:203], v218 offset:63488
  v_cvt_pk_bf16_f32 v186, v188, v189
  v_fma_f32 v131, v131, s42, v223
  v_add_f32 v232, v232, v191
  v_cvt_pk_bf16_f32 v187, v190, v191
  v_mfma_f32_32x32x16_bf16 v[48:63], v[204:207], v[160:163], v[48:63]
  v_exp_f32 v129, v129
  v_fma_f32 v132, v132, s42, v223
  v_exp_f32 v130, v130
  v_add_f32 v229, v229, v128
  v_mfma_f32_32x32x16_bf16 v[112:127], v[204:207], v[176:179], v[112:127]
  ds_read_b64_tr_b16 v[204:205], v219 offset:61440
  ds_read_b64_tr_b16 v[206:207], v219 offset:63488
  v_fma_f32 v133, v133, s42, v223
  v_exp_f32 v131, v131
  s_waitcnt lgkmcnt(4)
  v_mfma_f32_32x32x16_bf16 v[0:15], v[192:195], v[168:171], v[0:15]
  v_add_f32 v230, v230, v129
  v_fma_f32 v134, v134, s42, v223
  v_exp_f32 v132, v132
  s_waitcnt vmcnt(8)
  s_barrier
  v_xor_b32 v208, 0x10000, v208
  v_mfma_f32_32x32x16_bf16 v[64:79], v[192:195], v[184:187], v[64:79]
  ds_read_b128 v[192:195], v208 offset:32768
  v_add_f32 v229, v229, v130
  v_cvt_pk_bf16_f32 v128, v128, v129
  v_fma_f32 v135, v135, s42, v223
  v_exp_f32 v133, v133
  v_mfma_f32_32x32x16_bf16 v[16:31], v[196:199], v[168:171], v[16:31]
  buffer_load_dwordx4 a[244:247], v249, s[20:23], s56 offen offset:128 nt
  buffer_load_dwordx4 a[252:255], v249, s[20:23], s56 offen offset:192 nt
  v_add_f32 v230, v230, v131
  v_fma_f32 v144, v144, s42, v224
  v_xor_b32 v209, 0x10000, v209
  v_mfma_f32_32x32x16_bf16 v[80:95], v[196:199], v[184:187], v[80:95]
  ds_read_b128 v[196:199], v209 offset:32768
  v_exp_f32 v134, v134
  v_add_f32 v229, v229, v132
  v_cvt_pk_bf16_f32 v129, v130, v131
  v_fma_f32 v145, v145, s42, v224
  s_waitcnt lgkmcnt(2)
  v_mfma_f32_32x32x16_bf16 v[32:47], v[200:203], v[168:171], v[32:47]
  v_exp_f32 v135, v135
  v_add_f32 v230, v230, v133
  v_fma_f32 v146, v146, s42, v224
  v_xor_b32 v210, 0x10000, v210
  v_mfma_f32_32x32x16_bf16 v[96:111], v[200:203], v[184:187], v[96:111]
  ds_read_b128 v[200:203], v210 offset:32768
  v_exp_f32 v144, v144
  v_add_f32 v229, v229, v134
  v_cvt_pk_bf16_f32 v130, v132, v133
  v_fma_f32 v147, v147, s42, v224
  v_mfma_f32_32x32x16_bf16 v[48:63], v[204:207], v[168:171], v[48:63]
  v_exp_f32 v145, v145
  v_add_f32 v230, v230, v135
  v_fma_f32 v148, v148, s42, v224
  v_exp_f32 v146, v146
  v_xor_b32 v211, 0x10000, v211
  v_mfma_f32_32x32x16_bf16 v[112:127], v[204:207], v[184:187], v[112:127]
  ds_read_b128 v[204:207], v211 offset:32768
  v_add_f32 v231, v231, v144
  v_cvt_pk_bf16_f32 v131, v134, v135
  v_fma_f32 v149, v149, s42, v224
  s_waitcnt lgkmcnt(2)
  v_mfma_f32_32x32x16_bf16 v[160:175], v[192:195], a[128:131], 0
  v_exp_f32 v147, v147
  v_add_f32 v232, v232, v145
  v_fma_f32 v150, v150, s42, v224
  v_exp_f32 v148, v148
  v_xor_b32 v212, 0x10000, v212
  v_mfma_f32_32x32x16_bf16 v[176:191], v[192:195], a[160:163], 0
  ds_read_b128 v[192:195], v212 offset:32768
  v_add_f32 v231, v231, v146
  v_cvt_pk_bf16_f32 v144, v144, v145
  v_fma_f32 v151, v151, s42, v224
  v_exp_f32 v149, v149
  v_mfma_f32_32x32x16_bf16 v[160:175], v[196:199], a[132:135], v[160:175]
  v_add_f32 v232, v232, v147
  v_fma_f32 v136, v136, s42, v223
  v_exp_f32 v150, v150
  v_add_f32 v231, v231, v148
  v_xor_b32 v213, 0x10000, v213
  v_mfma_f32_32x32x16_bf16 v[176:191], v[196:199], a[164:167], v[176:191]
  ds_read_b128 v[196:199], v213 offset:32768
  v_cvt_pk_bf16_f32 v145, v146, v147
  v_fma_f32 v137, v137, s42, v223
  v_exp_f32 v151, v151
  s_waitcnt lgkmcnt(2)
  v_mfma_f32_32x32x16_bf16 v[160:175], v[200:203], a[136:139], v[160:175]
  v_add_f32 v232, v232, v149
  v_fma_f32 v138, v138, s42, v223
  v_exp_f32 v136, v136
  v_add_f32 v231, v231, v150
  v_xor_b32 v214, 0x10000, v214
  v_mfma_f32_32x32x16_bf16 v[176:191], v[200:203], a[168:171], v[176:191]
  ds_read_b128 v[200:203], v214 offset:32768
  v_cvt_pk_bf16_f32 v146, v148, v149
  v_fma_f32 v139, v139, s42, v223
  v_exp_f32 v137, v137
  v_add_f32 v232, v232, v151
  v_mfma_f32_32x32x16_bf16 v[160:175], v[204:207], a[140:143], v[160:175]
  v_fma_f32 v140, v140, s42, v223
  v_exp_f32 v138, v138
  v_add_f32 v229, v229, v136
  v_cvt_pk_bf16_f32 v147, v150, v151
  v_xor_b32 v215, 0x10000, v215
  v_mfma_f32_32x32x16_bf16 v[176:191], v[204:207], a[172:175], v[176:191]
  ds_read_b128 v[204:207], v215 offset:32768
  v_fma_f32 v141, v141, s42, v223
  v_exp_f32 v139, v139
  s_waitcnt lgkmcnt(2)
  v_mfma_f32_32x32x16_bf16 v[160:175], v[192:195], a[144:147], v[160:175]
  v_add_f32 v230, v230, v137
  v_fma_f32 v142, v142, s42, v223
  v_exp_f32 v140, v140
  v_mfma_f32_32x32x16_bf16 v[176:191], v[192:195], a[176:179], v[176:191]
  v_add_f32 v229, v229, v138
  v_cvt_pk_bf16_f32 v136, v136, v137
  v_fma_f32 v143, v143, s42, v223
  v_exp_f32 v141, v141
  v_mfma_f32_32x32x16_bf16 v[160:175], v[196:199], a[148:151], v[160:175]
  v_add_f32 v230, v230, v139
  v_fma_f32 v152, v152, s42, v224
  v_exp_f32 v142, v142
  v_mfma_f32_32x32x16_bf16 v[176:191], v[196:199], a[180:183], v[176:191]
  v_add_f32 v229, v229, v140
  v_cvt_pk_bf16_f32 v137, v138, v139
  v_fma_f32 v153, v153, s42, v224
  s_waitcnt lgkmcnt(0)
  v_mfma_f32_32x32x16_bf16 v[160:175], v[200:203], a[152:155], v[160:175]
  v_exp_f32 v143, v143
  v_add_f32 v230, v230, v141
  v_fma_f32 v154, v154, s42, v224
  v_mfma_f32_32x32x16_bf16 v[176:191], v[200:203], a[184:187], v[176:191]
  v_exp_f32 v152, v152
  v_add_f32 v229, v229, v142
  v_cvt_pk_bf16_f32 v138, v140, v141
  v_mfma_f32_32x32x16_bf16 v[160:175], v[204:207], a[156:159], v[160:175]
  v_fma_f32 v155, v155, s42, v224
  v_exp_f32 v153, v153
  v_add_f32 v230, v230, v143
  v_mfma_f32_32x32x16_bf16 v[176:191], v[204:207], a[188:191], v[176:191]
  v_fma_f32 v156, v156, s42, v224
  v_exp_f32 v154, v154
  v_add_f32 v231, v231, v152
  v_mfma_f32_32x32x16_bf16 v[0:15], a[0:3], v[128:131], v[0:15]
  v_cvt_pk_bf16_f32 v139, v142, v143
  v_fma_f32 v157, v157, s42, v224
  v_exp_f32 v155, v155
  v_mfma_f32_32x32x16_bf16 v[64:79], a[0:3], v[144:147], v[64:79]
  v_add_f32 v232, v232, v153
  v_fma_f32 v160, v160, s42, v223
  v_fma_f32 v158, v158, s42, v224
  v_fma_f32 v161, v161, s42, v223
  v_exp_f32 v156, v156
  v_mfma_f32_32x32x16_bf16 v[16:31], a[4:7], v[128:131], v[16:31]
  v_add_f32 v231, v231, v154
  v_fma_f32 v162, v162, s42, v223
  v_cvt_pk_bf16_f32 v152, v152, v153
  v_fma_f32 v159, v159, s42, v224
  v_exp_f32 v157, v157
  v_mfma_f32_32x32x16_bf16 v[80:95], a[4:7], v[144:147], v[80:95]
  v_add_f32 v232, v232, v155
  v_exp_f32 v160, v160
  v_exp_f32 v158, v158
  v_add_f32 v231, v231, v156
  v_mfma_f32_32x32x16_bf16 v[32:47], a[8:11], v[128:131], v[32:47]
  v_cvt_pk_bf16_f32 v153, v154, v155
  v_fma_f32 v163, v163, s42, v223
  v_exp_f32 v159, v159
  v_add_f32 v232, v232, v157
  v_mfma_f32_32x32x16_bf16 v[96:111], a[8:11], v[144:147], v[96:111]
  v_add_f32 v231, v231, v158
  v_exp_f32 v161, v161
  v_cvt_pk_bf16_f32 v154, v156, v157
  v_add_f32 v232, v232, v159
  v_cvt_pk_bf16_f32 v155, v158, v159
  v_mfma_f32_32x32x16_bf16 v[48:63], a[12:15], v[128:131], v[48:63]
  v_fma_f32 v164, v164, s42, v223
  v_exp_f32 v162, v162
  v_add_f32 v229, v229, v160
  v_fma_f32 v165, v165, s42, v223
  v_mfma_f32_32x32x16_bf16 v[112:127], a[12:15], v[144:147], v[112:127]
  v_exp_f32 v163, v163
  v_add_f32 v230, v230, v161
  v_fma_f32 v166, v166, s42, v223
  v_exp_f32 v164, v164
  v_mfma_f32_32x32x16_bf16 v[0:15], a[16:19], v[136:139], v[0:15]
  v_add_f32 v229, v229, v162
  v_cvt_pk_bf16_f32 v160, v160, v161
  v_fma_f32 v167, v167, s42, v223
  v_exp_f32 v165, v165
  v_xor_b32 v208, 0x10000, v208
  v_mfma_f32_32x32x16_bf16 v[64:79], a[16:19], v[152:155], v[64:79]
  ds_read_b128 v[192:195], v208 offset:8192
  v_add_f32 v230, v230, v163
  v_fma_f32 v176, v176, s42, v224
  v_exp_f32 v166, v166
  v_mfma_f32_32x32x16_bf16 v[16:31], a[20:23], v[136:139], v[16:31]
  v_add_f32 v229, v229, v164
  v_cvt_pk_bf16_f32 v161, v162, v163
  v_fma_f32 v177, v177, s42, v224
  v_exp_f32 v167, v167
  v_xor_b32 v209, 0x10000, v209
  v_mfma_f32_32x32x16_bf16 v[80:95], a[20:23], v[152:155], v[80:95]
  ds_read_b128 v[196:199], v209 offset:8192
  v_add_f32 v230, v230, v165
  v_fma_f32 v178, v178, s42, v224
  v_exp_f32 v176, v176
  v_mfma_f32_32x32x16_bf16 v[32:47], a[24:27], v[136:139], v[32:47]
  v_add_f32 v229, v229, v166
  v_cvt_pk_bf16_f32 v162, v164, v165
  v_fma_f32 v179, v179, s42, v224
  v_exp_f32 v177, v177
  v_xor_b32 v210, 0x10000, v210
  v_mfma_f32_32x32x16_bf16 v[96:111], a[24:27], v[152:155], v[96:111]
  ds_read_b128 v[200:203], v210 offset:8192
  v_add_f32 v230, v230, v167
  v_fma_f32 v180, v180, s42, v224
  v_exp_f32 v178, v178
  v_mfma_f32_32x32x16_bf16 v[48:63], a[28:31], v[136:139], v[48:63]
  v_add_f32 v231, v231, v176
  v_cvt_pk_bf16_f32 v163, v166, v167
  v_fma_f32 v181, v181, s42, v224
  v_exp_f32 v179, v179
  v_xor_b32 v211, 0x10000, v211
  v_mfma_f32_32x32x16_bf16 v[112:127], a[28:31], v[152:155], v[112:127]
  ds_read_b128 v[204:207], v211 offset:8192
  v_add_f32 v232, v232, v177
  v_fma_f32 v182, v182, s42, v224
  s_waitcnt lgkmcnt(2)
  v_mfma_f32_32x32x16_bf16 v[128:143], v[192:195], a[128:131], 0
  v_exp_f32 v180, v180
  v_add_f32 v231, v231, v178
  v_cvt_pk_bf16_f32 v176, v176, v177
  v_fma_f32 v183, v183, s42, v224
  v_xor_b32 v212, 0x10000, v212
  v_mfma_f32_32x32x16_bf16 v[144:159], v[192:195], a[160:163], 0
  ds_read_b128 v[192:195], v212 offset:8192
  v_exp_f32 v181, v181
  v_add_f32 v232, v232, v179
  v_fma_f32 v168, v168, s42, v223
  v_mfma_f32_32x32x16_bf16 v[128:143], v[196:199], a[132:135], v[128:143]
  v_exp_f32 v182, v182
  v_add_f32 v231, v231, v180
  v_cvt_pk_bf16_f32 v177, v178, v179
  v_fma_f32 v169, v169, s42, v223
  v_xor_b32 v213, 0x10000, v213
  v_mfma_f32_32x32x16_bf16 v[144:159], v[196:199], a[164:167], v[144:159]
  ds_read_b128 v[196:199], v213 offset:8192
  v_exp_f32 v183, v183
  v_add_f32 v232, v232, v181
  v_fma_f32 v170, v170, s42, v223
  s_waitcnt lgkmcnt(2)
  v_mfma_f32_32x32x16_bf16 v[128:143], v[200:203], a[136:139], v[128:143]
  v_exp_f32 v168, v168
  v_add_f32 v231, v231, v182
  v_cvt_pk_bf16_f32 v178, v180, v181
  v_xor_b32 v214, 0x10000, v214
  v_mfma_f32_32x32x16_bf16 v[144:159], v[200:203], a[168:171], v[144:159]
  ds_read_b128 v[200:203], v214 offset:8192
  v_fma_f32 v171, v171, s42, v223
  v_exp_f32 v169, v169
  v_add_f32 v232, v232, v183
  v_fma_f32 v172, v172, s42, v223
  v_mfma_f32_32x32x16_bf16 v[128:143], v[204:207], a[140:143], v[128:143]
  v_exp_f32 v170, v170
  v_add_f32 v229, v229, v168
  v_cvt_pk_bf16_f32 v179, v182, v183
  v_xor_b32 v215, 0x10000, v215
  v_mfma_f32_32x32x16_bf16 v[144:159], v[204:207], a[172:175], v[144:159]
  ds_read_b128 v[204:207], v215 offset:8192
  v_fma_f32 v173, v173, s42, v223
  v_exp_f32 v171, v171
  s_waitcnt lgkmcnt(2)
  v_mfma_f32_32x32x16_bf16 v[128:143], v[192:195], a[144:147], v[128:143]
  v_add_f32 v230, v230, v169
  v_fma_f32 v174, v174, s42, v223
  v_exp_f32 v172, v172
  v_mfma_f32_32x32x16_bf16 v[144:159], v[192:195], a[176:179], v[144:159]
  v_add_f32 v229, v229, v170
  v_cvt_pk_bf16_f32 v168, v168, v169
  v_fma_f32 v175, v175, s42, v223
  v_exp_f32 v173, v173
  v_mfma_f32_32x32x16_bf16 v[128:143], v[196:199], a[148:151], v[128:143]
  v_add_f32 v230, v230, v171
  v_fma_f32 v184, v184, s42, v224
  v_exp_f32 v174, v174
  v_mfma_f32_32x32x16_bf16 v[144:159], v[196:199], a[180:183], v[144:159]
  v_add_f32 v229, v229, v172
  v_cvt_pk_bf16_f32 v169, v170, v171
  v_fma_f32 v185, v185, s42, v224
  s_waitcnt lgkmcnt(0)
  v_mfma_f32_32x32x16_bf16 v[128:143], v[200:203], a[152:155], v[128:143]
  v_exp_f32 v175, v175
  v_add_f32 v230, v230, v173
  v_fma_f32 v186, v186, s42, v224
  v_mfma_f32_32x32x16_bf16 v[144:159], v[200:203], a[184:187], v[144:159]
  v_exp_f32 v184, v184
  v_add_f32 v229, v229, v174
  v_cvt_pk_bf16_f32 v170, v172, v173
  v_mfma_f32_32x32x16_bf16 v[128:143], v[204:207], a[156:159], v[128:143]
  v_fma_f32 v187, v187, s42, v224
  v_exp_f32 v185, v185
  v_add_f32 v230, v230, v175
  v_mfma_f32_32x32x16_bf16 v[144:159], v[204:207], a[188:191], v[144:159]
  v_fma_f32 v188, v188, s42, v224
  v_exp_f32 v186, v186
  v_add_f32 v231, v231, v184
  v_mfma_f32_32x32x16_bf16 v[0:15], a[32:35], v[160:163], v[0:15]
  v_cvt_pk_bf16_f32 v171, v174, v175
  v_fma_f32 v189, v189, s42, v224
  v_exp_f32 v187, v187
  v_mfma_f32_32x32x16_bf16 v[64:79], a[32:35], v[176:179], v[64:79]
  v_add_f32 v232, v232, v185
  v_fma_f32 v128, v128, s42, v223
  v_fma_f32 v190, v190, s42, v224
  v_fma_f32 v129, v129, s42, v223
  v_exp_f32 v188, v188
  v_mfma_f32_32x32x16_bf16 v[16:31], a[36:39], v[160:163], v[16:31]
  v_add_f32 v231, v231, v186
  v_fma_f32 v130, v130, s42, v223
  v_cvt_pk_bf16_f32 v184, v184, v185
  v_fma_f32 v191, v191, s42, v224
  v_exp_f32 v189, v189
  v_mfma_f32_32x32x16_bf16 v[80:95], a[36:39], v[176:179], v[80:95]
  v_add_f32 v232, v232, v187
  v_exp_f32 v128, v128
  v_exp_f32 v190, v190
  v_add_f32 v231, v231, v188
  v_mfma_f32_32x32x16_bf16 v[32:47], a[40:43], v[160:163], v[32:47]
  v_cvt_pk_bf16_f32 v185, v186, v187
  v_fma_f32 v131, v131, s42, v223
  v_exp_f32 v191, v191
  v_add_f32 v232, v232, v189
  v_mfma_f32_32x32x16_bf16 v[96:111], a[40:43], v[176:179], v[96:111]
  v_add_f32 v231, v231, v190
  v_exp_f32 v129, v129
  v_cvt_pk_bf16_f32 v186, v188, v189
  v_add_f32 v232, v232, v191
  v_cvt_pk_bf16_f32 v187, v190, v191
  v_mfma_f32_32x32x16_bf16 v[48:63], a[44:47], v[160:163], v[48:63]
  v_fma_f32 v132, v132, s42, v223
  v_exp_f32 v130, v130
  v_add_f32 v229, v229, v128
  v_fma_f32 v133, v133, s42, v223
  v_exp_f32 v131, v131
  v_mfma_f32_32x32x16_bf16 v[112:127], a[44:47], v[176:179], v[112:127]
  v_add_f32 v230, v230, v129
  v_fma_f32 v134, v134, s42, v223
  v_exp_f32 v132, v132
  v_add_f32 v229, v229, v130
  v_mfma_f32_32x32x16_bf16 v[0:15], a[48:51], v[168:171], v[0:15]
  v_cvt_pk_bf16_f32 v128, v128, v129
  v_fma_f32 v135, v135, s42, v223
  v_exp_f32 v133, v133
  v_add_f32 v230, v230, v131
  s_barrier
  v_mfma_f32_32x32x16_bf16 v[64:79], a[48:51], v[184:187], v[64:79]
  ds_read_b128 v[192:195], v208 offset:16384
  v_fma_f32 v144, v144, s42, v224
  v_exp_f32 v134, v134
  v_add_f32 v229, v229, v132
  v_mfma_f32_32x32x16_bf16 v[16:31], a[52:55], v[168:171], v[16:31]
  s_add_u32 m0, s40, 32768
  s_add_u32 s41, s8, 0
  buffer_load_dwordx4 v253, s[24:27], s41 offen lds
  v_cvt_pk_bf16_f32 v129, v130, v131
  v_fma_f32 v145, v145, s42, v224
  v_exp_f32 v135, v135
  v_mfma_f32_32x32x16_bf16 v[80:95], a[52:55], v[184:187], v[80:95]
  ds_read_b128 v[196:199], v209 offset:16384
  v_add_f32 v230, v230, v133
  v_fma_f32 v146, v146, s42, v224
  v_exp_f32 v144, v144
  v_mfma_f32_32x32x16_bf16 v[32:47], a[56:59], v[168:171], v[32:47]
  s_add_u32 m0, s40, 36864
  s_add_u32 s41, s8, 4096
  buffer_load_dwordx4 v253, s[24:27], s41 offen lds
  v_add_f32 v229, v229, v134
  v_cvt_pk_bf16_f32 v130, v132, v133
  v_fma_f32 v147, v147, s42, v224
  v_mfma_f32_32x32x16_bf16 v[96:111], a[56:59], v[184:187], v[96:111]
  ds_read_b128 v[200:203], v210 offset:16384
  v_exp_f32 v145, v145
  v_add_f32 v230, v230, v135
  v_fma_f32 v148, v148, s42, v224
  v_mfma_f32_32x32x16_bf16 v[48:63], a[60:63], v[168:171], v[48:63]
  v_exp_f32 v146, v146
  v_add_f32 v231, v231, v144
  v_cvt_pk_bf16_f32 v131, v134, v135
  v_fma_f32 v149, v149, s42, v224
  v_exp_f32 v147, v147
  v_mfma_f32_32x32x16_bf16 v[112:127], a[60:63], v[184:187], v[112:127]
  ds_read_b128 v[204:207], v211 offset:16384
  v_add_f32 v232, v232, v145
  v_fma_f32 v150, v150, s42, v224
  s_waitcnt lgkmcnt(2)
  v_mfma_f32_32x32x16_bf16 v[160:175], v[192:195], a[128:131], 0
  v_exp_f32 v148, v148
  v_add_f32 v231, v231, v146
  v_cvt_pk_bf16_f32 v144, v144, v145
  v_fma_f32 v151, v151, s42, v224
  v_exp_f32 v149, v149
  v_mfma_f32_32x32x16_bf16 v[176:191], v[192:195], a[160:163], 0
  ds_read_b128 v[192:195], v212 offset:16384
  v_add_f32 v232, v232, v147
  v_fma_f32 v136, v136, s42, v223
  v_exp_f32 v150, v150
  v_mfma_f32_32x32x16_bf16 v[160:175], v[196:199], a[132:135], v[160:175]
  v_add_f32 v231, v231, v148
  v_cvt_pk_bf16_f32 v145, v146, v147
  v_fma_f32 v137, v137, s42, v223
  v_exp_f32 v151, v151
  v_add_f32 v232, v232, v149
  v_mfma_f32_32x32x16_bf16 v[176:191], v[196:199], a[164:167], v[176:191]
  ds_read_b128 v[196:199], v213 offset:16384
  ds_write_b128 v250, a[192:195] offset:0
  ds_write_b128 v250, a[196:199] offset:1024
  s_waitcnt lgkmcnt(4)
  v_mfma_f32_32x32x16_bf16 v[160:175], v[200:203], a[136:139], v[160:175]
  v_fma_f32 v138, v138, s42, v223
  v_exp_f32 v136, v136
  v_add_f32 v231, v231, v150
  v_cvt_pk_bf16_f32 v146, v148, v149
  v_fma_f32 v139, v139, s42, v223
  v_mfma_f32_32x32x16_bf16 v[176:191], v[200:203], a[168:171], v[176:191]
  ds_read_b128 v[200:203], v214 offset:16384
  ds_read_b128 a[128:131], v245
  ds_read_b128 a[132:135], v246
  v_exp_f32 v137, v137
  v_mfma_f32_32x32x16_bf16 v[160:175], v[204:207], a[140:143], v[160:175]
  v_add_f32 v232, v232, v151
  v_fma_f32 v140, v140, s42, v223
  v_exp_f32 v138, v138
  v_add_f32 v229, v229, v136
  v_cvt_pk_bf16_f32 v147, v150, v151
  v_mfma_f32_32x32x16_bf16 v[176:191], v[204:207], a[172:175], v[176:191]
  ds_read_b128 v[204:207], v215 offset:16384
  ds_write_b128 v250, a[224:227] offset:0
  s_waitcnt vmcnt(11)
  ds_write_b128 v250, a[228:231] offset:1024
  s_waitcnt lgkmcnt(6)
  v_mfma_f32_32x32x16_bf16 v[160:175], v[192:195], a[144:147], v[160:175]
  v_fma_f32 v141, v141, s42, v223
  v_exp_f32 v139, v139
  v_add_f32 v230, v230, v137
  v_fma_f32 v142, v142, s42, v223
  v_exp_f32 v140, v140
  v_mfma_f32_32x32x16_bf16 v[176:191], v[192:195], a[176:179], v[176:191]
  ds_read_b128 a[160:163], v245
  ds_read_b128 a[164:167], v246
  v_add_f32 v229, v229, v138
  v_cvt_pk_bf16_f32 v136, v136, v137
  v_fma_f32 v143, v143, s42, v223
  v_mfma_f32_32x32x16_bf16 v[160:175], v[196:199], a[148:151], v[160:175]
  v_exp_f32 v141, v141
  v_add_f32 v230, v230, v139
  v_fma_f32 v152, v152, s42, v224
  v_exp_f32 v142, v142
  v_add_f32 v229, v229, v140
  v_mfma_f32_32x32x16_bf16 v[176:191], v[196:199], a[180:183], v[176:191]
  ds_write_b128 v250, a[200:203] offset:0
  ds_write_b128 v250, a[204:207] offset:1024
  s_waitcnt lgkmcnt(4)
  v_mfma_f32_32x32x16_bf16 v[160:175], v[200:203], a[152:155], v[160:175]
  v_cvt_pk_bf16_f32 v137, v138, v139
  v_fma_f32 v153, v153, s42, v224
  v_exp_f32 v143, v143
  v_add_f32 v230, v230, v141
  v_fma_f32 v154, v154, s42, v224
  v_mfma_f32_32x32x16_bf16 v[176:191], v[200:203], a[184:187], v[176:191]
  ds_read_b128 a[136:139], v245
  ds_read_b128 a[140:143], v246
  v_exp_f32 v152, v152
  v_add_f32 v229, v229, v142
  v_cvt_pk_bf16_f32 v138, v140, v141
  v_mfma_f32_32x32x16_bf16 v[160:175], v[204:207], a[156:159], v[160:175]
  v_fma_f32 v155, v155, s42, v224
  v_exp_f32 v153, v153
  v_add_f32 v230, v230, v143
  v_fma_f32 v156, v156, s42, v224
  v_exp_f32 v154, v154
  v_mfma_f32_32x32x16_bf16 v[176:191], v[204:207], a[188:191], v[176:191]
  ds_write_b128 v250, a[232:235] offset:0
  s_waitcnt vmcnt(10)
  ds_write_b128 v250, a[236:239] offset:1024
  v_mfma_f32_32x32x16_bf16 v[0:15], a[64:67], v[128:131], v[0:15]
  v_add_f32 v231, v231, v152
  v_cvt_pk_bf16_f32 v139, v142, v143
  v_fma_f32 v157, v157, s42, v224
  v_exp_f32 v155, v155
  v_mfma_f32_32x32x16_bf16 v[64:79], a[64:67], v[144:147], v[64:79]
  ds_read_b128 a[168:171], v245
  ds_read_b128 a[172:175], v246
  v_add_f32 v232, v232, v153
  v_fma_f32 v160, v160, s42, v223
  v_fma_f32 v158, v158, s42, v224
  v_exp_f32 v156, v156
  v_mfma_f32_32x32x16_bf16 v[16:31], a[68:71], v[128:131], v[16:31]
  v_add_f32 v231, v231, v154
  v_fma_f32 v161, v161, s42, v223
  v_cvt_pk_bf16_f32 v152, v152, v153
  v_fma_f32 v162, v162, s42, v223
  v_fma_f32 v159, v159, s42, v224
  v_exp_f32 v157, v157
  v_add_f32 v232, v232, v155
  v_mfma_f32_32x32x16_bf16 v[80:95], a[68:71], v[144:147], v[80:95]
  s_waitcnt vmcnt(9)
  ds_write_b128 v250, a[208:211] offset:0
  s_waitcnt vmcnt(5)
  ds_write_b128 v250, a[212:215] offset:1024
  v_mfma_f32_32x32x16_bf16 v[32:47], a[72:75], v[128:131], v[32:47]
  v_exp_f32 v158, v158
  v_add_f32 v231, v231, v156
  v_cvt_pk_bf16_f32 v153, v154, v155
  v_exp_f32 v159, v159
  v_add_f32 v232, v232, v157
  v_mfma_f32_32x32x16_bf16 v[96:111], a[72:75], v[144:147], v[96:111]
  ds_read_b128 a[144:147], v245
  ds_read_b128 a[148:151], v246
  v_add_f32 v231, v231, v158
  v_exp_f32 v160, v160
  v_cvt_pk_bf16_f32 v154, v156, v157
  v_add_f32 v232, v232, v159
  v_cvt_pk_bf16_f32 v155, v158, v159
  v_mfma_f32_32x32x16_bf16 v[48:63], a[76:79], v[128:131], v[48:63]
  v_fma_f32 v163, v163, s42, v223
  v_exp_f32 v161, v161
  v_fma_f32 v164, v164, s42, v223
  v_exp_f32 v162, v162
  v_add_f32 v229, v229, v160
  v_mfma_f32_32x32x16_bf16 v[112:127], a[76:79], v[144:147], v[112:127]
  ds_write_b128 v250, a[240:243] offset:0
  s_waitcnt vmcnt(3)
  ds_write_b128 v250, a[244:247] offset:1024
  v_mfma_f32_32x32x16_bf16 v[0:15], a[80:83], v[136:139], v[0:15]
  v_fma_f32 v165, v165, s42, v223
  v_exp_f32 v163, v163
  v_add_f32 v230, v230, v161
  v_fma_f32 v166, v166, s42, v223
  v_xor_b32 v208, 0x10000, v208
  v_mfma_f32_32x32x16_bf16 v[64:79], a[80:83], v[152:155], v[64:79]
  ds_read_b128 v[192:195], v208 offset:0
  ds_read_b128 a[176:179], v245
  ds_read_b128 a[180:183], v246
  v_exp_f32 v164, v164
  v_add_f32 v229, v229, v162
  v_cvt_pk_bf16_f32 v160, v160, v161
  v_fma_f32 v167, v167, s42, v223
  v_mfma_f32_32x32x16_bf16 v[16:31], a[84:87], v[136:139], v[16:31]
  v_exp_f32 v165, v165
  v_add_f32 v230, v230, v163
  v_fma_f32 v176, v176, s42, v224
  v_exp_f32 v166, v166
  v_xor_b32 v209, 0x10000, v209
  v_mfma_f32_32x32x16_bf16 v[80:95], a[84:87], v[152:155], v[80:95]
  ds_read_b128 v[196:199], v209 offset:0
  ds_write_b128 v250, a[216:219] offset:0
  ds_write_b128 v250, a[220:223] offset:1024
  v_mfma_f32_32x32x16_bf16 v[32:47], a[88:91], v[136:139], v[32:47]
  v_add_f32 v229, v229, v164
  v_cvt_pk_bf16_f32 v161, v162, v163
  v_fma_f32 v177, v177, s42, v224
  v_exp_f32 v167, v167
  v_add_f32 v230, v230, v165
  v_xor_b32 v210, 0x10000, v210
  v_mfma_f32_32x32x16_bf16 v[96:111], a[88:91], v[152:155], v[96:111]
  ds_read_b128 v[200:203], v210 offset:0
  ds_read_b128 a[152:155], v245
  ds_read_b128 a[156:159], v246
  v_fma_f32 v178, v178, s42, v224
  v_exp_f32 v176, v176
  v_add_f32 v229, v229, v166
  v_mfma_f32_32x32x16_bf16 v[48:63], a[92:95], v[136:139], v[48:63]
  v_cvt_pk_bf16_f32 v162, v164, v165
  v_fma_f32 v179, v179, s42, v224
  v_exp_f32 v177, v177
  v_add_f32 v230, v230, v167
  v_fma_f32 v180, v180, s42, v224
  v_xor_b32 v211, 0x10000, v211
  v_mfma_f32_32x32x16_bf16 v[112:127], a[92:95], v[152:155], v[112:127]
  ds_read_b128 v[204:207], v211 offset:0
  ds_write_b128 v250, a[248:251] offset:0
  s_waitcnt vmcnt(2)
  ds_write_b128 v250, a[252:255] offset:1024
  s_waitcnt lgkmcnt(6)
  v_mfma_f32_32x32x16_bf16 v[128:143], v[192:195], a[128:131], 0
  v_exp_f32 v178, v178
  v_add_f32 v231, v231, v176
  v_cvt_pk_bf16_f32 v163, v166, v167
  v_fma_f32 v181, v181, s42, v224
  v_exp_f32 v179, v179
  v_xor_b32 v212, 0x10000, v212
  v_mfma_f32_32x32x16_bf16 v[144:159], v[192:195], a[160:163], 0
  ds_read_b128 v[192:195], v212 offset:0
  ds_read_b128 a[184:187], v245
  ds_read_b128 a[188:191], v246
  v_add_f32 v232, v232, v177
  v_fma_f32 v182, v182, s42, v224
  v_exp_f32 v180, v180
  v_mfma_f32_32x32x16_bf16 v[128:143], v[196:199], a[132:135], v[128:143]
  v_add_f32 v231, v231, v178
  v_cvt_pk_bf16_f32 v176, v176, v177
  v_fma_f32 v183, v183, s42, v224
  v_exp_f32 v181, v181
  v_add_f32 v232, v232, v179
  v_xor_b32 v213, 0x10000, v213
  v_mfma_f32_32x32x16_bf16 v[144:159], v[196:199], a[164:167], v[144:159]
  ds_read_b128 v[196:199], v213 offset:0
  v_fma_f32 v168, v168, s42, v223
  v_exp_f32 v182, v182
  v_add_f32 v231, v231, v180
  v_cvt_pk_bf16_f32 v177, v178, v179
  s_waitcnt lgkmcnt(4)
  v_mfma_f32_32x32x16_bf16 v[128:143], v[200:203], a[136:139], v[128:143]
  v_fma_f32 v169, v169, s42, v223
  v_exp_f32 v183, v183
  v_add_f32 v232, v232, v181
  v_fma_f32 v170, v170, s42, v223
  v_xor_b32 v214, 0x10000, v214
  v_mfma_f32_32x32x16_bf16 v[144:159], v[200:203], a[168:171], v[144:159]
  ds_read_b128 v[200:203], v214 offset:0
  v_exp_f32 v168, v168
  v_add_f32 v231, v231, v182
  v_cvt_pk_bf16_f32 v178, v180, v181
  v_fma_f32 v171, v171, s42, v223
  v_exp_f32 v169, v169
  v_mfma_f32_32x32x16_bf16 v[128:143], v[204:207], a[140:143], v[128:143]
  v_add_f32 v232, v232, v183
  v_fma_f32 v172, v172, s42, v223
  v_exp_f32 v170, v170
  v_add_f32 v229, v229, v168
  v_cvt_pk_bf16_f32 v179, v182, v183
  v_xor_b32 v215, 0x10000, v215
  v_mfma_f32_32x32x16_bf16 v[144:159], v[204:207], a[172:175], v[144:159]
  ds_read_b128 v[204:207], v215 offset:0
  v_fma_f32 v173, v173, s42, v223
  v_exp_f32 v171, v171
  s_waitcnt lgkmcnt(2)
  v_mfma_f32_32x32x16_bf16 v[128:143], v[192:195], a[144:147], v[128:143]
  v_add_f32 v230, v230, v169
  v_fma_f32 v174, v174, s42, v223
  v_exp_f32 v172, v172
  v_mfma_f32_32x32x16_bf16 v[144:159], v[192:195], a[176:179], v[144:159]
  v_add_f32 v229, v229, v170
  v_cvt_pk_bf16_f32 v168, v168, v169
  v_fma_f32 v175, v175, s42, v223
  v_exp_f32 v173, v173
  v_mfma_f32_32x32x16_bf16 v[128:143], v[196:199], a[148:151], v[128:143]
  v_add_f32 v230, v230, v171
  v_fma_f32 v184, v184, s42, v224
  v_exp_f32 v174, v174
  v_mfma_f32_32x32x16_bf16 v[144:159], v[196:199], a[180:183], v[144:159]
  v_add_f32 v229, v229, v172
  v_cvt_pk_bf16_f32 v169, v170, v171
  v_fma_f32 v185, v185, s42, v224
  s_waitcnt lgkmcnt(0)
  v_mfma_f32_32x32x16_bf16 v[128:143], v[200:203], a[152:155], v[128:143]
  v_exp_f32 v175, v175
  v_add_f32 v230, v230, v173
  v_fma_f32 v186, v186, s42, v224
  v_mfma_f32_32x32x16_bf16 v[144:159], v[200:203], a[184:187], v[144:159]
  v_exp_f32 v184, v184
  v_add_f32 v229, v229, v174
  v_cvt_pk_bf16_f32 v170, v172, v173
  v_mfma_f32_32x32x16_bf16 v[128:143], v[204:207], a[156:159], v[128:143]
  v_fma_f32 v187, v187, s42, v224
  v_exp_f32 v185, v185
  v_add_f32 v230, v230, v175
  v_mfma_f32_32x32x16_bf16 v[144:159], v[204:207], a[188:191], v[144:159]
  v_fma_f32 v188, v188, s42, v224
  v_exp_f32 v186, v186
  v_add_f32 v231, v231, v184
  v_mfma_f32_32x32x16_bf16 v[0:15], a[96:99], v[160:163], v[0:15]
  v_cvt_pk_bf16_f32 v171, v174, v175
  v_fma_f32 v189, v189, s42, v224
  v_exp_f32 v187, v187
  v_mfma_f32_32x32x16_bf16 v[64:79], a[96:99], v[176:179], v[64:79]
  v_add_f32 v232, v232, v185
  v_max3_f32 v233, v128, v129, v130
  v_fma_f32 v190, v190, s42, v224
  v_max3_f32 v234, v131, v132, v133
  v_exp_f32 v188, v188
  v_max3_f32 v235, v134, v135, v136
  v_mfma_f32_32x32x16_bf16 v[16:31], a[100:103], v[160:163], v[16:31]
  v_add_f32 v231, v231, v186
  v_max3_f32 v236, v137, v138, v139
  v_cvt_pk_bf16_f32 v184, v184, v185
  v_max3_f32 v237, v144, v145, v146
  v_fma_f32 v191, v191, s42, v224
  v_exp_f32 v189, v189
  v_mfma_f32_32x32x16_bf16 v[80:95], a[100:103], v[176:179], v[80:95]
  v_add_f32 v232, v232, v187
  v_max3_f32 v238, v147, v148, v149
  v_exp_f32 v190, v190
  v_max3_f32 v239, v150, v151, v152
  v_add_f32 v231, v231, v188
  v_max3_f32 v240, v153, v154, v155
  v_mfma_f32_32x32x16_bf16 v[32:47], a[104:107], v[160:163], v[32:47]
  v_cvt_pk_bf16_f32 v185, v186, v187
  v_max3_f32 v233, v233, v140, v141
  v_exp_f32 v191, v191
  v_max3_f32 v234, v234, v142, v143
  v_add_f32 v232, v232, v189
  v_max3_f32 v237, v237, v156, v157
  v_mfma_f32_32x32x16_bf16 v[96:111], a[104:107], v[176:179], v[96:111]
  v_add_f32 v231, v231, v190
  v_max3_f32 v238, v238, v158, v159
  v_cvt_pk_bf16_f32 v186, v188, v189
  v_max3_f32 v235, v235, v236, v233
  v_add_f32 v232, v232, v191
  v_max3_f32 v239, v239, v240, v237
  v_cvt_pk_bf16_f32 v187, v190, v191
  v_mfma_f32_32x32x16_bf16 v[48:63], a[108:111], v[160:163], v[48:63]
  v_add_f32 v229, v229, v230
  v_add_f32 v231, v231, v232
  v_mov_b32 v230, v229
  v_max_f32 v233, v234, v235
  v_mov_b32 v232, v231
  v_permlane32_swap_b32 v229, v230
  v_mfma_f32_32x32x16_bf16 v[112:127], a[108:111], v[176:179], v[112:127]
  v_permlane32_swap_b32 v231, v232
  v_add_f32 v229, v229, v230
  v_max_f32 v237, v238, v239
  v_add_f32 v231, v231, v232
  v_rcp_f32 v251, v229
  v_mfma_f32_32x32x16_bf16 v[0:15], a[112:115], v[168:171], v[0:15]
  v_rcp_f32 v252, v231
  v_cmp_ngt_f32 s[38:39], s44, v229
  v_mov_b32 v234, v233
  v_mov_b32 v238, v237
  v_cmp_ngt_f32 s[62:63], s44, v231
  s_nop 3
  v_mfma_f32_32x32x16_bf16 v[64:79], a[112:115], v[184:187], v[64:79]
  ds_read_b128 v[192:195], v208 offset:8192
  s_cmp_lg_u64 s[38:39], 0
  s_cselect_b32 s38, 2, 0
  s_or_b32 s45, s45, s38
  s_cmp_lg_u64 s[62:63], 0
  s_cselect_b32 s62, 4, 0
  s_or_b32 s45, s45, s62
  v_mfma_f32_32x32x16_bf16 v[16:31], a[116:119], v[168:171], v[16:31]
  v_permlane32_swap_b32 v233, v234
  v_permlane32_swap_b32 v237, v238
  v_max_f32 v233, v233, v234
  v_max_f32 v237, v237, v238
  v_mfma_f32_32x32x16_bf16 v[80:95], a[116:119], v[184:187], v[80:95]
  ds_read_b128 v[196:199], v209 offset:8192
  v_mul_f32 v221, s43, v233
  v_mul_f32 v0, v0, v251
  v_mul_f32 v222, s43, v237
  v_mul_f32 v1, v1, v251
  v_fma_f32 v128, v128, s42, v221
  v_mul_f32 v2, v2, v251
  v_fma_f32 v129, v129, s42, v221
  v_mul_f32 v3, v3, v251
  v_fma_f32 v130, v130, s42, v221
  v_mul_f32 v4, v4, v251
  v_exp_f32 v128, v128
  v_mul_f32 v5, v5, v251
  v_mul_f32 v6, v6, v251
  v_mul_f32 v7, v7, v251
  v_mfma_f32_32x32x16_bf16 v[32:47], a[120:123], v[168:171], v[32:47]
  v_fma_f32 v131, v131, s42, v221
  v_mul_f32 v8, v8, v251
  v_exp_f32 v129, v129
  v_mul_f32 v9, v9, v251
  v_fma_f32 v132, v132, s42, v221
  v_mul_f32 v10, v10, v251
  v_exp_f32 v130, v130
  v_mul_f32 v11, v11, v251
  v_mul_f32 v12, v12, v251
  v_mul_f32 v13, v13, v251
  v_mul_f32 v14, v14, v251
  v_mul_f32 v15, v15, v251
  v_cvt_pk_bf16_f32 v0, v0, v1
  v_mfma_f32_32x32x16_bf16 v[96:111], a[120:123], v[184:187], v[96:111]
  ds_read_b128 v[200:203], v210 offset:8192
  v_add_f32 v225, 0, v128
  v_cvt_pk_bf16_f32 v1, v2, v3
  v_fma_f32 v133, v133, s42, v221
  v_cvt_pk_bf16_f32 v2, v4, v5
  v_exp_f32 v131, v131
  v_cvt_pk_bf16_f32 v3, v6, v7
  v_add_f32 v226, 0, v129
  v_cvt_pk_bf16_f32 v8, v8, v9
  v_fma_f32 v134, v134, s42, v221
  v_cvt_pk_bf16_f32 v9, v10, v11
  v_cvt_pk_bf16_f32 v10, v12, v13
  v_cvt_pk_bf16_f32 v11, v14, v15
  ds_write_b64 v247, v[0:1]
  v_mfma_f32_32x32x16_bf16 v[48:63], a[124:127], v[168:171], v[48:63]
  v_exp_f32 v132, v132
  ds_write_b64 v248, v[2:3]
  v_add_f32 v225, v225, v130
  ds_write_b64 v255, v[8:9]
  v_cvt_pk_bf16_f32 v128, v128, v129
  ds_write_b64 v254, v[10:11]
  v_fma_f32 v135, v135, s42, v221
  ds_read_b128 a[192:195], v250 offset:0
  v_exp_f32 v133, v133
  ds_read_b128 a[196:199], v250 offset:1024
  v_mfma_f32_32x32x16_bf16 v[112:127], a[124:127], v[184:187], v[112:127]
  ds_read_b128 v[204:207], v211 offset:8192
  v_add_f32 v226, v226, v131
  v_mul_f32 v64, v64, v252
  v_fma_f32 v144, v144, s42, v222
  v_mul_f32 v65, v65, v252
  v_exp_f32 v134, v134
  v_mul_f32 v66, v66, v252
  v_add_f32 v225, v225, v132
  v_mul_f32 v67, v67, v252
  v_mul_f32 v68, v68, v252
  v_mul_f32 v69, v69, v252
  v_mul_f32 v70, v70, v252
  v_mul_f32 v71, v71, v252
  v_mul_f32 v72, v72, v252
  v_mul_f32 v73, v73, v252
  v_mul_f32 v74, v74, v252
  s_waitcnt lgkmcnt(8)
  v_mfma_f32_32x32x16_bf16 v[160:175], v[192:195], a[128:131], 0
  v_cvt_pk_bf16_f32 v129, v130, v131
  v_mul_f32 v75, v75, v252
  v_fma_f32 v145, v145, s42, v222
  v_mul_f32 v76, v76, v252
  v_exp_f32 v135, v135
  v_mul_f32 v77, v77, v252
  v_add_f32 v226, v226, v133
  v_mul_f32 v78, v78, v252
  v_fma_f32 v146, v146, s42, v222
  v_mul_f32 v79, v79, v252
  v_cvt_pk_bf16_f32 v64, v64, v65
  v_cvt_pk_bf16_f32 v65, v66, v67
  v_cvt_pk_bf16_f32 v66, v68, v69
  v_cvt_pk_bf16_f32 v67, v70, v71
  v_cvt_pk_bf16_f32 v72, v72, v73
  v_cvt_pk_bf16_f32 v73, v74, v75
  v_cvt_pk_bf16_f32 v74, v76, v77
  v_cvt_pk_bf16_f32 v75, v78, v79
  v_mfma_f32_32x32x16_bf16 v[176:191], v[192:195], a[160:163], 0
  ds_read_b128 v[192:195], v212 offset:8192
  v_exp_f32 v144, v144
  ds_write_b64 v247, v[64:65]
  v_add_f32 v225, v225, v134
  ds_write_b64 v248, v[66:67]
  v_cvt_pk_bf16_f32 v130, v132, v133
  ds_write_b64 v255, v[72:73]
  v_fma_f32 v147, v147, s42, v222
  ds_write_b64 v254, v[74:75]
  v_exp_f32 v145, v145
  ds_read_b128 a[224:227], v250 offset:0
  ds_read_b128 a[228:231], v250 offset:1024
  v_mfma_f32_32x32x16_bf16 v[160:175], v[196:199], a[132:135], v[160:175]
  v_add_f32 v226, v226, v135
  v_mul_f32 v16, v16, v251
  v_fma_f32 v148, v148, s42, v222
  v_mul_f32 v17, v17, v251
  v_exp_f32 v146, v146
  v_mul_f32 v18, v18, v251
  v_add_f32 v227, 0, v144
  v_mul_f32 v19, v19, v251
  v_cvt_pk_bf16_f32 v131, v134, v135
  v_mul_f32 v20, v20, v251
  v_mul_f32 v21, v21, v251
  v_mul_f32 v22, v22, v251
  v_mul_f32 v23, v23, v251
  v_mul_f32 v24, v24, v251
  v_mfma_f32_32x32x16_bf16 v[176:191], v[196:199], a[164:167], v[176:191]
  ds_read_b128 v[196:199], v213 offset:8192
  v_fma_f32 v149, v149, s42, v222
  v_mul_f32 v25, v25, v251
  v_exp_f32 v147, v147
  v_mul_f32 v26, v26, v251
  v_add_f32 v228, 0, v145
  v_mul_f32 v27, v27, v251
  v_fma_f32 v150, v150, s42, v222
  v_mul_f32 v28, v28, v251
  v_mul_f32 v29, v29, v251
  v_mul_f32 v30, v30, v251
  v_mul_f32 v31, v31, v251
  v_cvt_pk_bf16_f32 v16, v16, v17
  s_waitcnt lgkmcnt(8)
  v_mfma_f32_32x32x16_bf16 v[160:175], v[200:203], a[136:139], v[160:175]
  v_exp_f32 v148, v148
  v_cvt_pk_bf16_f32 v17, v18, v19
  v_add_f32 v227, v227, v146
  v_cvt_pk_bf16_f32 v18, v20, v21
  v_cvt_pk_bf16_f32 v144, v144, v145
  v_cvt_pk_bf16_f32 v19, v22, v23
  v_fma_f32 v151, v151, s42, v222
  v_cvt_pk_bf16_f32 v24, v24, v25
  v_exp_f32 v149, v149
  v_cvt_pk_bf16_f32 v25, v26, v27
  v_cvt_pk_bf16_f32 v26, v28, v29
  v_cvt_pk_bf16_f32 v27, v30, v31
  ds_write_b64 v247, v[16:17]
  v_mfma_f32_32x32x16_bf16 v[176:191], v[200:203], a[168:171], v[176:191]
  ds_read_b128 v[200:203], v214 offset:8192
  v_add_f32 v228, v228, v147
  ds_write_b64 v248, v[18:19]
  v_fma_f32 v136, v136, s42, v221
  ds_write_b64 v255, v[24:25]
  v_exp_f32 v150, v150
  ds_write_b64 v254, v[26:27]
  v_add_f32 v227, v227, v148
  ds_read_b128 a[200:203], v250 offset:0
  v_cvt_pk_bf16_f32 v145, v146, v147
  ds_read_b128 a[204:207], v250 offset:1024
  v_mfma_f32_32x32x16_bf16 v[160:175], v[204:207], a[140:143], v[160:175]
  v_fma_f32 v137, v137, s42, v221
  v_mul_f32 v80, v80, v252
  v_exp_f32 v151, v151
  v_mul_f32 v81, v81, v252
  v_add_f32 v228, v228, v149
  v_mul_f32 v82, v82, v252
  v_fma_f32 v138, v138, s42, v221
  v_mul_f32 v83, v83, v252
  v_exp_f32 v136, v136
  v_mul_f32 v84, v84, v252
  v_mul_f32 v85, v85, v252
  v_mul_f32 v86, v86, v252
  v_mul_f32 v87, v87, v252
  v_mul_f32 v88, v88, v252
  v_mul_f32 v89, v89, v252
  v_mul_f32 v90, v90, v252
  v_mfma_f32_32x32x16_bf16 v[176:191], v[204:207], a[172:175], v[176:191]
  ds_read_b128 v[204:207], v215 offset:8192
  v_add_f32 v227, v227, v150
  v_mul_f32 v91, v91, v252
  v_cvt_pk_bf16_f32 v146, v148, v149
  v_mul_f32 v92, v92, v252
  v_fma_f32 v139, v139, s42, v221
  v_mul_f32 v93, v93, v252
  v_exp_f32 v137, v137
  v_mul_f32 v94, v94, v252
  v_mul_f32 v95, v95, v252
  v_cvt_pk_bf16_f32 v80, v80, v81
  v_cvt_pk_bf16_f32 v81, v82, v83
  v_cvt_pk_bf16_f32 v82, v84, v85
  v_cvt_pk_bf16_f32 v83, v86, v87
  v_cvt_pk_bf16_f32 v88, v88, v89
  v_cvt_pk_bf16_f32 v89, v90, v91
  s_waitcnt lgkmcnt(8)
  v_mfma_f32_32x32x16_bf16 v[160:175], v[192:195], a[144:147], v[160:175]
  v_add_f32 v228, v228, v151
  v_cvt_pk_bf16_f32 v90, v92, v93
  v_fma_f32 v140, v140, s42, v221
  v_cvt_pk_bf16_f32 v91, v94, v95
  v_exp_f32 v138, v138
  ds_write_b64 v247, v[80:81]
  v_add_f32 v225, v225, v136
  ds_write_b64 v248, v[82:83]
  v_cvt_pk_bf16_f32 v147, v150, v151
  ds_write_b64 v255, v[88:89]
  ds_write_b64 v254, v[90:91]
  ds_read_b128 a[232:235], v250 offset:0
  ds_read_b128 a[236:239], v250 offset:1024
  v_mfma_f32_32x32x16_bf16 v[176:191], v[192:195], a[176:179], v[176:191]
  ds_read_b64_tr_b16 v[192:193], v216 offset:0
  ds_read_b64_tr_b16 v[194:195], v216 offset:2048
  v_fma_f32 v141, v141, s42, v221
  v_mul_f32 v32, v32, v251
  v_exp_f32 v139, v139
  v_mul_f32 v33, v33, v251
  v_add_f32 v226, v226, v137
  v_mul_f32 v34, v34, v251
  v_mul_f32 v35, v35, v251
  v_mul_f32 v36, v36, v251
  v_mul_f32 v37, v37, v251
  v_mul_f32 v38, v38, v251
  v_mul_f32 v39, v39, v251
  v_mul_f32 v40, v40, v251
  v_mul_f32 v41, v41, v251
  v_mul_f32 v42, v42, v251
  v_mfma_f32_32x32x16_bf16 v[160:175], v[196:199], a[148:151], v[160:175]
  v_fma_f32 v142, v142, s42, v221
  v_mul_f32 v43, v43, v251
  v_exp_f32 v140, v140
  v_mul_f32 v44, v44, v251
  v_add_f32 v225, v225, v138
  v_mul_f32 v45, v45, v251
  v_cvt_pk_bf16_f32 v136, v136, v137
  v_mul_f32 v46, v46, v251
  v_fma_f32 v143, v143, s42, v221
  v_mul_f32 v47, v47, v251
  v_cvt_pk_bf16_f32 v32, v32, v33
  v_cvt_pk_bf16_f32 v33, v34, v35
  v_cvt_pk_bf16_f32 v34, v36, v37
  v_cvt_pk_bf16_f32 v35, v38, v39
  v_cvt_pk_bf16_f32 v40, v40, v41
  v_cvt_pk_bf16_f32 v41, v42, v43
  v_cvt_pk_bf16_f32 v42, v44, v45
  v_mfma_f32_32x32x16_bf16 v[176:191], v[196:199], a[180:183], v[176:191]
  ds_read_b64_tr_b16 v[196:197], v217 offset:0
  ds_read_b64_tr_b16 v[198:199], v217 offset:2048
  v_exp_f32 v141, v141
  v_cvt_pk_bf16_f32 v43, v46, v47
  v_add_f32 v226, v226, v139
  ds_write_b64 v247, v[32:33]
  ds_write_b64 v248, v[34:35]
  ds_write_b64 v255, v[40:41]
  ds_write_b64 v254, v[42:43]
  ds_read_b128 a[208:211], v250 offset:0
  ds_read_b128 a[212:215], v250 offset:1024
  s_waitcnt lgkmcnt(15)
  v_mfma_f32_32x32x16_bf16 v[160:175], v[200:203], a[152:155], v[160:175]
  v_fma_f32 v152, v152, s42, v222
  v_mul_f32 v96, v96, v252
  v_exp_f32 v142, v142
  v_mul_f32 v97, v97, v252
  v_add_f32 v225, v225, v140
  v_mul_f32 v98, v98, v252
  v_cvt_pk_bf16_f32 v137, v138, v139
  v_mul_f32 v99, v99, v252
  v_fma_f32 v153, v153, s42, v222
  v_mul_f32 v100, v100, v252
  v_mul_f32 v101, v101, v252
  v_mul_f32 v102, v102, v252
  v_mul_f32 v103, v103, v252
  v_mfma_f32_32x32x16_bf16 v[176:191], v[200:203], a[184:187], v[176:191]
  ds_read_b64_tr_b16 v[200:201], v218 offset:0
  ds_read_b64_tr_b16 v[202:203], v218 offset:2048
  v_exp_f32 v143, v143
  v_mul_f32 v104, v104, v252
  v_add_f32 v226, v226, v141
  v_mul_f32 v105, v105, v252
  v_fma_f32 v154, v154, s42, v222
  v_mul_f32 v106, v106, v252
  v_mul_f32 v107, v107, v252
  v_mul_f32 v108, v108, v252
  v_mul_f32 v109, v109, v252
  v_mul_f32 v110, v110, v252
  v_mul_f32 v111, v111, v252
  v_cvt_pk_bf16_f32 v96, v96, v97
  v_mfma_f32_32x32x16_bf16 v[160:175], v[204:207], a[156:159], v[160:175]
  v_exp_f32 v152, v152
  v_cvt_pk_bf16_f32 v97, v98, v99
  v_add_f32 v225, v225, v142
  v_cvt_pk_bf16_f32 v98, v100, v101
  v_cvt_pk_bf16_f32 v138, v140, v141
  v_cvt_pk_bf16_f32 v99, v102, v103
  v_fma_f32 v155, v155, s42, v222
  v_cvt_pk_bf16_f32 v104, v104, v105
  v_cvt_pk_bf16_f32 v105, v106, v107
  v_cvt_pk_bf16_f32 v106, v108, v109
  v_cvt_pk_bf16_f32 v107, v110, v111
  ds_write_b64 v247, v[96:97]
  v_mfma_f32_32x32x16_bf16 v[176:191], v[204:207], a[188:191], v[176:191]
  ds_read_b64_tr_b16 v[204:205], v219 offset:0
  ds_read_b64_tr_b16 v[206:207], v219 offset:2048
  v_exp_f32 v153, v153
  ds_write_b64 v248, v[98:99]
  v_add_f32 v226, v226, v143
  ds_write_b64 v255, v[104:105]
  ds_write_b64 v254, v[106:107]
  ds_read_b128 a[240:243], v250 offset:0
  ds_read_b128 a[244:247], v250 offset:1024
  s_waitcnt lgkmcnt(10)
  v_mfma_f32_32x32x16_bf16 v[0:15], v[192:195], v[128:131], 0
  v_fma_f32 v156, v156, s42, v222
  v_mul_f32 v48, v48, v251
  v_exp_f32 v154, v154
  v_mul_f32 v49, v49, v251
  v_add_f32 v227, v227, v152
  v_mul_f32 v50, v50, v251
  v_cvt_pk_bf16_f32 v139, v142, v143
  v_mul_f32 v51, v51, v251
  v_fma_f32 v157, v157, s42, v222
  v_mul_f32 v52, v52, v251
  v_mul_f32 v53, v53, v251
  v_mul_f32 v54, v54, v251
  v_mul_f32 v55, v55, v251
  v_mul_f32 v56, v56, v251
  v_mul_f32 v57, v57, v251
  v_mul_f32 v58, v58, v251
  v_mul_f32 v59, v59, v251
  v_mfma_f32_32x32x16_bf16 v[64:79], v[192:195], v[144:147], 0
  ds_read_b64_tr_b16 v[192:193], v216 offset:4096
  ds_read_b64_tr_b16 v[194:195], v216 offset:6144
  v_exp_f32 v155, v155
  v_mul_f32 v60, v60, v251
  v_add_f32 v228, v228, v153
  v_mul_f32 v61, v61, v251
  v_fma_f32 v158, v158, s42, v222
  v_mul_f32 v62, v62, v251
  v_mul_f32 v63, v63, v251
  v_cvt_pk_bf16_f32 v48, v48, v49
  v_cvt_pk_bf16_f32 v49, v50, v51
  v_cvt_pk_bf16_f32 v50, v52, v53
  v_cvt_pk_bf16_f32 v51, v54, v55
  v_cvt_pk_bf16_f32 v56, v56, v57
  v_cvt_pk_bf16_f32 v57, v58, v59
  v_cvt_pk_bf16_f32 v58, v60, v61
  v_mfma_f32_32x32x16_bf16 v[16:31], v[196:199], v[128:131], 0
  v_exp_f32 v156, v156
  v_cvt_pk_bf16_f32 v59, v62, v63
  v_add_f32 v227, v227, v154
  ds_write_b64 v247, v[48:49]
  v_cvt_pk_bf16_f32 v152, v152, v153
  ds_write_b64 v248, v[50:51]
  v_fma_f32 v159, v159, s42, v222
  ds_write_b64 v255, v[56:57]
  v_exp_f32 v157, v157
  ds_write_b64 v254, v[58:59]
  ds_read_b128 a[216:219], v250 offset:0
  ds_read_b128 a[220:223], v250 offset:1024
  v_mfma_f32_32x32x16_bf16 v[80:95], v[196:199], v[144:147], 0
  ds_read_b64_tr_b16 v[196:197], v217 offset:4096
  ds_read_b64_tr_b16 v[198:199], v217 offset:6144
  v_add_f32 v228, v228, v155
  v_mul_f32 v112, v112, v252
  v_exp_f32 v158, v158
  v_mul_f32 v113, v113, v252
  v_mul_f32 v114, v114, v252
  v_mul_f32 v115, v115, v252
  v_mul_f32 v116, v116, v252
  v_mul_f32 v117, v117, v252
  v_mul_f32 v118, v118, v252
  v_mul_f32 v119, v119, v252
  v_mul_f32 v120, v120, v252
  v_mul_f32 v121, v121, v252
  v_mul_f32 v122, v122, v252
  s_waitcnt lgkmcnt(10)
  v_mfma_f32_32x32x16_bf16 v[32:47], v[200:203], v[128:131], 0
  v_add_f32 v227, v227, v156
  v_fma_f32 v160, v160, s42, v221
  v_mul_f32 v123, v123, v252
  v_cvt_pk_bf16_f32 v153, v154, v155
  v_mul_f32 v124, v124, v252
  v_exp_f32 v159, v159
  v_mul_f32 v125, v125, v252
  v_add_f32 v228, v228, v157
  v_mul_f32 v126, v126, v252
  v_mul_f32 v127, v127, v252
  v_cvt_pk_bf16_f32 v112, v112, v113
  v_cvt_pk_bf16_f32 v113, v114, v115
  v_cvt_pk_bf16_f32 v114, v116, v117
  v_cvt_pk_bf16_f32 v115, v118, v119
  v_cvt_pk_bf16_f32 v120, v120, v121
  v_cvt_pk_bf16_f32 v121, v122, v123
  v_cvt_pk_bf16_f32 v122, v124, v125
  v_mfma_f32_32x32x16_bf16 v[96:111], v[200:203], v[144:147], 0
  ds_read_b64_tr_b16 v[200:201], v218 offset:4096
  ds_read_b64_tr_b16 v[202:203], v218 offset:6144
  v_add_f32 v227, v227, v158
  v_cvt_pk_bf16_f32 v123, v126, v127
  v_cvt_pk_bf16_f32 v154, v156, v157
  ds_write_b64 v247, v[112:113]
  v_add_f32 v228, v228, v159
  ds_write_b64 v248, v[114:115]
  v_cvt_pk_bf16_f32 v155, v158, v159
  ds_write_b64 v255, v[120:121]
  ds_write_b64 v254, v[122:123]
  ds_read_b128 a[248:251], v250 offset:0
  ds_read_b128 a[252:255], v250 offset:1024
  v_mfma_f32_32x32x16_bf16 v[48:63], v[204:207], v[128:131], 0
  v_fma_f32 v161, v161, s42, v221
  v_fma_f32 v162, v162, s42, v221
  v_exp_f32 v160, v160
  v_fma_f32 v163, v163, s42, v221
  v_mfma_f32_32x32x16_bf16 v[112:127], v[204:207], v[144:147], 0
  ds_read_b64_tr_b16 v[204:205], v219 offset:4096
  ds_read_b64_tr_b16 v[206:207], v219 offset:6144
  v_exp_f32 v161, v161
  v_fma_f32 v164, v164, s42, v221
  s_waitcnt lgkmcnt(10)
  v_mfma_f32_32x32x16_bf16 v[0:15], v[192:195], v[136:139], v[0:15]
  v_exp_f32 v162, v162
  v_add_f32 v225, v225, v160
  v_fma_f32 v165, v165, s42, v221
  v_exp_f32 v163, v163
  v_mfma_f32_32x32x16_bf16 v[64:79], v[192:195], v[152:155], v[64:79]
  ds_read_b128 v[192:195], v208 offset:16384
  v_add_f32 v226, v226, v161
  v_fma_f32 v166, v166, s42, v221
  v_exp_f32 v164, v164
  v_add_f32 v225, v225, v162
  v_mfma_f32_32x32x16_bf16 v[16:31], v[196:199], v[136:139], v[16:31]
  buffer_store_dwordx4 a[192:195], v249, s[32:35], s47 offen offset:0 sc1
  v_cvt_pk_bf16_f32 v160, v160, v161
  v_fma_f32 v167, v167, s42, v221
  v_exp_f32 v165, v165
  v_add_f32 v226, v226, v163
  v_mfma_f32_32x32x16_bf16 v[80:95], v[196:199], v[152:155], v[80:95]
  ds_read_b128 v[196:199], v209 offset:16384
  v_fma_f32 v176, v176, s42, v222
  v_exp_f32 v166, v166
  v_add_f32 v225, v225, v164
  s_waitcnt lgkmcnt(2)
  v_mfma_f32_32x32x16_bf16 v[32:47], v[200:203], v[136:139], v[32:47]
  v_cvt_pk_bf16_f32 v161, v162, v163
  v_fma_f32 v177, v177, s42, v222
  v_exp_f32 v167, v167
  v_add_f32 v226, v226, v165
  v_mfma_f32_32x32x16_bf16 v[96:111], v[200:203], v[152:155], v[96:111]
  ds_read_b128 v[200:203], v210 offset:16384
  v_fma_f32 v178, v178, s42, v222
  v_exp_f32 v176, v176
  v_add_f32 v225, v225, v166
  v_cvt_pk_bf16_f32 v162, v164, v165
  v_mfma_f32_32x32x16_bf16 v[48:63], v[204:207], v[136:139], v[48:63]
  v_fma_f32 v179, v179, s42, v222
  v_exp_f32 v177, v177
  v_add_f32 v226, v226, v167
  v_fma_f32 v180, v180, s42, v222
  v_mfma_f32_32x32x16_bf16 v[112:127], v[204:207], v[152:155], v[112:127]
  ds_read_b128 v[204:207], v211 offset:16384
  v_exp_f32 v178, v178
  v_add_f32 v227, v227, v176
  v_cvt_pk_bf16_f32 v163, v166, v167
  v_fma_f32 v181, v181, s42, v222
  s_waitcnt lgkmcnt(2)
  v_mfma_f32_32x32x16_bf16 v[128:143], v[192:195], a[128:131], 0
  v_exp_f32 v179, v179
  v_add_f32 v228, v228, v177
  v_fma_f32 v182, v182, s42, v222
  v_exp_f32 v180, v180
  v_mfma_f32_32x32x16_bf16 v[144:159], v[192:195], a[160:163], 0
  ds_read_b128 v[192:195], v212 offset:16384
  v_add_f32 v227, v227, v178
  v_cvt_pk_bf16_f32 v176, v176, v177
  v_fma_f32 v183, v183, s42, v222
  v_exp_f32 v181, v181
  v_mfma_f32_32x32x16_bf16 v[128:143], v[196:199], a[132:135], v[128:143]
  v_add_f32 v228, v228, v179
  v_fma_f32 v168, v168, s42, v221
  v_exp_f32 v182, v182
  v_add_f32 v227, v227, v180
  v_mfma_f32_32x32x16_bf16 v[144:159], v[196:199], a[164:167], v[144:159]
  ds_read_b128 v[196:199], v213 offset:16384
  v_cvt_pk_bf16_f32 v177, v178, v179
  v_fma_f32 v169, v169, s42, v221
  v_exp_f32 v183, v183
  s_waitcnt lgkmcnt(2)
  v_mfma_f32_32x32x16_bf16 v[128:143], v[200:203], a[136:139], v[128:143]
  buffer_store_dwordx4 a[200:203], v249, s[32:35], s47 offen offset:64 sc1
  v_add_f32 v228, v228, v181
  v_fma_f32 v170, v170, s42, v221
  v_exp_f32 v168, v168
  v_add_f32 v227, v227, v182
  v_mfma_f32_32x32x16_bf16 v[144:159], v[200:203], a[168:171], v[144:159]
  ds_read_b128 v[200:203], v214 offset:16384
  v_cvt_pk_bf16_f32 v178, v180, v181
  v_fma_f32 v171, v171, s42, v221
  v_exp_f32 v169, v169
  v_mfma_f32_32x32x16_bf16 v[128:143], v[204:207], a[140:143], v[128:143]
  v_add_f32 v228, v228, v183
  v_fma_f32 v172, v172, s42, v221
  v_exp_f32 v170, v170
  v_add_f32 v225, v225, v168
  v_cvt_pk_bf16_f32 v179, v182, v183
  v_mfma_f32_32x32x16_bf16 v[144:159], v[204:207], a[172:175], v[144:159]
  ds_read_b128 v[204:207], v215 offset:16384
  v_fma_f32 v173, v173, s42, v221
  v_exp_f32 v171, v171
  s_waitcnt lgkmcnt(2)
  v_mfma_f32_32x32x16_bf16 v[128:143], v[192:195], a[144:147], v[128:143]
  v_add_f32 v226, v226, v169
  v_fma_f32 v174, v174, s42, v221
  v_exp_f32 v172, v172
  v_add_f32 v225, v225, v170
  v_cvt_pk_bf16_f32 v168, v168, v169
  v_mfma_f32_32x32x16_bf16 v[144:159], v[192:195], a[176:179], v[144:159]
  ds_read_b64_tr_b16 v[192:193], v216 offset:8192
  ds_read_b64_tr_b16 v[194:195], v216 offset:10240
  v_fma_f32 v175, v175, s42, v221
  v_exp_f32 v173, v173
  v_mfma_f32_32x32x16_bf16 v[128:143], v[196:199], a[148:151], v[128:143]
  v_add_f32 v226, v226, v171
  v_fma_f32 v184, v184, s42, v222
  v_exp_f32 v174, v174
  v_add_f32 v225, v225, v172
  v_mfma_f32_32x32x16_bf16 v[144:159], v[196:199], a[180:183], v[144:159]
  ds_read_b64_tr_b16 v[196:197], v217 offset:8192
  ds_read_b64_tr_b16 v[198:199], v217 offset:10240
  v_cvt_pk_bf16_f32 v169, v170, v171
  v_fma_f32 v185, v185, s42, v222
  s_waitcnt lgkmcnt(4)
  v_mfma_f32_32x32x16_bf16 v[128:143], v[200:203], a[152:155], v[128:143]
  v_exp_f32 v175, v175
  v_add_f32 v226, v226, v173
  v_fma_f32 v186, v186, s42, v222
  v_exp_f32 v184, v184
  v_mfma_f32_32x32x16_bf16 v[144:159], v[200:203], a[184:187], v[144:159]
  ds_read_b64_tr_b16 v[200:201], v218 offset:8192
  ds_read_b64_tr_b16 v[202:203], v218 offset:10240
  v_add_f32 v225, v225, v174
  v_cvt_pk_bf16_f32 v170, v172, v173
  v_fma_f32 v187, v187, s42, v222
  v_mfma_f32_32x32x16_bf16 v[128:143], v[204:207], a[156:159], v[128:143]
  buffer_store_dwordx4 a[224:227], v249, s[32:35], s48 offen offset:0 sc1
  v_exp_f32 v185, v185
  v_add_f32 v226, v226, v175
  v_fma_f32 v188, v188, s42, v222
  v_mfma_f32_32x32x16_bf16 v[144:159], v[204:207], a[188:191], v[144:159]
  ds_read_b64_tr_b16 v[204:205], v219 offset:8192
  ds_read_b64_tr_b16 v[206:207], v219 offset:10240
  v_exp_f32 v186, v186
  v_add_f32 v227, v227, v184
  s_waitcnt lgkmcnt(4)
  v_mfma_f32_32x32x16_bf16 v[0:15], v[192:195], v[160:163], v[0:15]
  v_cvt_pk_bf16_f32 v171, v174, v175
  v_fma_f32 v189, v189, s42, v222
  v_exp_f32 v187, v187
  v_add_f32 v228, v228, v185
  v_mfma_f32_32x32x16_bf16 v[64:79], v[192:195], v[176:179], v[64:79]
  ds_read_b64_tr_b16 v[192:193], v216 offset:12288
  ds_read_b64_tr_b16 v[194:195], v216 offset:14336
  v_fma_f32 v190, v190, s42, v222
  v_exp_f32 v188, v188
  v_add_f32 v227, v227, v186
  v_mfma_f32_32x32x16_bf16 v[16:31], v[196:199], v[160:163], v[16:31]
  v_cvt_pk_bf16_f32 v184, v184, v185
  v_fma_f32 v128, v128, s42, v221
  v_fma_f32 v191, v191, s42, v222
  v_exp_f32 v189, v189
  v_add_f32 v228, v228, v187
  v_mfma_f32_32x32x16_bf16 v[80:95], v[196:199], v[176:179], v[80:95]
  ds_read_b64_tr_b16 v[196:197], v217 offset:12288
  ds_read_b64_tr_b16 v[198:199], v217 offset:14336
  v_exp_f32 v190, v190
  v_fma_f32 v129, v129, s42, v221
  s_waitcnt lgkmcnt(4)
  v_mfma_f32_32x32x16_bf16 v[32:47], v[200:203], v[160:163], v[32:47]
  v_add_f32 v227, v227, v188
  v_cvt_pk_bf16_f32 v185, v186, v187
  v_exp_f32 v191, v191
  v_add_f32 v228, v228, v189
  v_add_f32 v227, v227, v190
  v_mfma_f32_32x32x16_bf16 v[96:111], v[200:203], v[176:179], v[96:111]
  ds_read_b64_tr_b16 v[200:201], v218 offset:12288
  ds_read_b64_tr_b16 v[202:203], v218 offset:14336
  v_cvt_pk_bf16_f32 v186, v188, v189
  v_fma_f32 v130, v130, s42, v221
  v_add_f32 v228, v228, v191
  v_cvt_pk_bf16_f32 v187, v190, v191
  v_mfma_f32_32x32x16_bf16 v[48:63], v[204:207], v[160:163], v[48:63]
  v_exp_f32 v128, v128
  v_fma_f32 v131, v131, s42, v221
  v_exp_f32 v129, v129
  v_mfma_f32_32x32x16_bf16 v[112:127], v[204:207], v[176:179], v[112:127]
  ds_read_b64_tr_b16 v[204:205], v219 offset:12288
  ds_read_b64_tr_b16 v[206:207], v219 offset:14336
  v_fma_f32 v132, v132, s42, v221
  v_exp_f32 v130, v130
  s_waitcnt lgkmcnt(4)
  v_mfma_f32_32x32x16_bf16 v[0:15], v[192:195], v[168:171], v[0:15]
  buffer_store_dwordx4 a[232:235], v249, s[32:35], s48 offen offset:64 sc1
  v_add_f32 v225, v225, v128
  v_fma_f32 v133, v133, s42, v221
  v_exp_f32 v131, v131
  v_add_f32 v226, v226, v129
  v_mfma_f32_32x32x16_bf16 v[64:79], v[192:195], v[184:187], v[64:79]
  ds_read_b128 v[192:195], v208 offset:24576
  v_fma_f32 v134, v134, s42, v221
  v_exp_f32 v132, v132
  v_add_f32 v225, v225, v130
  v_cvt_pk_bf16_f32 v128, v128, v129
  v_mfma_f32_32x32x16_bf16 v[16:31], v[196:199], v[168:171], v[16:31]
  v_fma_f32 v135, v135, s42, v221
  v_exp_f32 v133, v133
  v_add_f32 v226, v226, v131
  v_fma_f32 v144, v144, s42, v222
  v_mfma_f32_32x32x16_bf16 v[80:95], v[196:199], v[184:187], v[80:95]
  ds_read_b128 v[196:199], v209 offset:24576
  v_exp_f32 v134, v134
  v_add_f32 v225, v225, v132
  v_cvt_pk_bf16_f32 v129, v130, v131
  s_waitcnt lgkmcnt(2)
  v_mfma_f32_32x32x16_bf16 v[32:47], v[200:203], v[168:171], v[32:47]
  v_fma_f32 v145, v145, s42, v222
  v_exp_f32 v135, v135
  v_add_f32 v226, v226, v133
  v_fma_f32 v146, v146, s42, v222
  v_mfma_f32_32x32x16_bf16 v[96:111], v[200:203], v[184:187], v[96:111]
  ds_read_b128 v[200:203], v210 offset:24576
  v_exp_f32 v144, v144
  v_add_f32 v225, v225, v134
  v_cvt_pk_bf16_f32 v130, v132, v133
  v_fma_f32 v147, v147, s42, v222
  v_mfma_f32_32x32x16_bf16 v[48:63], v[204:207], v[168:171], v[48:63]
  v_exp_f32 v145, v145
  v_add_f32 v226, v226, v135
  v_fma_f32 v148, v148, s42, v222
  v_exp_f32 v146, v146
  v_mfma_f32_32x32x16_bf16 v[112:127], v[204:207], v[184:187], v[112:127]
  ds_read_b128 v[204:207], v211 offset:24576
  v_add_f32 v227, v227, v144
  v_cvt_pk_bf16_f32 v131, v134, v135
  v_fma_f32 v149, v149, s42, v222
  s_waitcnt lgkmcnt(2)
  v_mfma_f32_32x32x16_bf16 v[160:175], v[192:195], a[128:131], 0
  v_exp_f32 v147, v147
  v_add_f32 v228, v228, v145
  v_fma_f32 v150, v150, s42, v222
  v_exp_f32 v148, v148
  v_mfma_f32_32x32x16_bf16 v[176:191], v[192:195], a[160:163], 0
  ds_read_b128 v[192:195], v212 offset:24576
  v_add_f32 v227, v227, v146
  v_cvt_pk_bf16_f32 v144, v144, v145
  v_fma_f32 v151, v151, s42, v222
  v_exp_f32 v149, v149
  v_mfma_f32_32x32x16_bf16 v[160:175], v[196:199], a[132:135], v[160:175]
  buffer_store_dwordx4 a[196:199], v249, s[32:35], s53 offen offset:0 sc1
  v_add_f32 v228, v228, v147
  v_fma_f32 v136, v136, s42, v221
  v_exp_f32 v150, v150
  v_mfma_f32_32x32x16_bf16 v[176:191], v[196:199], a[164:167], v[176:191]
  ds_read_b128 v[196:199], v213 offset:24576
  v_add_f32 v227, v227, v148
  v_cvt_pk_bf16_f32 v145, v146, v147
  v_fma_f32 v137, v137, s42, v221
  v_exp_f32 v151, v151
  s_waitcnt lgkmcnt(2)
  v_mfma_f32_32x32x16_bf16 v[160:175], v[200:203], a[136:139], v[160:175]
  v_add_f32 v228, v228, v149
  v_fma_f32 v138, v138, s42, v221
  v_exp_f32 v136, v136
  v_add_f32 v227, v227, v150
  v_mfma_f32_32x32x16_bf16 v[176:191], v[200:203], a[168:171], v[176:191]
  ds_read_b128 v[200:203], v214 offset:24576
  v_cvt_pk_bf16_f32 v146, v148, v149
  v_fma_f32 v139, v139, s42, v221
  v_exp_f32 v137, v137
  v_mfma_f32_32x32x16_bf16 v[160:175], v[204:207], a[140:143], v[160:175]
  v_add_f32 v228, v228, v151
  v_fma_f32 v140, v140, s42, v221
  v_exp_f32 v138, v138
  v_add_f32 v225, v225, v136
  v_cvt_pk_bf16_f32 v147, v150, v151
  v_mfma_f32_32x32x16_bf16 v[176:191], v[204:207], a[172:175], v[176:191]
  ds_read_b128 v[204:207], v215 offset:24576
  v_fma_f32 v141, v141, s42, v221
  v_exp_f32 v139, v139
  s_waitcnt lgkmcnt(2)
  v_mfma_f32_32x32x16_bf16 v[160:175], v[192:195], a[144:147], v[160:175]
  v_add_f32 v226, v226, v137
  v_fma_f32 v142, v142, s42, v221
  v_exp_f32 v140, v140
  v_add_f32 v225, v225, v138
  v_cvt_pk_bf16_f32 v136, v136, v137
  v_mfma_f32_32x32x16_bf16 v[176:191], v[192:195], a[176:179], v[176:191]
  ds_read_b64_tr_b16 v[192:193], v216 offset:16384
  ds_read_b64_tr_b16 v[194:195], v216 offset:18432
  v_fma_f32 v143, v143, s42, v221
  v_exp_f32 v141, v141
  v_mfma_f32_32x32x16_bf16 v[160:175], v[196:199], a[148:151], v[160:175]
  v_add_f32 v226, v226, v139
  v_fma_f32 v152, v152, s42, v222
  v_exp_f32 v142, v142
  v_add_f32 v225, v225, v140
  v_mfma_f32_32x32x16_bf16 v[176:191], v[196:199], a[180:183], v[176:191]
  ds_read_b64_tr_b16 v[196:197], v217 offset:16384
  ds_read_b64_tr_b16 v[198:199], v217 offset:18432
  v_cvt_pk_bf16_f32 v137, v138, v139
  v_fma_f32 v153, v153, s42, v222
  s_waitcnt lgkmcnt(4)
  v_mfma_f32_32x32x16_bf16 v[160:175], v[200:203], a[152:155], v[160:175]
  buffer_store_dwordx4 a[204:207], v249, s[32:35], s53 offen offset:64 sc1
  v_exp_f32 v143, v143
  v_add_f32 v226, v226, v141
  v_fma_f32 v154, v154, s42, v222
  v_exp_f32 v152, v152
  v_mfma_f32_32x32x16_bf16 v[176:191], v[200:203], a[184:187], v[176:191]
  ds_read_b64_tr_b16 v[200:201], v218 offset:16384
  ds_read_b64_tr_b16 v[202:203], v218 offset:18432
  v_add_f32 v225, v225, v142
  v_cvt_pk_bf16_f32 v138, v140, v141
  v_mfma_f32_32x32x16_bf16 v[160:175], v[204:207], a[156:159], v[160:175]
  v_fma_f32 v155, v155, s42, v222
  v_exp_f32 v153, v153
  v_add_f32 v226, v226, v143
  v_fma_f32 v156, v156, s42, v222
  v_mfma_f32_32x32x16_bf16 v[176:191], v[204:207], a[188:191], v[176:191]
  ds_read_b64_tr_b16 v[204:205], v219 offset:16384
  ds_read_b64_tr_b16 v[206:207], v219 offset:18432
  v_exp_f32 v154, v154
  v_add_f32 v227, v227, v152
  s_waitcnt lgkmcnt(4)
  v_mfma_f32_32x32x16_bf16 v[0:15], v[192:195], v[128:131], v[0:15]
  v_cvt_pk_bf16_f32 v139, v142, v143
  v_fma_f32 v157, v157, s42, v222
  v_exp_f32 v155, v155
  v_add_f32 v228, v228, v153
  v_mfma_f32_32x32x16_bf16 v[64:79], v[192:195], v[144:147], v[64:79]
  ds_read_b64_tr_b16 v[192:193], v216 offset:20480
  ds_read_b64_tr_b16 v[194:195], v216 offset:22528
  v_fma_f32 v158, v158, s42, v222
  v_exp_f32 v156, v156
  v_add_f32 v227, v227, v154
  v_mfma_f32_32x32x16_bf16 v[16:31], v[196:199], v[128:131], v[16:31]
  v_cvt_pk_bf16_f32 v152, v152, v153
  v_fma_f32 v160, v160, s42, v221
  v_fma_f32 v159, v159, s42, v222
  v_exp_f32 v157, v157
  v_add_f32 v228, v228, v155
  v_mfma_f32_32x32x16_bf16 v[80:95], v[196:199], v[144:147], v[80:95]
  ds_read_b64_tr_b16 v[196:197], v217 offset:20480
  ds_read_b64_tr_b16 v[198:199], v217 offset:22528
  v_exp_f32 v158, v158
  v_fma_f32 v161, v161, s42, v221
  s_waitcnt lgkmcnt(4)
  v_mfma_f32_32x32x16_bf16 v[32:47], v[200:203], v[128:131], v[32:47]
  v_add_f32 v227, v227, v156
  v_cvt_pk_bf16_f32 v153, v154, v155
  v_exp_f32 v159, v159
  v_add_f32 v228, v228, v157
  v_add_f32 v227, v227, v158
  v_mfma_f32_32x32x16_bf16 v[96:111], v[200:203], v[144:147], v[96:111]
  ds_read_b64_tr_b16 v[200:201], v218 offset:20480
  ds_read_b64_tr_b16 v[202:203], v218 offset:22528
  v_cvt_pk_bf16_f32 v154, v156, v157
  v_fma_f32 v162, v162, s42, v221
  v_add_f32 v228, v228, v159
  v_cvt_pk_bf16_f32 v155, v158, v159
  v_mfma_f32_32x32x16_bf16 v[48:63], v[204:207], v[128:131], v[48:63]
  buffer_store_dwordx4 a[228:231], v249, s[32:35], s54 offen offset:0 sc1
  v_exp_f32 v160, v160
  v_fma_f32 v163, v163, s42, v221
  v_exp_f32 v161, v161
  v_mfma_f32_32x32x16_bf16 v[112:127], v[204:207], v[144:147], v[112:127]
  ds_read_b64_tr_b16 v[204:205], v219 offset:20480
  ds_read_b64_tr_b16 v[206:207], v219 offset:22528
  v_fma_f32 v164, v164, s42, v221
  v_exp_f32 v162, v162
  s_waitcnt lgkmcnt(4)
  v_mfma_f32_32x32x16_bf16 v[0:15], v[192:195], v[136:139], v[0:15]
  v_add_f32 v225, v225, v160
  v_fma_f32 v165, v165, s42, v221
  v_exp_f32 v163, v163
  s_waitcnt vmcnt(7)
  s_barrier
  v_mfma_f32_32x32x16_bf16 v[64:79], v[192:195], v[152:155], v[64:79]
  ds_read_b128 v[192:195], v208 offset:32768
  v_add_f32 v226, v226, v161
  v_fma_f32 v166, v166, s42, v221
  v_exp_f32 v164, v164
  v_mfma_f32_32x32x16_bf16 v[16:31], v[196:199], v[136:139], v[16:31]
  v_add_f32 v225, v225, v162
  v_cvt_pk_bf16_f32 v160, v160, v161
  v_fma_f32 v167, v167, s42, v221
  v_exp_f32 v165, v165
  v_add_f32 v226, v226, v163
  v_mfma_f32_32x32x16_bf16 v[80:95], v[196:199], v[152:155], v[80:95]
  ds_read_b128 v[196:199], v209 offset:32768
  v_fma_f32 v176, v176, s42, v222
  v_exp_f32 v166, v166
  v_add_f32 v225, v225, v164
  s_waitcnt lgkmcnt(2)
  v_mfma_f32_32x32x16_bf16 v[32:47], v[200:203], v[136:139], v[32:47]
  v_cvt_pk_bf16_f32 v161, v162, v163
  v_fma_f32 v177, v177, s42, v222
  v_exp_f32 v167, v167
  v_add_f32 v226, v226, v165
  v_mfma_f32_32x32x16_bf16 v[96:111], v[200:203], v[152:155], v[96:111]
  ds_read_b128 v[200:203], v210 offset:32768
  v_fma_f32 v178, v178, s42, v222
  v_exp_f32 v176, v176
  v_add_f32 v225, v225, v166
  v_cvt_pk_bf16_f32 v162, v164, v165
  v_mfma_f32_32x32x16_bf16 v[48:63], v[204:207], v[136:139], v[48:63]
  v_fma_f32 v179, v179, s42, v222
  v_exp_f32 v177, v177
  v_add_f32 v226, v226, v167
  v_fma_f32 v180, v180, s42, v222
  v_mfma_f32_32x32x16_bf16 v[112:127], v[204:207], v[152:155], v[112:127]
  ds_read_b128 v[204:207], v211 offset:32768
  v_exp_f32 v178, v178
  v_add_f32 v227, v227, v176
  v_cvt_pk_bf16_f32 v163, v166, v167
  v_fma_f32 v181, v181, s42, v222
  s_waitcnt lgkmcnt(2)
  v_mfma_f32_32x32x16_bf16 v[128:143], v[192:195], a[128:131], 0
  buffer_store_dwordx4 a[236:239], v249, s[32:35], s54 offen offset:64 sc1
  v_exp_f32 v179, v179
  v_add_f32 v228, v228, v177
  v_fma_f32 v182, v182, s42, v222
  v_mfma_f32_32x32x16_bf16 v[144:159], v[192:195], a[160:163], 0
  ds_read_b128 v[192:195], v212 offset:32768
  v_exp_f32 v180, v180
  v_add_f32 v227, v227, v178
  v_cvt_pk_bf16_f32 v176, v176, v177
  v_fma_f32 v183, v183, s42, v222
  v_mfma_f32_32x32x16_bf16 v[128:143], v[196:199], a[132:135], v[128:143]
  v_exp_f32 v181, v181
  v_add_f32 v228, v228, v179
  v_fma_f32 v168, v168, s42, v221
  v_exp_f32 v182, v182
  v_mfma_f32_32x32x16_bf16 v[144:159], v[196:199], a[164:167], v[144:159]
  ds_read_b128 v[196:199], v213 offset:32768
  v_add_f32 v227, v227, v180
  v_cvt_pk_bf16_f32 v177, v178, v179
  v_fma_f32 v169, v169, s42, v221
  s_waitcnt lgkmcnt(2)
  v_mfma_f32_32x32x16_bf16 v[128:143], v[200:203], a[136:139], v[128:143]
  v_exp_f32 v183, v183
  v_add_f32 v228, v228, v181
  v_fma_f32 v170, v170, s42, v221
  v_exp_f32 v168, v168
  v_add_f32 v227, v227, v182
  v_mfma_f32_32x32x16_bf16 v[144:159], v[200:203], a[168:171], v[144:159]
  ds_read_b128 v[200:203], v214 offset:32768
  v_cvt_pk_bf16_f32 v178, v180, v181
  v_fma_f32 v171, v171, s42, v221
  v_exp_f32 v169, v169
  v_mfma_f32_32x32x16_bf16 v[128:143], v[204:207], a[140:143], v[128:143]
  v_add_f32 v228, v228, v183
  v_fma_f32 v172, v172, s42, v221
  v_exp_f32 v170, v170
  v_add_f32 v225, v225, v168
  v_cvt_pk_bf16_f32 v179, v182, v183
  v_mfma_f32_32x32x16_bf16 v[144:159], v[204:207], a[172:175], v[144:159]
  ds_read_b128 v[204:207], v215 offset:32768
  v_fma_f32 v173, v173, s42, v221
  v_exp_f32 v171, v171
  s_waitcnt lgkmcnt(2)
  v_mfma_f32_32x32x16_bf16 v[128:143], v[192:195], a[144:147], v[128:143]
  v_add_f32 v226, v226, v169
  v_fma_f32 v174, v174, s42, v221
  v_exp_f32 v172, v172
  v_add_f32 v225, v225, v170
  v_cvt_pk_bf16_f32 v168, v168, v169
  v_mfma_f32_32x32x16_bf16 v[144:159], v[192:195], a[176:179], v[144:159]
  ds_read_b64_tr_b16 v[192:193], v216 offset:24576
  ds_read_b64_tr_b16 v[194:195], v216 offset:26624
  v_fma_f32 v175, v175, s42, v221
  v_exp_f32 v173, v173
  v_mfma_f32_32x32x16_bf16 v[128:143], v[196:199], a[148:151], v[128:143]
  buffer_store_dwordx4 a[208:211], v249, s[32:35], s47 offen offset:128 sc1
  v_add_f32 v226, v226, v171
  v_fma_f32 v184, v184, s42, v222
  v_exp_f32 v174, v174
  v_add_f32 v225, v225, v172
  v_mfma_f32_32x32x16_bf16 v[144:159], v[196:199], a[180:183], v[144:159]
  ds_read_b64_tr_b16 v[196:197], v217 offset:24576
  ds_read_b64_tr_b16 v[198:199], v217 offset:26624
  v_cvt_pk_bf16_f32 v169, v170, v171
  v_fma_f32 v185, v185, s42, v222
  s_waitcnt lgkmcnt(4)
  v_mfma_f32_32x32x16_bf16 v[128:143], v[200:203], a[152:155], v[128:143]
  v_exp_f32 v175, v175
  v_add_f32 v226, v226, v173
  v_fma_f32 v186, v186, s42, v222
  v_exp_f32 v184, v184
  v_mfma_f32_32x32x16_bf16 v[144:159], v[200:203], a[184:187], v[144:159]
  ds_read_b64_tr_b16 v[200:201], v218 offset:24576
  ds_read_b64_tr_b16 v[202:203], v218 offset:26624
  v_add_f32 v225, v225, v174
  v_cvt_pk_bf16_f32 v170, v172, v173
  v_fma_f32 v187, v187, s42, v222
  v_mfma_f32_32x32x16_bf16 v[128:143], v[204:207], a[156:159], v[128:143]
  v_exp_f32 v185, v185
  v_add_f32 v226, v226, v175
  v_fma_f32 v188, v188, s42, v222
  v_exp_f32 v186, v186
  v_mfma_f32_32x32x16_bf16 v[144:159], v[204:207], a[188:191], v[144:159]
  ds_read_b64_tr_b16 v[204:205], v219 offset:24576
  ds_read_b64_tr_b16 v[206:207], v219 offset:26624
  v_add_f32 v227, v227, v184
  v_cvt_pk_bf16_f32 v171, v174, v175
  s_waitcnt lgkmcnt(4)
  v_mfma_f32_32x32x16_bf16 v[0:15], v[192:195], v[160:163], v[0:15]
  v_fma_f32 v189, v189, s42, v222
  v_exp_f32 v187, v187
  v_add_f32 v228, v228, v185
  v_fma_f32 v190, v190, s42, v222
  v_mfma_f32_32x32x16_bf16 v[64:79], v[192:195], v[176:179], v[64:79]
  ds_read_b64_tr_b16 v[192:193], v216 offset:28672
  ds_read_b64_tr_b16 v[194:195], v216 offset:30720
  v_exp_f32 v188, v188
  v_fma_f32 v128, v128, s42, v221
  v_add_f32 v227, v227, v186
  v_mfma_f32_32x32x16_bf16 v[16:31], v[196:199], v[160:163], v[16:31]
  v_cvt_pk_bf16_f32 v184, v184, v185
  v_fma_f32 v129, v129, s42, v221
  v_fma_f32 v191, v191, s42, v222
  v_exp_f32 v189, v189
  v_add_f32 v228, v228, v187
  v_mfma_f32_32x32x16_bf16 v[80:95], v[196:199], v[176:179], v[80:95]
  ds_read_b64_tr_b16 v[196:197], v217 offset:28672
  ds_read_b64_tr_b16 v[198:199], v217 offset:30720
  v_exp_f32 v190, v190
  v_add_f32 v227, v227, v188
  s_waitcnt lgkmcnt(4)
  v_mfma_f32_32x32x16_bf16 v[32:47], v[200:203], v[160:163], v[32:47]
  buffer_store_dwordx4 a[216:219], v249, s[32:35], s47 offen offset:192 sc1
  v_cvt_pk_bf16_f32 v185, v186, v187
  v_exp_f32 v191, v191
  v_add_f32 v228, v228, v189
  v_add_f32 v227, v227, v190
  v_mfma_f32_32x32x16_bf16 v[96:111], v[200:203], v[176:179], v[96:111]
  ds_read_b64_tr_b16 v[200:201], v218 offset:28672
  ds_read_b64_tr_b16 v[202:203], v218 offset:30720
  v_cvt_pk_bf16_f32 v186, v188, v189
  v_fma_f32 v130, v130, s42, v221
  v_add_f32 v228, v228, v191
  v_cvt_pk_bf16_f32 v187, v190, v191
  v_mfma_f32_32x32x16_bf16 v[48:63], v[204:207], v[160:163], v[48:63]
  v_exp_f32 v128, v128
  v_fma_f32 v131, v131, s42, v221
  v_exp_f32 v129, v129
  v_mfma_f32_32x32x16_bf16 v[112:127], v[204:207], v[176:179], v[112:127]
  ds_read_b64_tr_b16 v[204:205], v219 offset:28672
  ds_read_b64_tr_b16 v[206:207], v219 offset:30720
  v_fma_f32 v132, v132, s42, v221
  v_exp_f32 v130, v130
  s_waitcnt lgkmcnt(4)
  v_mfma_f32_32x32x16_bf16 v[0:15], v[192:195], v[168:171], v[0:15]
  v_add_f32 v225, v225, v128
  v_fma_f32 v133, v133, s42, v221
  v_exp_f32 v131, v131
  v_add_f32 v226, v226, v129
  v_fma_f32 v134, v134, s42, v221
  v_mfma_f32_32x32x16_bf16 v[64:79], v[192:195], v[184:187], v[64:79]
  ds_read_b128 v[192:195], v208 offset:40960
  v_exp_f32 v132, v132
  v_add_f32 v225, v225, v130
  v_cvt_pk_bf16_f32 v128, v128, v129
  v_mfma_f32_32x32x16_bf16 v[16:31], v[196:199], v[168:171], v[16:31]
  v_fma_f32 v135, v135, s42, v221
  v_exp_f32 v133, v133
  v_add_f32 v226, v226, v131
  v_fma_f32 v144, v144, s42, v222
  v_mfma_f32_32x32x16_bf16 v[80:95], v[196:199], v[184:187], v[80:95]
  ds_read_b128 v[196:199], v209 offset:40960
  v_exp_f32 v134, v134
  v_add_f32 v225, v225, v132
  v_cvt_pk_bf16_f32 v129, v130, v131
  s_waitcnt lgkmcnt(2)
  v_mfma_f32_32x32x16_bf16 v[32:47], v[200:203], v[168:171], v[32:47]
  v_fma_f32 v145, v145, s42, v222
  v_exp_f32 v135, v135
  v_add_f32 v226, v226, v133
  v_fma_f32 v146, v146, s42, v222
  v_exp_f32 v144, v144
  v_mfma_f32_32x32x16_bf16 v[96:111], v[200:203], v[184:187], v[96:111]
  ds_read_b128 v[200:203], v210 offset:40960
  v_add_f32 v225, v225, v134
  v_cvt_pk_bf16_f32 v130, v132, v133
  v_fma_f32 v147, v147, s42, v222
  v_mfma_f32_32x32x16_bf16 v[48:63], v[204:207], v[168:171], v[48:63]
  buffer_store_dwordx4 a[240:243], v249, s[32:35], s48 offen offset:128 sc1
  v_exp_f32 v145, v145
  v_add_f32 v226, v226, v135
  v_fma_f32 v148, v148, s42, v222
  v_exp_f32 v146, v146
  v_mfma_f32_32x32x16_bf16 v[112:127], v[204:207], v[184:187], v[112:127]
  ds_read_b128 v[204:207], v211 offset:40960
  v_add_f32 v227, v227, v144
  v_cvt_pk_bf16_f32 v131, v134, v135
  v_fma_f32 v149, v149, s42, v222
  s_waitcnt lgkmcnt(2)
  v_mfma_f32_32x32x16_bf16 v[160:175], v[192:195], a[128:131], 0
  v_exp_f32 v147, v147
  v_add_f32 v228, v228, v145
  v_fma_f32 v150, v150, s42, v222
  v_exp_f32 v148, v148
  v_mfma_f32_32x32x16_bf16 v[176:191], v[192:195], a[160:163], 0
  ds_read_b128 v[192:195], v212 offset:40960
  v_add_f32 v227, v227, v146
  v_cvt_pk_bf16_f32 v144, v144, v145
  v_fma_f32 v151, v151, s42, v222
  v_exp_f32 v149, v149
  v_mfma_f32_32x32x16_bf16 v[160:175], v[196:199], a[132:135], v[160:175]
  v_add_f32 v228, v228, v147
  v_fma_f32 v136, v136, s42, v221
  v_exp_f32 v150, v150
  v_add_f32 v227, v227, v148
  v_mfma_f32_32x32x16_bf16 v[176:191], v[196:199], a[164:167], v[176:191]
  ds_read_b128 v[196:199], v213 offset:40960
  v_cvt_pk_bf16_f32 v145, v146, v147
  v_fma_f32 v137, v137, s42, v221
  v_exp_f32 v151, v151
  s_waitcnt lgkmcnt(2)
  v_mfma_f32_32x32x16_bf16 v[160:175], v[200:203], a[136:139], v[160:175]
  v_add_f32 v228, v228, v149
  v_fma_f32 v138, v138, s42, v221
  v_exp_f32 v136, v136
  v_add_f32 v227, v227, v150
  v_mfma_f32_32x32x16_bf16 v[176:191], v[200:203], a[168:171], v[176:191]
  ds_read_b128 v[200:203], v214 offset:40960
  v_cvt_pk_bf16_f32 v146, v148, v149
  v_fma_f32 v139, v139, s42, v221
  v_exp_f32 v137, v137
  v_mfma_f32_32x32x16_bf16 v[160:175], v[204:207], a[140:143], v[160:175]
  v_add_f32 v228, v228, v151
  v_fma_f32 v140, v140, s42, v221
  v_exp_f32 v138, v138
  v_add_f32 v225, v225, v136
  v_cvt_pk_bf16_f32 v147, v150, v151
  v_mfma_f32_32x32x16_bf16 v[176:191], v[204:207], a[172:175], v[176:191]
  ds_read_b128 v[204:207], v215 offset:40960
  v_fma_f32 v141, v141, s42, v221
  v_exp_f32 v139, v139
  s_waitcnt lgkmcnt(2)
  v_mfma_f32_32x32x16_bf16 v[160:175], v[192:195], a[144:147], v[160:175]
  buffer_store_dwordx4 a[248:251], v249, s[32:35], s48 offen offset:192 sc1
  v_add_f32 v226, v226, v137
  v_fma_f32 v142, v142, s42, v221
  v_exp_f32 v140, v140
  v_add_f32 v225, v225, v138
  v_mfma_f32_32x32x16_bf16 v[176:191], v[192:195], a[176:179], v[176:191]
  ds_read_b64_tr_b16 v[192:193], v216 offset:32768
  ds_read_b64_tr_b16 v[194:195], v216 offset:34816
  v_cvt_pk_bf16_f32 v136, v136, v137
  v_fma_f32 v143, v143, s42, v221
  v_exp_f32 v141, v141
  v_mfma_f32_32x32x16_bf16 v[160:175], v[196:199], a[148:151], v[160:175]
  v_add_f32 v226, v226, v139
  v_fma_f32 v152, v152, s42, v222
  v_exp_f32 v142, v142
  v_add_f32 v225, v225, v140
  v_mfma_f32_32x32x16_bf16 v[176:191], v[196:199], a[180:183], v[176:191]
  ds_read_b64_tr_b16 v[196:197], v217 offset:32768
  ds_read_b64_tr_b16 v[198:199], v217 offset:34816
  v_cvt_pk_bf16_f32 v137, v138, v139
  v_fma_f32 v153, v153, s42, v222
  s_waitcnt lgkmcnt(4)
  v_mfma_f32_32x32x16_bf16 v[160:175], v[200:203], a[152:155], v[160:175]
  v_exp_f32 v143, v143
  v_add_f32 v226, v226, v141
  v_fma_f32 v154, v154, s42, v222
  v_exp_f32 v152, v152
  v_mfma_f32_32x32x16_bf16 v[176:191], v[200:203], a[184:187], v[176:191]
  ds_read_b64_tr_b16 v[200:201], v218 offset:32768
  ds_read_b64_tr_b16 v[202:203], v218 offset:34816
  v_add_f32 v225, v225, v142
  v_cvt_pk_bf16_f32 v138, v140, v141
  v_fma_f32 v155, v155, s42, v222
  v_mfma_f32_32x32x16_bf16 v[160:175], v[204:207], a[156:159], v[160:175]
  v_exp_f32 v153, v153
  v_add_f32 v226, v226, v143
  v_fma_f32 v156, v156, s42, v222
  v_exp_f32 v154, v154
  v_mfma_f32_32x32x16_bf16 v[176:191], v[204:207], a[188:191], v[176:191]
  ds_read_b64_tr_b16 v[204:205], v219 offset:32768
  ds_read_b64_tr_b16 v[206:207], v219 offset:34816
  v_add_f32 v227, v227, v152
  v_cvt_pk_bf16_f32 v139, v142, v143
  s_waitcnt lgkmcnt(4)
  v_mfma_f32_32x32x16_bf16 v[0:15], v[192:195], v[128:131], v[0:15]
  v_fma_f32 v157, v157, s42, v222
  v_exp_f32 v155, v155
  v_add_f32 v228, v228, v153
  v_fma_f32 v158, v158, s42, v222
  v_mfma_f32_32x32x16_bf16 v[64:79], v[192:195], v[144:147], v[64:79]
  ds_read_b64_tr_b16 v[192:193], v216 offset:36864
  ds_read_b64_tr_b16 v[194:195], v216 offset:38912
  v_exp_f32 v156, v156
  v_fma_f32 v160, v160, s42, v221
  v_add_f32 v227, v227, v154
  v_mfma_f32_32x32x16_bf16 v[16:31], v[196:199], v[128:131], v[16:31]
  buffer_store_dwordx4 a[212:215], v249, s[32:35], s53 offen offset:128 sc1
  v_cvt_pk_bf16_f32 v152, v152, v153
  v_fma_f32 v161, v161, s42, v221
  v_fma_f32 v159, v159, s42, v222
  v_exp_f32 v157, v157
  v_add_f32 v228, v228, v155
  v_mfma_f32_32x32x16_bf16 v[80:95], v[196:199], v[144:147], v[80:95]
  ds_read_b64_tr_b16 v[196:197], v217 offset:36864
  ds_read_b64_tr_b16 v[198:199], v217 offset:38912
  v_exp_f32 v158, v158
  v_fma_f32 v162, v162, s42, v221
  s_waitcnt lgkmcnt(4)
  v_mfma_f32_32x32x16_bf16 v[32:47], v[200:203], v[128:131], v[32:47]
  v_add_f32 v227, v227, v156
  v_cvt_pk_bf16_f32 v153, v154, v155
  v_exp_f32 v159, v159
  v_add_f32 v228, v228, v157
  v_add_f32 v227, v227, v158
  v_mfma_f32_32x32x16_bf16 v[96:111], v[200:203], v[144:147], v[96:111]
  ds_read_b64_tr_b16 v[200:201], v218 offset:36864
  ds_read_b64_tr_b16 v[202:203], v218 offset:38912
  v_cvt_pk_bf16_f32 v154, v156, v157
  v_exp_f32 v160, v160
  v_add_f32 v228, v228, v159
  v_cvt_pk_bf16_f32 v155, v158, v159
  v_mfma_f32_32x32x16_bf16 v[48:63], v[204:207], v[128:131], v[48:63]
  v_fma_f32 v163, v163, s42, v221
  v_exp_f32 v161, v161
  v_fma_f32 v164, v164, s42, v221
  v_exp_f32 v162, v162
  v_mfma_f32_32x32x16_bf16 v[112:127], v[204:207], v[144:147], v[112:127]
  ds_read_b64_tr_b16 v[204:205], v219 offset:36864
  ds_read_b64_tr_b16 v[206:207], v219 offset:38912
  v_add_f32 v225, v225, v160
  v_fma_f32 v165, v165, s42, v221
  s_waitcnt lgkmcnt(4)
  v_mfma_f32_32x32x16_bf16 v[0:15], v[192:195], v[136:139], v[0:15]
  v_exp_f32 v163, v163
  v_add_f32 v226, v226, v161
  v_fma_f32 v166, v166, s42, v221
  v_exp_f32 v164, v164
  s_barrier
  v_mfma_f32_32x32x16_bf16 v[64:79], v[192:195], v[152:155], v[64:79]
  ds_read_b128 v[192:195], v208 offset:49152
  v_add_f32 v225, v225, v162
  v_cvt_pk_bf16_f32 v160, v160, v161
  v_fma_f32 v167, v167, s42, v221
  v_exp_f32 v165, v165
  v_mfma_f32_32x32x16_bf16 v[16:31], v[196:199], v[136:139], v[16:31]
  s_add_u32 m0, s40, 32768
  s_add_u32 s41, s59, 0
  buffer_load_dwordx4 v253, s[24:27], s41 offen lds
  v_add_f32 v226, v226, v163
  v_fma_f32 v176, v176, s42, v222
  v_mfma_f32_32x32x16_bf16 v[80:95], v[196:199], v[152:155], v[80:95]
  ds_read_b128 v[196:199], v209 offset:49152
  v_exp_f32 v166, v166
  v_add_f32 v225, v225, v164
  v_cvt_pk_bf16_f32 v161, v162, v163
  v_fma_f32 v177, v177, s42, v222
  s_waitcnt lgkmcnt(2)
  v_mfma_f32_32x32x16_bf16 v[32:47], v[200:203], v[136:139], v[32:47]
  s_add_u32 m0, s40, 36864
  s_add_u32 s41, s59, 4096
  buffer_load_dwordx4 v253, s[24:27], s41 offen lds
  buffer_store_dwordx4 a[220:223], v249, s[32:35], s53 offen offset:192 sc1
  v_exp_f32 v167, v167
  v_mfma_f32_32x32x16_bf16 v[96:111], v[200:203], v[152:155], v[96:111]
  ds_read_b128 v[200:203], v210 offset:49152
  v_add_f32 v226, v226, v165
  v_fma_f32 v178, v178, s42, v222
  v_exp_f32 v176, v176
  v_add_f32 v225, v225, v166
  v_mfma_f32_32x32x16_bf16 v[48:63], v[204:207], v[136:139], v[48:63]
  v_cvt_pk_bf16_f32 v162, v164, v165
  v_fma_f32 v179, v179, s42, v222
  v_exp_f32 v177, v177
  v_add_f32 v226, v226, v167
  v_fma_f32 v180, v180, s42, v222
  v_mfma_f32_32x32x16_bf16 v[112:127], v[204:207], v[152:155], v[112:127]
  ds_read_b128 v[204:207], v211 offset:49152
  v_exp_f32 v178, v178
  v_add_f32 v227, v227, v176
  v_cvt_pk_bf16_f32 v163, v166, v167
  s_waitcnt lgkmcnt(2)
  v_mfma_f32_32x32x16_bf16 v[128:143], v[192:195], a[128:131], 0
  v_fma_f32 v181, v181, s42, v222
  v_exp_f32 v179, v179
  v_add_f32 v228, v228, v177
  v_fma_f32 v182, v182, s42, v222
  v_mfma_f32_32x32x16_bf16 v[144:159], v[192:195], a[160:163], 0
  ds_read_b128 v[192:195], v212 offset:49152
  v_exp_f32 v180, v180
  v_add_f32 v227, v227, v178
  v_cvt_pk_bf16_f32 v176, v176, v177
  v_fma_f32 v183, v183, s42, v222
  v_mfma_f32_32x32x16_bf16 v[128:143], v[196:199], a[132:135], v[128:143]
  v_exp_f32 v181, v181
  v_add_f32 v228, v228, v179
  v_fma_f32 v168, v168, s42, v221
  v_exp_f32 v182, v182
  v_mfma_f32_32x32x16_bf16 v[144:159], v[196:199], a[164:167], v[144:159]
  ds_read_b128 v[196:199], v213 offset:49152
  v_add_f32 v227, v227, v180
  v_cvt_pk_bf16_f32 v177, v178, v179
  v_fma_f32 v169, v169, s42, v221
  v_exp_f32 v183, v183
  s_waitcnt lgkmcnt(2)
  v_mfma_f32_32x32x16_bf16 v[128:143], v[200:203], a[136:139], v[128:143]
  v_add_f32 v228, v228, v181
  v_fma_f32 v170, v170, s42, v221
  v_exp_f32 v168, v168
  v_add_f32 v227, v227, v182
  v_mfma_f32_32x32x16_bf16 v[144:159], v[200:203], a[168:171], v[144:159]
  ds_read_b128 v[200:203], v214 offset:49152
  v_cvt_pk_bf16_f32 v178, v180, v181
  v_fma_f32 v171, v171, s42, v221
  v_exp_f32 v169, v169
  v_add_f32 v228, v228, v183
  v_mfma_f32_32x32x16_bf16 v[128:143], v[204:207], a[140:143], v[128:143]
  buffer_store_dwordx4 a[244:247], v249, s[32:35], s54 offen offset:128 sc1
  v_fma_f32 v172, v172, s42, v221
  v_exp_f32 v170, v170
  v_add_f32 v225, v225, v168
  v_cvt_pk_bf16_f32 v179, v182, v183
  v_mfma_f32_32x32x16_bf16 v[144:159], v[204:207], a[172:175], v[144:159]
  ds_read_b128 v[204:207], v215 offset:49152
  v_fma_f32 v173, v173, s42, v221
  v_exp_f32 v171, v171
  s_waitcnt lgkmcnt(2)
  v_mfma_f32_32x32x16_bf16 v[128:143], v[192:195], a[144:147], v[128:143]
  v_add_f32 v226, v226, v169
  v_fma_f32 v174, v174, s42, v221
  v_exp_f32 v172, v172
  v_add_f32 v225, v225, v170
  v_cvt_pk_bf16_f32 v168, v168, v169
  v_mfma_f32_32x32x16_bf16 v[144:159], v[192:195], a[176:179], v[144:159]
  ds_read_b64_tr_b16 v[192:193], v216 offset:40960
  ds_read_b64_tr_b16 v[194:195], v216 offset:43008
  v_fma_f32 v175, v175, s42, v221
  v_exp_f32 v173, v173
  v_mfma_f32_32x32x16_bf16 v[128:143], v[196:199], a[148:151], v[128:143]
  v_add_f32 v226, v226, v171
  v_fma_f32 v184, v184, s42, v222
  v_exp_f32 v174, v174
  v_add_f32 v225, v225, v172
  v_mfma_f32_32x32x16_bf16 v[144:159], v[196:199], a[180:183], v[144:159]
  ds_read_b64_tr_b16 v[196:197], v217 offset:40960
  ds_read_b64_tr_b16 v[198:199], v217 offset:43008
  v_cvt_pk_bf16_f32 v169, v170, v171
  v_fma_f32 v185, v185, s42, v222
  s_waitcnt lgkmcnt(4)
  v_mfma_f32_32x32x16_bf16 v[128:143], v[200:203], a[152:155], v[128:143]
  v_exp_f32 v175, v175
  v_add_f32 v226, v226, v173
  v_fma_f32 v186, v186, s42, v222
  v_exp_f32 v184, v184
  v_mfma_f32_32x32x16_bf16 v[144:159], v[200:203], a[184:187], v[144:159]
  ds_read_b64_tr_b16 v[200:201], v218 offset:40960
  ds_read_b64_tr_b16 v[202:203], v218 offset:43008
  v_add_f32 v225, v225, v174
  v_cvt_pk_bf16_f32 v170, v172, v173
  v_fma_f32 v187, v187, s42, v222
  v_mfma_f32_32x32x16_bf16 v[128:143], v[204:207], a[156:159], v[128:143]
  v_exp_f32 v185, v185
  v_add_f32 v226, v226, v175
  v_fma_f32 v188, v188, s42, v222
  v_exp_f32 v186, v186
  v_mfma_f32_32x32x16_bf16 v[144:159], v[204:207], a[188:191], v[144:159]
  ds_read_b64_tr_b16 v[204:205], v219 offset:40960
  ds_read_b64_tr_b16 v[206:207], v219 offset:43008
  v_add_f32 v227, v227, v184
  v_cvt_pk_bf16_f32 v171, v174, v175
  s_waitcnt lgkmcnt(4)
  v_mfma_f32_32x32x16_bf16 v[0:15], v[192:195], v[160:163], v[0:15]
  buffer_store_dwordx4 a[252:255], v249, s[32:35], s54 offen offset:192 sc1
  v_fma_f32 v189, v189, s42, v222
  v_exp_f32 v187, v187
  v_add_f32 v228, v228, v185
  v_mfma_f32_32x32x16_bf16 v[64:79], v[192:195], v[176:179], v[64:79]
  ds_read_b64_tr_b16 v[192:193], v216 offset:45056
  ds_read_b64_tr_b16 v[194:195], v216 offset:47104
  v_fma_f32 v190, v190, s42, v222
  v_exp_f32 v188, v188
  v_add_f32 v227, v227, v186
  v_mfma_f32_32x32x16_bf16 v[16:31], v[196:199], v[160:163], v[16:31]
  v_cvt_pk_bf16_f32 v184, v184, v185
  v_fma_f32 v128, v128, s42, v221
  v_fma_f32 v191, v191, s42, v222
  v_exp_f32 v189, v189
  v_add_f32 v228, v228, v187
  v_mfma_f32_32x32x16_bf16 v[80:95], v[196:199], v[176:179], v[80:95]
  ds_read_b64_tr_b16 v[196:197], v217 offset:45056
  ds_read_b64_tr_b16 v[198:199], v217 offset:47104
  v_exp_f32 v190, v190
  v_fma_f32 v129, v129, s42, v221
  s_waitcnt lgkmcnt(4)
  v_mfma_f32_32x32x16_bf16 v[32:47], v[200:203], v[160:163], v[32:47]
  v_add_f32 v227, v227, v188
  v_cvt_pk_bf16_f32 v185, v186, v187
  v_exp_f32 v191, v191
  v_add_f32 v228, v228, v189
  v_add_f32 v227, v227, v190
  v_mfma_f32_32x32x16_bf16 v[96:111], v[200:203], v[176:179], v[96:111]
  ds_read_b64_tr_b16 v[200:201], v218 offset:45056
  ds_read_b64_tr_b16 v[202:203], v218 offset:47104
  v_cvt_pk_bf16_f32 v186, v188, v189
  v_fma_f32 v130, v130, s42, v221
  v_add_f32 v228, v228, v191
  v_cvt_pk_bf16_f32 v187, v190, v191
  v_mfma_f32_32x32x16_bf16 v[48:63], v[204:207], v[160:163], v[48:63]
  v_exp_f32 v128, v128
  v_fma_f32 v131, v131, s42, v221
  v_exp_f32 v129, v129
  v_mfma_f32_32x32x16_bf16 v[112:127], v[204:207], v[176:179], v[112:127]
  ds_read_b64_tr_b16 v[204:205], v219 offset:45056
  ds_read_b64_tr_b16 v[206:207], v219 offset:47104
  v_fma_f32 v132, v132, s42, v221
  v_exp_f32 v130, v130
  s_waitcnt lgkmcnt(4)
  v_mfma_f32_32x32x16_bf16 v[0:15], v[192:195], v[168:171], v[0:15]
  v_add_f32 v225, v225, v128
  v_fma_f32 v133, v133, s42, v221
  v_exp_f32 v131, v131
  v_add_f32 v226, v226, v129
  v_fma_f32 v134, v134, s42, v221
  v_mfma_f32_32x32x16_bf16 v[64:79], v[192:195], v[184:187], v[64:79]
  ds_read_b128 v[192:195], v208 offset:57344
  v_exp_f32 v132, v132
  v_add_f32 v225, v225, v130
  v_cvt_pk_bf16_f32 v128, v128, v129
  v_mfma_f32_32x32x16_bf16 v[16:31], v[196:199], v[168:171], v[16:31]
  v_fma_f32 v135, v135, s42, v221
  v_exp_f32 v133, v133
  v_add_f32 v226, v226, v131
  v_fma_f32 v144, v144, s42, v222
  v_exp_f32 v134, v134
  v_mfma_f32_32x32x16_bf16 v[80:95], v[196:199], v[184:187], v[80:95]
  ds_read_b128 v[196:199], v209 offset:57344
  v_add_f32 v225, v225, v132
  v_cvt_pk_bf16_f32 v129, v130, v131
  v_fma_f32 v145, v145, s42, v222
  s_waitcnt lgkmcnt(2)
  v_mfma_f32_32x32x16_bf16 v[32:47], v[200:203], v[168:171], v[32:47]
  v_exp_f32 v135, v135
  v_add_f32 v226, v226, v133
  v_fma_f32 v146, v146, s42, v222
  v_exp_f32 v144, v144
  v_mfma_f32_32x32x16_bf16 v[96:111], v[200:203], v[184:187], v[96:111]
  ds_read_b128 v[200:203], v210 offset:57344
  v_add_f32 v225, v225, v134
  v_cvt_pk_bf16_f32 v130, v132, v133
  v_fma_f32 v147, v147, s42, v222
  v_exp_f32 v145, v145
  v_mfma_f32_32x32x16_bf16 v[48:63], v[204:207], v[168:171], v[48:63]
  buffer_load_dwordx4 a[192:195], v249, s[20:23], s51 offen offset:0 nt
  buffer_load_dwordx4 a[200:203], v249, s[20:23], s51 offen offset:64 nt
  v_add_f32 v226, v226, v135
  v_fma_f32 v148, v148, s42, v222
  v_mfma_f32_32x32x16_bf16 v[112:127], v[204:207], v[184:187], v[112:127]
  ds_read_b128 v[204:207], v211 offset:57344
  v_exp_f32 v146, v146
  v_add_f32 v227, v227, v144
  v_cvt_pk_bf16_f32 v131, v134, v135
  v_fma_f32 v149, v149, s42, v222
  s_waitcnt lgkmcnt(2)
  v_mfma_f32_32x32x16_bf16 v[160:175], v[192:195], a[128:131], 0
  v_exp_f32 v147, v147
  v_add_f32 v228, v228, v145
  v_fma_f32 v150, v150, s42, v222
  v_exp_f32 v148, v148
  v_mfma_f32_32x32x16_bf16 v[176:191], v[192:195], a[160:163], 0
  ds_read_b128 v[192:195], v212 offset:57344
  v_add_f32 v227, v227, v146
  v_cvt_pk_bf16_f32 v144, v144, v145
  v_fma_f32 v151, v151, s42, v222
  v_mfma_f32_32x32x16_bf16 v[160:175], v[196:199], a[132:135], v[160:175]
  v_exp_f32 v149, v149
  v_add_f32 v228, v228, v147
  v_fma_f32 v136, v136, s42, v221
  v_exp_f32 v150, v150
  v_mfma_f32_32x32x16_bf16 v[176:191], v[196:199], a[164:167], v[176:191]
  ds_read_b128 v[196:199], v213 offset:57344
  v_add_f32 v227, v227, v148
  v_cvt_pk_bf16_f32 v145, v146, v147
  v_fma_f32 v137, v137, s42, v221
  v_exp_f32 v151, v151
  s_waitcnt lgkmcnt(2)
  v_mfma_f32_32x32x16_bf16 v[160:175], v[200:203], a[136:139], v[160:175]
  v_add_f32 v228, v228, v149
  v_fma_f32 v138, v138, s42, v221
  v_exp_f32 v136, v136
  v_add_f32 v227, v227, v150
  v_mfma_f32_32x32x16_bf16 v[176:191], v[200:203], a[168:171], v[176:191]
  ds_read_b128 v[200:203], v214 offset:57344
  v_cvt_pk_bf16_f32 v146, v148, v149
  v_fma_f32 v139, v139, s42, v221
  v_exp_f32 v137, v137
  v_mfma_f32_32x32x16_bf16 v[160:175], v[204:207], a[140:143], v[160:175]
  v_add_f32 v228, v228, v151
  v_fma_f32 v140, v140, s42, v221
  v_exp_f32 v138, v138
  v_add_f32 v225, v225, v136
  v_cvt_pk_bf16_f32 v147, v150, v151
  v_mfma_f32_32x32x16_bf16 v[176:191], v[204:207], a[172:175], v[176:191]
  ds_read_b128 v[204:207], v215 offset:57344
  v_fma_f32 v141, v141, s42, v221
  v_exp_f32 v139, v139
  s_waitcnt lgkmcnt(2)
  v_mfma_f32_32x32x16_bf16 v[160:175], v[192:195], a[144:147], v[160:175]
  v_add_f32 v226, v226, v137
  v_fma_f32 v142, v142, s42, v221
  v_exp_f32 v140, v140
  v_add_f32 v225, v225, v138
  v_cvt_pk_bf16_f32 v136, v136, v137
  v_mfma_f32_32x32x16_bf16 v[176:191], v[192:195], a[176:179], v[176:191]
  ds_read_b64_tr_b16 v[192:193], v216 offset:49152
  ds_read_b64_tr_b16 v[194:195], v216 offset:51200
  v_fma_f32 v143, v143, s42, v221
  v_exp_f32 v141, v141
  v_mfma_f32_32x32x16_bf16 v[160:175], v[196:199], a[148:151], v[160:175]
  v_add_f32 v226, v226, v139
  v_fma_f32 v152, v152, s42, v222
  v_exp_f32 v142, v142
  v_add_f32 v225, v225, v140
  v_mfma_f32_32x32x16_bf16 v[176:191], v[196:199], a[180:183], v[176:191]
  ds_read_b64_tr_b16 v[196:197], v217 offset:49152
  ds_read_b64_tr_b16 v[198:199], v217 offset:51200
  v_cvt_pk_bf16_f32 v137, v138, v139
  v_fma_f32 v153, v153, s42, v222
  v_exp_f32 v143, v143
  s_waitcnt lgkmcnt(4)
  v_mfma_f32_32x32x16_bf16 v[160:175], v[200:203], a[152:155], v[160:175]
  v_add_f32 v226, v226, v141
  v_fma_f32 v154, v154, s42, v222
  v_exp_f32 v152, v152
  v_mfma_f32_32x32x16_bf16 v[176:191], v[200:203], a[184:187], v[176:191]
  ds_read_b64_tr_b16 v[200:201], v218 offset:49152
  ds_read_b64_tr_b16 v[202:203], v218 offset:51200
  v_add_f32 v225, v225, v142
  v_cvt_pk_bf16_f32 v138, v140, v141
  v_fma_f32 v155, v155, s42, v222
  v_mfma_f32_32x32x16_bf16 v[160:175], v[204:207], a[156:159], v[160:175]
  v_exp_f32 v153, v153
  v_add_f32 v226, v226, v143
  v_fma_f32 v156, v156, s42, v222
  v_exp_f32 v154, v154
  v_mfma_f32_32x32x16_bf16 v[176:191], v[204:207], a[188:191], v[176:191]
  ds_read_b64_tr_b16 v[204:205], v219 offset:49152
  ds_read_b64_tr_b16 v[206:207], v219 offset:51200
  v_add_f32 v227, v227, v152
  v_cvt_pk_bf16_f32 v139, v142, v143
  v_fma_f32 v157, v157, s42, v222
  s_waitcnt lgkmcnt(4)
  v_mfma_f32_32x32x16_bf16 v[0:15], v[192:195], v[128:131], v[0:15]
  v_exp_f32 v155, v155
  v_add_f32 v228, v228, v153
  v_fma_f32 v158, v158, s42, v222
  v_mfma_f32_32x32x16_bf16 v[64:79], v[192:195], v[144:147], v[64:79]
  ds_read_b64_tr_b16 v[192:193], v216 offset:53248
  ds_read_b64_tr_b16 v[194:195], v216 offset:55296
  v_exp_f32 v156, v156
  v_add_f32 v227, v227, v154
  v_cvt_pk_bf16_f32 v152, v152, v153
  v_mfma_f32_32x32x16_bf16 v[16:31], v[196:199], v[128:131], v[16:31]
  buffer_load_dwordx4 a[196:199], v249, s[20:23], s57 offen offset:0 nt
  buffer_load_dwordx4 a[204:207], v249, s[20:23], s57 offen offset:64 nt
  v_fma_f32 v159, v159, s42, v222
  v_fma_f32 v160, v160, s42, v221
  v_exp_f32 v157, v157
  v_add_f32 v228, v228, v155
  v_mfma_f32_32x32x16_bf16 v[80:95], v[196:199], v[144:147], v[80:95]
  ds_read_b64_tr_b16 v[196:197], v217 offset:53248
  ds_read_b64_tr_b16 v[198:199], v217 offset:55296
  v_exp_f32 v158, v158
  v_fma_f32 v161, v161, s42, v221
  s_waitcnt lgkmcnt(4)
  v_mfma_f32_32x32x16_bf16 v[32:47], v[200:203], v[128:131], v[32:47]
  v_add_f32 v227, v227, v156
  v_fma_f32 v162, v162, s42, v221
  v_cvt_pk_bf16_f32 v153, v154, v155
  v_exp_f32 v159, v159
  v_add_f32 v228, v228, v157
  v_add_f32 v227, v227, v158
  v_mfma_f32_32x32x16_bf16 v[96:111], v[200:203], v[144:147], v[96:111]
  ds_read_b64_tr_b16 v[200:201], v218 offset:53248
  ds_read_b64_tr_b16 v[202:203], v218 offset:55296
  v_cvt_pk_bf16_f32 v154, v156, v157
  v_exp_f32 v160, v160
  v_add_f32 v228, v228, v159
  v_cvt_pk_bf16_f32 v155, v158, v159
  v_mfma_f32_32x32x16_bf16 v[48:63], v[204:207], v[128:131], v[48:63]
  v_fma_f32 v163, v163, s42, v221
  v_exp_f32 v161, v161
  v_fma_f32 v164, v164, s42, v221
  v_exp_f32 v162, v162
  v_mfma_f32_32x32x16_bf16 v[112:127], v[204:207], v[144:147], v[112:127]
  ds_read_b64_tr_b16 v[204:205], v219 offset:53248
  ds_read_b64_tr_b16 v[206:207], v219 offset:55296
  v_add_f32 v225, v225, v160
  v_fma_f32 v165, v165, s42, v221
  s_waitcnt lgkmcnt(4)
  v_mfma_f32_32x32x16_bf16 v[0:15], v[192:195], v[136:139], v[0:15]
  v_exp_f32 v163, v163
  v_add_f32 v226, v226, v161
  v_fma_f32 v166, v166, s42, v221
  v_exp_f32 v164, v164
  v_xor_b32 v208, 0x10000, v208
  v_mfma_f32_32x32x16_bf16 v[64:79], v[192:195], v[152:155], v[64:79]
  ds_read_b128 v[192:195], v208 offset:0
  v_add_f32 v225, v225, v162
  v_cvt_pk_bf16_f32 v160, v160, v161
  v_fma_f32 v167, v167, s42, v221
  v_exp_f32 v165, v165
  v_mfma_f32_32x32x16_bf16 v[16:31], v[196:199], v[136:139], v[16:31]
  v_add_f32 v226, v226, v163
  v_fma_f32 v176, v176, s42, v222
  v_exp_f32 v166, v166
  v_xor_b32 v209, 0x10000, v209
  v_mfma_f32_32x32x16_bf16 v[80:95], v[196:199], v[152:155], v[80:95]
  ds_read_b128 v[196:199], v209 offset:0
  v_add_f32 v225, v225, v164
  v_cvt_pk_bf16_f32 v161, v162, v163
  v_fma_f32 v177, v177, s42, v222
  v_exp_f32 v167, v167
  s_waitcnt lgkmcnt(2)
  v_mfma_f32_32x32x16_bf16 v[32:47], v[200:203], v[136:139], v[32:47]
  v_add_f32 v226, v226, v165
  v_fma_f32 v178, v178, s42, v222
  v_exp_f32 v176, v176
  v_xor_b32 v210, 0x10000, v210
  v_mfma_f32_32x32x16_bf16 v[96:111], v[200:203], v[152:155], v[96:111]
  ds_read_b128 v[200:203], v210 offset:0
  v_add_f32 v225, v225, v166
  v_cvt_pk_bf16_f32 v162, v164, v165
  v_fma_f32 v179, v179, s42, v222
  v_exp_f32 v177, v177
  v_mfma_f32_32x32x16_bf16 v[48:63], v[204:207], v[136:139], v[48:63]
  v_add_f32 v226, v226, v167
  v_fma_f32 v180, v180, s42, v222
  v_exp_f32 v178, v178
  v_add_f32 v227, v227, v176
  v_xor_b32 v211, 0x10000, v211
  v_mfma_f32_32x32x16_bf16 v[112:127], v[204:207], v[152:155], v[112:127]
  ds_read_b128 v[204:207], v211 offset:0
  v_cvt_pk_bf16_f32 v163, v166, v167
  v_fma_f32 v181, v181, s42, v222
  v_exp_f32 v179, v179
  v_add_f32 v228, v228, v177
  s_waitcnt lgkmcnt(2)
  v_mfma_f32_32x32x16_bf16 v[128:143], v[192:195], a[128:131], 0
  v_fma_f32 v182, v182, s42, v222
  v_exp_f32 v180, v180
  v_add_f32 v227, v227, v178
  v_cvt_pk_bf16_f32 v176, v176, v177
  v_xor_b32 v212, 0x10000, v212
  v_mfma_f32_32x32x16_bf16 v[144:159], v[192:195], a[160:163], 0
  ds_read_b128 v[192:195], v212 offset:0
  v_fma_f32 v183, v183, s42, v222
  v_exp_f32 v181, v181
  v_add_f32 v228, v228, v179
  v_fma_f32 v168, v168, s42, v221
  v_mfma_f32_32x32x16_bf16 v[128:143], v[196:199], a[132:135], v[128:143]
  v_exp_f32 v182, v182
  v_add_f32 v227, v227, v180
  v_cvt_pk_bf16_f32 v177, v178, v179
  v_fma_f32 v169, v169, s42, v221
  v_xor_b32 v213, 0x10000, v213
  v_mfma_f32_32x32x16_bf16 v[144:159], v[196:199], a[164:167], v[144:159]
  ds_read_b128 v[196:199], v213 offset:0
  v_exp_f32 v183, v183
  v_add_f32 v228, v228, v181
  v_fma_f32 v170, v170, s42, v221
  s_waitcnt lgkmcnt(2)
  v_mfma_f32_32x32x16_bf16 v[128:143], v[200:203], a[136:139], v[128:143]
  v_exp_f32 v168, v168
  v_add_f32 v227, v227, v182
  v_cvt_pk_bf16_f32 v178, v180, v181
  v_fma_f32 v171, v171, s42, v221
  v_xor_b32 v214, 0x10000, v214
  v_mfma_f32_32x32x16_bf16 v[144:159], v[200:203], a[168:171], v[144:159]
  ds_read_b128 v[200:203], v214 offset:0
  v_exp_f32 v169, v169
  v_add_f32 v228, v228, v183
  v_fma_f32 v172, v172, s42, v221
  v_mfma_f32_32x32x16_bf16 v[128:143], v[204:207], a[140:143], v[128:143]
  buffer_load_dwordx4 a[208:211], v249, s[20:23], s51 offen offset:128 nt
  buffer_load_dwordx4 a[216:219], v249, s[20:23], s51 offen offset:192 nt
  v_exp_f32 v170, v170
  v_add_f32 v225, v225, v168
  v_cvt_pk_bf16_f32 v179, v182, v183
  v_xor_b32 v215, 0x10000, v215
  v_mfma_f32_32x32x16_bf16 v[144:159], v[204:207], a[172:175], v[144:159]
  ds_read_b128 v[204:207], v215 offset:0
  v_fma_f32 v173, v173, s42, v221
  v_exp_f32 v171, v171
  s_waitcnt lgkmcnt(2)
  v_mfma_f32_32x32x16_bf16 v[128:143], v[192:195], a[144:147], v[128:143]
  v_add_f32 v226, v226, v169
  v_fma_f32 v174, v174, s42, v221
  v_exp_f32 v172, v172
  v_add_f32 v225, v225, v170
  v_mfma_f32_32x32x16_bf16 v[144:159], v[192:195], a[176:179], v[144:159]
  ds_read_b64_tr_b16 v[192:193], v216 offset:57344
  ds_read_b64_tr_b16 v[194:195], v216 offset:59392
  v_cvt_pk_bf16_f32 v168, v168, v169
  v_fma_f32 v175, v175, s42, v221
  v_exp_f32 v173, v173
  v_mfma_f32_32x32x16_bf16 v[128:143], v[196:199], a[148:151], v[128:143]
  v_add_f32 v226, v226, v171
  v_fma_f32 v184, v184, s42, v222
  v_exp_f32 v174, v174
  v_add_f32 v225, v225, v172
  v_mfma_f32_32x32x16_bf16 v[144:159], v[196:199], a[180:183], v[144:159]
  ds_read_b64_tr_b16 v[196:197], v217 offset:57344
  ds_read_b64_tr_b16 v[198:199], v217 offset:59392
  v_cvt_pk_bf16_f32 v169, v170, v171
  v_fma_f32 v185, v185, s42, v222
  s_waitcnt lgkmcnt(4)
  v_mfma_f32_32x32x16_bf16 v[128:143], v[200:203], a[152:155], v[128:143]
  v_exp_f32 v175, v175
  v_add_f32 v226, v226, v173
  v_fma_f32 v186, v186, s42, v222
  v_exp_f32 v184, v184
  v_mfma_f32_32x32x16_bf16 v[144:159], v[200:203], a[184:187], v[144:159]
  ds_read_b64_tr_b16 v[200:201], v218 offset:57344
  ds_read_b64_tr_b16 v[202:203], v218 offset:59392
  v_add_f32 v225, v225, v174
  v_cvt_pk_bf16_f32 v170, v172, v173
  v_fma_f32 v187, v187, s42, v222
  v_mfma_f32_32x32x16_bf16 v[128:143], v[204:207], a[156:159], v[128:143]
  v_exp_f32 v185, v185
  v_add_f32 v226, v226, v175
  v_fma_f32 v188, v188, s42, v222
  v_mfma_f32_32x32x16_bf16 v[144:159], v[204:207], a[188:191], v[144:159]
  ds_read_b64_tr_b16 v[204:205], v219 offset:57344
  ds_read_b64_tr_b16 v[206:207], v219 offset:59392
  v_exp_f32 v186, v186
  v_add_f32 v227, v227, v184
  s_waitcnt lgkmcnt(4)
  v_mfma_f32_32x32x16_bf16 v[0:15], v[192:195], v[160:163], v[0:15]
  v_cvt_pk_bf16_f32 v171, v174, v175
  v_fma_f32 v189, v189, s42, v222
  v_exp_f32 v187, v187
  v_add_f32 v228, v228, v185
  v_fma_f32 v190, v190, s42, v222
  v_mfma_f32_32x32x16_bf16 v[64:79], v[192:195], v[176:179], v[64:79]
  ds_read_b64_tr_b16 v[192:193], v216 offset:61440
  ds_read_b64_tr_b16 v[194:195], v216 offset:63488
  v_exp_f32 v188, v188
  v_fma_f32 v128, v128, s42, v221
  v_add_f32 v227, v227, v186
  v_mfma_f32_32x32x16_bf16 v[16:31], v[196:199], v[160:163], v[16:31]
  v_cvt_pk_bf16_f32 v184, v184, v185
  v_fma_f32 v129, v129, s42, v221
  v_fma_f32 v191, v191, s42, v222
  v_fma_f32 v130, v130, s42, v221
  v_exp_f32 v189, v189
  v_add_f32 v228, v228, v187
  v_mfma_f32_32x32x16_bf16 v[80:95], v[196:199], v[176:179], v[80:95]
  ds_read_b64_tr_b16 v[196:197], v217 offset:61440
  ds_read_b64_tr_b16 v[198:199], v217 offset:63488
  v_exp_f32 v190, v190
  v_add_f32 v227, v227, v188
  s_waitcnt lgkmcnt(4)
  v_mfma_f32_32x32x16_bf16 v[32:47], v[200:203], v[160:163], v[32:47]
  v_cvt_pk_bf16_f32 v185, v186, v187
  v_exp_f32 v128, v128
  v_exp_f32 v191, v191
  v_add_f32 v228, v228, v189
  v_add_f32 v227, v227, v190
  v_mfma_f32_32x32x16_bf16 v[96:111], v[200:203], v[176:179], v[96:111]
  ds_read_b64_tr_b16 v[200:201], v218 offset:61440
  ds_read_b64_tr_b16 v[202:203], v218 offset:63488
  v_cvt_pk_bf16_f32 v186, v188, v189
  v_fma_f32 v131, v131, s42, v221
  v_add_f32 v228, v228, v191
  v_cvt_pk_bf16_f32 v187, v190, v191
  v_mfma_f32_32x32x16_bf16 v[48:63], v[204:207], v[160:163], v[48:63]
  v_exp_f32 v129, v129
  v_fma_f32 v132, v132, s42, v221
  v_exp_f32 v130, v130
  v_add_f32 v225, v225, v128
  v_mfma_f32_32x32x16_bf16 v[112:127], v[204:207], v[176:179], v[112:127]
  ds_read_b64_tr_b16 v[204:205], v219 offset:61440
  ds_read_b64_tr_b16 v[206:207], v219 offset:63488
  v_fma_f32 v133, v133, s42, v221
  v_exp_f32 v131, v131
  s_waitcnt lgkmcnt(4)
  v_mfma_f32_32x32x16_bf16 v[0:15], v[192:195], v[168:171], v[0:15]
  v_add_f32 v226, v226, v129
  v_fma_f32 v134, v134, s42, v221
  v_exp_f32 v132, v132
  s_waitcnt vmcnt(9)
  s_barrier
  v_xor_b32 v208, 0x10000, v208
  v_mfma_f32_32x32x16_bf16 v[64:79], v[192:195], v[184:187], v[64:79]
  ds_read_b128 v[192:195], v208 offset:32768
  v_add_f32 v225, v225, v130
  v_cvt_pk_bf16_f32 v128, v128, v129
  v_fma_f32 v135, v135, s42, v221
  v_exp_f32 v133, v133
  v_mfma_f32_32x32x16_bf16 v[16:31], v[196:199], v[168:171], v[16:31]
  buffer_load_dwordx4 a[212:215], v249, s[20:23], s57 offen offset:128 nt
  buffer_load_dwordx4 a[220:223], v249, s[20:23], s57 offen offset:192 nt
  v_add_f32 v226, v226, v131
  v_fma_f32 v144, v144, s42, v222
  v_xor_b32 v209, 0x10000, v209
  v_mfma_f32_32x32x16_bf16 v[80:95], v[196:199], v[184:187], v[80:95]
  ds_read_b128 v[196:199], v209 offset:32768
  v_exp_f32 v134, v134
  v_add_f32 v225, v225, v132
  v_cvt_pk_bf16_f32 v129, v130, v131
  v_fma_f32 v145, v145, s42, v222
  s_waitcnt lgkmcnt(2)
  v_mfma_f32_32x32x16_bf16 v[32:47], v[200:203], v[168:171], v[32:47]
  v_exp_f32 v135, v135
  v_add_f32 v226, v226, v133
  v_fma_f32 v146, v146, s42, v222
  v_xor_b32 v210, 0x10000, v210
  v_mfma_f32_32x32x16_bf16 v[96:111], v[200:203], v[184:187], v[96:111]
  ds_read_b128 v[200:203], v210 offset:32768
  v_exp_f32 v144, v144
  v_add_f32 v225, v225, v134
  v_cvt_pk_bf16_f32 v130, v132, v133
  v_fma_f32 v147, v147, s42, v222
  v_mfma_f32_32x32x16_bf16 v[48:63], v[204:207], v[168:171], v[48:63]
  v_exp_f32 v145, v145
  v_add_f32 v226, v226, v135
  v_fma_f32 v148, v148, s42, v222
  v_exp_f32 v146, v146
  v_xor_b32 v211, 0x10000, v211
  v_mfma_f32_32x32x16_bf16 v[112:127], v[204:207], v[184:187], v[112:127]
  ds_read_b128 v[204:207], v211 offset:32768
  v_add_f32 v227, v227, v144
  v_cvt_pk_bf16_f32 v131, v134, v135
  v_fma_f32 v149, v149, s42, v222
  s_waitcnt lgkmcnt(2)
  v_mfma_f32_32x32x16_bf16 v[160:175], v[192:195], a[128:131], 0
  v_exp_f32 v147, v147
  v_add_f32 v228, v228, v145
  v_fma_f32 v150, v150, s42, v222
  v_exp_f32 v148, v148
  v_xor_b32 v212, 0x10000, v212
  v_mfma_f32_32x32x16_bf16 v[176:191], v[192:195], a[160:163], 0
  ds_read_b128 v[192:195], v212 offset:32768
  v_add_f32 v227, v227, v146
  v_cvt_pk_bf16_f32 v144, v144, v145
  v_fma_f32 v151, v151, s42, v222
  v_exp_f32 v149, v149
  v_mfma_f32_32x32x16_bf16 v[160:175], v[196:199], a[132:135], v[160:175]
  v_add_f32 v228, v228, v147
  v_fma_f32 v136, v136, s42, v221
  v_exp_f32 v150, v150
  v_add_f32 v227, v227, v148
  v_xor_b32 v213, 0x10000, v213
  v_mfma_f32_32x32x16_bf16 v[176:191], v[196:199], a[164:167], v[176:191]
  ds_read_b128 v[196:199], v213 offset:32768
  v_cvt_pk_bf16_f32 v145, v146, v147
  v_fma_f32 v137, v137, s42, v221
  v_exp_f32 v151, v151
  s_waitcnt lgkmcnt(2)
  v_mfma_f32_32x32x16_bf16 v[160:175], v[200:203], a[136:139], v[160:175]
  v_add_f32 v228, v228, v149
  v_fma_f32 v138, v138, s42, v221
  v_exp_f32 v136, v136
  v_add_f32 v227, v227, v150
  v_xor_b32 v214, 0x10000, v214
  v_mfma_f32_32x32x16_bf16 v[176:191], v[200:203], a[168:171], v[176:191]
  ds_read_b128 v[200:203], v214 offset:32768
  v_cvt_pk_bf16_f32 v146, v148, v149
  v_fma_f32 v139, v139, s42, v221
  v_exp_f32 v137, v137
  v_add_f32 v228, v228, v151
  v_mfma_f32_32x32x16_bf16 v[160:175], v[204:207], a[140:143], v[160:175]
  v_fma_f32 v140, v140, s42, v221
  v_exp_f32 v138, v138
  v_add_f32 v225, v225, v136
  v_cvt_pk_bf16_f32 v147, v150, v151
  v_xor_b32 v215, 0x10000, v215
  v_mfma_f32_32x32x16_bf16 v[176:191], v[204:207], a[172:175], v[176:191]
  ds_read_b128 v[204:207], v215 offset:32768
  v_fma_f32 v141, v141, s42, v221
  v_exp_f32 v139, v139
  s_waitcnt lgkmcnt(2)
  v_mfma_f32_32x32x16_bf16 v[160:175], v[192:195], a[144:147], v[160:175]
  v_add_f32 v226, v226, v137
  v_fma_f32 v142, v142, s42, v221
  v_exp_f32 v140, v140
  v_mfma_f32_32x32x16_bf16 v[176:191], v[192:195], a[176:179], v[176:191]
  v_add_f32 v225, v225, v138
  v_cvt_pk_bf16_f32 v136, v136, v137
  v_fma_f32 v143, v143, s42, v221
  v_exp_f32 v141, v141
  v_mfma_f32_32x32x16_bf16 v[160:175], v[196:199], a[148:151], v[160:175]
  v_add_f32 v226, v226, v139
  v_fma_f32 v152, v152, s42, v222
  v_exp_f32 v142, v142
  v_mfma_f32_32x32x16_bf16 v[176:191], v[196:199], a[180:183], v[176:191]
  v_add_f32 v225, v225, v140
  v_cvt_pk_bf16_f32 v137, v138, v139
  v_fma_f32 v153, v153, s42, v222
  s_waitcnt lgkmcnt(0)
  v_mfma_f32_32x32x16_bf16 v[160:175], v[200:203], a[152:155], v[160:175]
  v_exp_f32 v143, v143
  v_add_f32 v226, v226, v141
  v_fma_f32 v154, v154, s42, v222
  v_mfma_f32_32x32x16_bf16 v[176:191], v[200:203], a[184:187], v[176:191]
  v_exp_f32 v152, v152
  v_add_f32 v225, v225, v142
  v_cvt_pk_bf16_f32 v138, v140, v141
  v_mfma_f32_32x32x16_bf16 v[160:175], v[204:207], a[156:159], v[160:175]
  v_fma_f32 v155, v155, s42, v222
  v_exp_f32 v153, v153
  v_add_f32 v226, v226, v143
  v_mfma_f32_32x32x16_bf16 v[176:191], v[204:207], a[188:191], v[176:191]
  v_fma_f32 v156, v156, s42, v222
  v_exp_f32 v154, v154
  v_add_f32 v227, v227, v152
  v_mfma_f32_32x32x16_bf16 v[0:15], a[0:3], v[128:131], v[0:15]
  v_cvt_pk_bf16_f32 v139, v142, v143
  v_fma_f32 v157, v157, s42, v222
  v_exp_f32 v155, v155
  v_mfma_f32_32x32x16_bf16 v[64:79], a[0:3], v[144:147], v[64:79]
  v_add_f32 v228, v228, v153
  v_fma_f32 v160, v160, s42, v221
  v_fma_f32 v158, v158, s42, v222
  v_fma_f32 v161, v161, s42, v221
  v_exp_f32 v156, v156
  v_mfma_f32_32x32x16_bf16 v[16:31], a[4:7], v[128:131], v[16:31]
  v_add_f32 v227, v227, v154
  v_fma_f32 v162, v162, s42, v221
  v_cvt_pk_bf16_f32 v152, v152, v153
  v_fma_f32 v159, v159, s42, v222
  v_exp_f32 v157, v157
  v_mfma_f32_32x32x16_bf16 v[80:95], a[4:7], v[144:147], v[80:95]
  v_add_f32 v228, v228, v155
  v_exp_f32 v160, v160
  v_exp_f32 v158, v158
  v_add_f32 v227, v227, v156
  v_mfma_f32_32x32x16_bf16 v[32:47], a[8:11], v[128:131], v[32:47]
  v_cvt_pk_bf16_f32 v153, v154, v155
  v_fma_f32 v163, v163, s42, v221
  v_exp_f32 v159, v159
  v_add_f32 v228, v228, v157
  v_mfma_f32_32x32x16_bf16 v[96:111], a[8:11], v[144:147], v[96:111]
  v_add_f32 v227, v227, v158
  v_exp_f32 v161, v161
  v_cvt_pk_bf16_f32 v154, v156, v157
  v_add_f32 v228, v228, v159
  v_cvt_pk_bf16_f32 v155, v158, v159
  v_mfma_f32_32x32x16_bf16 v[48:63], a[12:15], v[128:131], v[48:63]
  v_fma_f32 v164, v164, s42, v221
  v_exp_f32 v162, v162
  v_add_f32 v225, v225, v160
  v_fma_f32 v165, v165, s42, v221
  v_mfma_f32_32x32x16_bf16 v[112:127], a[12:15], v[144:147], v[112:127]
  v_exp_f32 v163, v163
  v_add_f32 v226, v226, v161
  v_fma_f32 v166, v166, s42, v221
  v_exp_f32 v164, v164
  v_mfma_f32_32x32x16_bf16 v[0:15], a[16:19], v[136:139], v[0:15]
  v_add_f32 v225, v225, v162
  v_cvt_pk_bf16_f32 v160, v160, v161
  v_fma_f32 v167, v167, s42, v221
  v_exp_f32 v165, v165
  v_xor_b32 v208, 0x10000, v208
  v_mfma_f32_32x32x16_bf16 v[64:79], a[16:19], v[152:155], v[64:79]
  ds_read_b128 v[192:195], v208 offset:8192
  v_add_f32 v226, v226, v163
  v_fma_f32 v176, v176, s42, v222
  v_exp_f32 v166, v166
  v_mfma_f32_32x32x16_bf16 v[16:31], a[20:23], v[136:139], v[16:31]
  v_add_f32 v225, v225, v164
  v_cvt_pk_bf16_f32 v161, v162, v163
  v_fma_f32 v177, v177, s42, v222
  v_exp_f32 v167, v167
  v_xor_b32 v209, 0x10000, v209
  v_mfma_f32_32x32x16_bf16 v[80:95], a[20:23], v[152:155], v[80:95]
  ds_read_b128 v[196:199], v209 offset:8192
  v_add_f32 v226, v226, v165
  v_fma_f32 v178, v178, s42, v222
  v_exp_f32 v176, v176
  v_mfma_f32_32x32x16_bf16 v[32:47], a[24:27], v[136:139], v[32:47]
  v_add_f32 v225, v225, v166
  v_cvt_pk_bf16_f32 v162, v164, v165
  v_fma_f32 v179, v179, s42, v222
  v_exp_f32 v177, v177
  v_xor_b32 v210, 0x10000, v210
  v_mfma_f32_32x32x16_bf16 v[96:111], a[24:27], v[152:155], v[96:111]
  ds_read_b128 v[200:203], v210 offset:8192
  v_add_f32 v226, v226, v167
  v_fma_f32 v180, v180, s42, v222
  v_exp_f32 v178, v178
  v_mfma_f32_32x32x16_bf16 v[48:63], a[28:31], v[136:139], v[48:63]
  v_add_f32 v227, v227, v176
  v_cvt_pk_bf16_f32 v163, v166, v167
  v_fma_f32 v181, v181, s42, v222
  v_exp_f32 v179, v179
  v_xor_b32 v211, 0x10000, v211
  v_mfma_f32_32x32x16_bf16 v[112:127], a[28:31], v[152:155], v[112:127]
  ds_read_b128 v[204:207], v211 offset:8192
  v_add_f32 v228, v228, v177
  v_fma_f32 v182, v182, s42, v222
  s_waitcnt lgkmcnt(2)
  v_mfma_f32_32x32x16_bf16 v[128:143], v[192:195], a[128:131], 0
  v_exp_f32 v180, v180
  v_add_f32 v227, v227, v178
  v_cvt_pk_bf16_f32 v176, v176, v177
  v_fma_f32 v183, v183, s42, v222
  v_xor_b32 v212, 0x10000, v212
  v_mfma_f32_32x32x16_bf16 v[144:159], v[192:195], a[160:163], 0
  ds_read_b128 v[192:195], v212 offset:8192
  v_exp_f32 v181, v181
  v_add_f32 v228, v228, v179
  v_fma_f32 v168, v168, s42, v221
  v_mfma_f32_32x32x16_bf16 v[128:143], v[196:199], a[132:135], v[128:143]
  v_exp_f32 v182, v182
  v_add_f32 v227, v227, v180
  v_cvt_pk_bf16_f32 v177, v178, v179
  v_fma_f32 v169, v169, s42, v221
  v_xor_b32 v213, 0x10000, v213
  v_mfma_f32_32x32x16_bf16 v[144:159], v[196:199], a[164:167], v[144:159]
  ds_read_b128 v[196:199], v213 offset:8192
  v_exp_f32 v183, v183
  v_add_f32 v228, v228, v181
  v_fma_f32 v170, v170, s42, v221
  s_waitcnt lgkmcnt(2)
  v_mfma_f32_32x32x16_bf16 v[128:143], v[200:203], a[136:139], v[128:143]
  v_exp_f32 v168, v168
  v_add_f32 v227, v227, v182
  v_cvt_pk_bf16_f32 v178, v180, v181
  v_xor_b32 v214, 0x10000, v214
  v_mfma_f32_32x32x16_bf16 v[144:159], v[200:203], a[168:171], v[144:159]
  ds_read_b128 v[200:203], v214 offset:8192
  v_fma_f32 v171, v171, s42, v221
  v_exp_f32 v169, v169
  v_add_f32 v228, v228, v183
  v_fma_f32 v172, v172, s42, v221
  v_mfma_f32_32x32x16_bf16 v[128:143], v[204:207], a[140:143], v[128:143]
  v_exp_f32 v170, v170
  v_add_f32 v225, v225, v168
  v_cvt_pk_bf16_f32 v179, v182, v183
  v_xor_b32 v215, 0x10000, v215
  v_mfma_f32_32x32x16_bf16 v[144:159], v[204:207], a[172:175], v[144:159]
  ds_read_b128 v[204:207], v215 offset:8192
  v_fma_f32 v173, v173, s42, v221
  v_exp_f32 v171, v171
  s_waitcnt lgkmcnt(2)
  v_mfma_f32_32x32x16_bf16 v[128:143], v[192:195], a[144:147], v[128:143]
  v_add_f32 v226, v226, v169
  v_fma_f32 v174, v174, s42, v221
  v_exp_f32 v172, v172
  v_mfma_f32_32x32x16_bf16 v[144:159], v[192:195], a[176:179], v[144:159]
  v_add_f32 v225, v225, v170
  v_cvt_pk_bf16_f32 v168, v168, v169
  v_fma_f32 v175, v175, s42, v221
  v_exp_f32 v173, v173
  v_mfma_f32_32x32x16_bf16 v[128:143], v[196:199], a[148:151], v[128:143]
  v_add_f32 v226, v226, v171
  v_fma_f32 v184, v184, s42, v222
  v_exp_f32 v174, v174
  v_mfma_f32_32x32x16_bf16 v[144:159], v[196:199], a[180:183], v[144:159]
  v_add_f32 v225, v225, v172
  v_cvt_pk_bf16_f32 v169, v170, v171
  v_fma_f32 v185, v185, s42, v222
  s_waitcnt lgkmcnt(0)
  v_mfma_f32_32x32x16_bf16 v[128:143], v[200:203], a[152:155], v[128:143]
  v_exp_f32 v175, v175
  v_add_f32 v226, v226, v173
  v_fma_f32 v186, v186, s42, v222
  v_mfma_f32_32x32x16_bf16 v[144:159], v[200:203], a[184:187], v[144:159]
  v_exp_f32 v184, v184
  v_add_f32 v225, v225, v174
  v_cvt_pk_bf16_f32 v170, v172, v173
  v_mfma_f32_32x32x16_bf16 v[128:143], v[204:207], a[156:159], v[128:143]
  v_fma_f32 v187, v187, s42, v222
  v_exp_f32 v185, v185
  v_add_f32 v226, v226, v175
  v_mfma_f32_32x32x16_bf16 v[144:159], v[204:207], a[188:191], v[144:159]
  v_fma_f32 v188, v188, s42, v222
  v_exp_f32 v186, v186
  v_add_f32 v227, v227, v184
  v_mfma_f32_32x32x16_bf16 v[0:15], a[32:35], v[160:163], v[0:15]
  v_cvt_pk_bf16_f32 v171, v174, v175
  v_fma_f32 v189, v189, s42, v222
  v_exp_f32 v187, v187
  v_mfma_f32_32x32x16_bf16 v[64:79], a[32:35], v[176:179], v[64:79]
  v_add_f32 v228, v228, v185
  v_fma_f32 v128, v128, s42, v221
  v_fma_f32 v190, v190, s42, v222
  v_fma_f32 v129, v129, s42, v221
  v_exp_f32 v188, v188
  v_mfma_f32_32x32x16_bf16 v[16:31], a[36:39], v[160:163], v[16:31]
  v_add_f32 v227, v227, v186
  v_fma_f32 v130, v130, s42, v221
  v_cvt_pk_bf16_f32 v184, v184, v185
  v_fma_f32 v191, v191, s42, v222
  v_exp_f32 v189, v189
  v_mfma_f32_32x32x16_bf16 v[80:95], a[36:39], v[176:179], v[80:95]
  v_add_f32 v228, v228, v187
  v_exp_f32 v128, v128
  v_exp_f32 v190, v190
  v_add_f32 v227, v227, v188
  v_mfma_f32_32x32x16_bf16 v[32:47], a[40:43], v[160:163], v[32:47]
  v_cvt_pk_bf16_f32 v185, v186, v187
  v_fma_f32 v131, v131, s42, v221
  v_exp_f32 v191, v191
  v_add_f32 v228, v228, v189
  v_mfma_f32_32x32x16_bf16 v[96:111], a[40:43], v[176:179], v[96:111]
  v_add_f32 v227, v227, v190
  v_exp_f32 v129, v129
  v_cvt_pk_bf16_f32 v186, v188, v189
  v_add_f32 v228, v228, v191
  v_cvt_pk_bf16_f32 v187, v190, v191
  v_mfma_f32_32x32x16_bf16 v[48:63], a[44:47], v[160:163], v[48:63]
  v_fma_f32 v132, v132, s42, v221
  v_exp_f32 v130, v130
  v_add_f32 v225, v225, v128
  v_fma_f32 v133, v133, s42, v221
  v_exp_f32 v131, v131
  v_mfma_f32_32x32x16_bf16 v[112:127], a[44:47], v[176:179], v[112:127]
  v_add_f32 v226, v226, v129
  v_fma_f32 v134, v134, s42, v221
  v_exp_f32 v132, v132
  v_add_f32 v225, v225, v130
  v_mfma_f32_32x32x16_bf16 v[0:15], a[48:51], v[168:171], v[0:15]
  v_cvt_pk_bf16_f32 v128, v128, v129
  v_fma_f32 v135, v135, s42, v221
  v_exp_f32 v133, v133
  v_add_f32 v226, v226, v131
  s_barrier
  v_mfma_f32_32x32x16_bf16 v[64:79], a[48:51], v[184:187], v[64:79]
  ds_read_b128 v[192:195], v208 offset:16384
  v_fma_f32 v144, v144, s42, v222
  v_exp_f32 v134, v134
  v_add_f32 v225, v225, v132
  v_mfma_f32_32x32x16_bf16 v[16:31], a[52:55], v[168:171], v[16:31]
  s_add_u32 m0, s40, 32768
  s_add_u32 s41, s8, 0
  buffer_load_dwordx4 v253, s[24:27], s41 offen lds
  v_cvt_pk_bf16_f32 v129, v130, v131
  v_fma_f32 v145, v145, s42, v222
  v_exp_f32 v135, v135
  v_mfma_f32_32x32x16_bf16 v[80:95], a[52:55], v[184:187], v[80:95]
  ds_read_b128 v[196:199], v209 offset:16384
  v_add_f32 v226, v226, v133
  v_fma_f32 v146, v146, s42, v222
  v_exp_f32 v144, v144
  v_mfma_f32_32x32x16_bf16 v[32:47], a[56:59], v[168:171], v[32:47]
  s_add_u32 m0, s40, 36864
  s_add_u32 s41, s8, 4096
  buffer_load_dwordx4 v253, s[24:27], s41 offen lds
  v_add_f32 v225, v225, v134
  v_cvt_pk_bf16_f32 v130, v132, v133
  v_fma_f32 v147, v147, s42, v222
  v_mfma_f32_32x32x16_bf16 v[96:111], a[56:59], v[184:187], v[96:111]
  ds_read_b128 v[200:203], v210 offset:16384
  v_exp_f32 v145, v145
  v_add_f32 v226, v226, v135
  v_fma_f32 v148, v148, s42, v222
  v_mfma_f32_32x32x16_bf16 v[48:63], a[60:63], v[168:171], v[48:63]
  v_exp_f32 v146, v146
  v_add_f32 v227, v227, v144
  v_cvt_pk_bf16_f32 v131, v134, v135
  v_fma_f32 v149, v149, s42, v222
  v_exp_f32 v147, v147
  v_mfma_f32_32x32x16_bf16 v[112:127], a[60:63], v[184:187], v[112:127]
  ds_read_b128 v[204:207], v211 offset:16384
  v_add_f32 v228, v228, v145
  v_fma_f32 v150, v150, s42, v222
  s_waitcnt lgkmcnt(2)
  v_mfma_f32_32x32x16_bf16 v[160:175], v[192:195], a[128:131], 0
  v_exp_f32 v148, v148
  v_add_f32 v227, v227, v146
  v_cvt_pk_bf16_f32 v144, v144, v145
  v_fma_f32 v151, v151, s42, v222
  v_exp_f32 v149, v149
  v_mfma_f32_32x32x16_bf16 v[176:191], v[192:195], a[160:163], 0
  ds_read_b128 v[192:195], v212 offset:16384
  v_add_f32 v228, v228, v147
  v_fma_f32 v136, v136, s42, v221
  v_exp_f32 v150, v150
  v_mfma_f32_32x32x16_bf16 v[160:175], v[196:199], a[132:135], v[160:175]
  v_add_f32 v227, v227, v148
  v_cvt_pk_bf16_f32 v145, v146, v147
  v_fma_f32 v137, v137, s42, v221
  v_exp_f32 v151, v151
  v_add_f32 v228, v228, v149
  v_mfma_f32_32x32x16_bf16 v[176:191], v[196:199], a[164:167], v[176:191]
  ds_read_b128 v[196:199], v213 offset:16384
  s_waitcnt vmcnt(9)
  ds_write_b128 v250, a[192:195] offset:0
  s_waitcnt vmcnt(7)
  ds_write_b128 v250, a[196:199] offset:1024
  s_waitcnt lgkmcnt(4)
  v_mfma_f32_32x32x16_bf16 v[160:175], v[200:203], a[136:139], v[160:175]
  v_fma_f32 v138, v138, s42, v221
  v_exp_f32 v136, v136
  v_add_f32 v227, v227, v150
  v_cvt_pk_bf16_f32 v146, v148, v149
  v_fma_f32 v139, v139, s42, v221
  v_mfma_f32_32x32x16_bf16 v[176:191], v[200:203], a[168:171], v[176:191]
  ds_read_b128 v[200:203], v214 offset:16384
  ds_read_b128 a[128:131], v245
  ds_read_b128 a[132:135], v246
  v_exp_f32 v137, v137
  v_mfma_f32_32x32x16_bf16 v[160:175], v[204:207], a[140:143], v[160:175]
  v_add_f32 v228, v228, v151
  v_fma_f32 v140, v140, s42, v221
  v_exp_f32 v138, v138
  v_add_f32 v225, v225, v136
  v_cvt_pk_bf16_f32 v147, v150, v151
  v_mfma_f32_32x32x16_bf16 v[176:191], v[204:207], a[172:175], v[176:191]
  ds_read_b128 v[204:207], v215 offset:16384
  ds_write_b128 v250, a[200:203] offset:0
  s_waitcnt vmcnt(6)
  ds_write_b128 v250, a[204:207] offset:1024
  s_waitcnt lgkmcnt(6)
  v_mfma_f32_32x32x16_bf16 v[160:175], v[192:195], a[144:147], v[160:175]
  v_fma_f32 v141, v141, s42, v221
  v_exp_f32 v139, v139
  v_add_f32 v226, v226, v137
  v_fma_f32 v142, v142, s42, v221
  v_mfma_f32_32x32x16_bf16 v[176:191], v[192:195], a[176:179], v[176:191]
  ds_read_b128 a[136:139], v245
  ds_read_b128 a[140:143], v246
  v_exp_f32 v140, v140
  v_add_f32 v225, v225, v138
  v_cvt_pk_bf16_f32 v136, v136, v137
  v_mfma_f32_32x32x16_bf16 v[160:175], v[196:199], a[148:151], v[160:175]
  v_fma_f32 v143, v143, s42, v221
  v_exp_f32 v141, v141
  v_add_f32 v226, v226, v139
  v_fma_f32 v152, v152, s42, v222
  v_mfma_f32_32x32x16_bf16 v[176:191], v[196:199], a[180:183], v[176:191]
  s_waitcnt vmcnt(5)
  ds_write_b128 v250, a[208:211] offset:0
  s_waitcnt vmcnt(3)
  ds_write_b128 v250, a[212:215] offset:1024
  s_waitcnt lgkmcnt(4)
  v_mfma_f32_32x32x16_bf16 v[160:175], v[200:203], a[152:155], v[160:175]
  v_exp_f32 v142, v142
  v_add_f32 v225, v225, v140
  v_cvt_pk_bf16_f32 v137, v138, v139
  v_fma_f32 v153, v153, s42, v222
  v_exp_f32 v143, v143
  v_mfma_f32_32x32x16_bf16 v[176:191], v[200:203], a[184:187], v[176:191]
  ds_read_b128 a[144:147], v245
  ds_read_b128 a[148:151], v246
  v_add_f32 v226, v226, v141
  v_fma_f32 v154, v154, s42, v222
  v_mfma_f32_32x32x16_bf16 v[160:175], v[204:207], a[156:159], v[160:175]
  v_exp_f32 v152, v152
  v_add_f32 v225, v225, v142
  v_cvt_pk_bf16_f32 v138, v140, v141
  v_fma_f32 v155, v155, s42, v222
  v_exp_f32 v153, v153
  v_mfma_f32_32x32x16_bf16 v[176:191], v[204:207], a[188:191], v[176:191]
  ds_write_b128 v250, a[216:219] offset:0
  s_waitcnt vmcnt(2)
  ds_write_b128 v250, a[220:223] offset:1024
  v_mfma_f32_32x32x16_bf16 v[0:15], a[64:67], v[128:131], v[0:15]
  v_add_f32 v226, v226, v143
  v_fma_f32 v156, v156, s42, v222
  v_exp_f32 v154, v154
  v_add_f32 v227, v227, v152
  v_mfma_f32_32x32x16_bf16 v[64:79], a[64:67], v[144:147], v[64:79]
  ds_read_b128 a[152:155], v245
  ds_read_b128 a[156:159], v246
  v_cvt_pk_bf16_f32 v139, v142, v143
  v_fma_f32 v160, v160, s42, v221
  v_fma_f32 v157, v157, s42, v222
  v_fma_f32 v161, v161, s42, v221
  v_exp_f32 v155, v155
  v_mfma_f32_32x32x16_bf16 v[16:31], a[68:71], v[128:131], v[16:31]
  v_add_f32 v228, v228, v153
  v_fma_f32 v162, v162, s42, v221
  v_fma_f32 v158, v158, s42, v222
  v_exp_f32 v160, v160
  v_exp_f32 v156, v156
  v_add_f32 v227, v227, v154
  v_mfma_f32_32x32x16_bf16 v[80:95], a[68:71], v[144:147], v[80:95]
  v_cvt_pk_bf16_f32 v152, v152, v153
  v_fma_f32 v163, v163, s42, v221
  v_fma_f32 v159, v159, s42, v222
  v_exp_f32 v161, v161
  v_exp_f32 v157, v157
  v_add_f32 v228, v228, v155
  v_mfma_f32_32x32x16_bf16 v[32:47], a[72:75], v[128:131], v[32:47]
  v_exp_f32 v158, v158
  v_fma_f32 v164, v164, s42, v221
  v_add_f32 v227, v227, v156
  v_cvt_pk_bf16_f32 v153, v154, v155
  v_exp_f32 v159, v159
  v_mfma_f32_32x32x16_bf16 v[96:111], a[72:75], v[144:147], v[96:111]
  v_add_f32 v228, v228, v157
  v_exp_f32 v162, v162
  v_add_f32 v227, v227, v158
  v_add_f32 v225, v225, v160
  v_cvt_pk_bf16_f32 v154, v156, v157
  v_add_f32 v228, v228, v159
  v_cvt_pk_bf16_f32 v155, v158, v159
  v_mfma_f32_32x32x16_bf16 v[48:63], a[76:79], v[128:131], v[48:63]
  v_fma_f32 v165, v165, s42, v221
  v_exp_f32 v163, v163
  v_add_f32 v226, v226, v161
  v_fma_f32 v166, v166, s42, v221
  v_exp_f32 v164, v164
  v_mfma_f32_32x32x16_bf16 v[112:127], a[76:79], v[144:147], v[112:127]
  v_add_f32 v225, v225, v162
  v_cvt_pk_bf16_f32 v160, v160, v161
  v_fma_f32 v167, v167, s42, v221
  v_exp_f32 v165, v165
  v_add_f32 v226, v226, v163
  v_fma_f32 v176, v176, s42, v222
  v_mfma_f32_32x32x16_bf16 v[0:15], a[80:83], v[136:139], v[0:15]
  v_exp_f32 v166, v166
  v_add_f32 v225, v225, v164
  v_cvt_pk_bf16_f32 v161, v162, v163
  v_fma_f32 v177, v177, s42, v222
  v_exp_f32 v167, v167
  v_xor_b32 v208, 0x10000, v208
  v_mfma_f32_32x32x16_bf16 v[64:79], a[80:83], v[152:155], v[64:79]
  ds_read_b128 v[192:195], v208 offset:0
  v_add_f32 v226, v226, v165
  v_fma_f32 v178, v178, s42, v222
  v_exp_f32 v176, v176
  v_add_f32 v225, v225, v166
  v_xor_b32 v209, 0x10000, v209
  v_mfma_f32_32x32x16_bf16 v[16:31], a[84:87], v[136:139], v[16:31]
  ds_read_b128 v[196:199], v209 offset:0
  v_cvt_pk_bf16_f32 v162, v164, v165
  v_fma_f32 v179, v179, s42, v222
  v_exp_f32 v177, v177
  v_add_f32 v226, v226, v167
  v_fma_f32 v180, v180, s42, v222
  v_xor_b32 v210, 0x10000, v210
  v_mfma_f32_32x32x16_bf16 v[80:95], a[84:87], v[152:155], v[80:95]
  ds_read_b128 v[200:203], v210 offset:0
  v_exp_f32 v178, v178
  v_add_f32 v227, v227, v176
  v_cvt_pk_bf16_f32 v163, v166, v167
  v_fma_f32 v181, v181, s42, v222
  v_xor_b32 v211, 0x10000, v211
  v_mfma_f32_32x32x16_bf16 v[32:47], a[88:91], v[136:139], v[32:47]
  ds_read_b128 v[204:207], v211 offset:0
  v_exp_f32 v179, v179
  v_add_f32 v228, v228, v177
  v_fma_f32 v182, v182, s42, v222
  v_exp_f32 v180, v180
  v_add_f32 v227, v227, v178
  v_mfma_f32_32x32x16_bf16 v[96:111], a[88:91], v[152:155], v[96:111]
  v_cvt_pk_bf16_f32 v176, v176, v177
  v_fma_f32 v183, v183, s42, v222
  v_exp_f32 v181, v181
  v_add_f32 v228, v228, v179
  v_fma_f32 v168, v168, s42, v221
  v_exp_f32 v182, v182
  v_mfma_f32_32x32x16_bf16 v[48:63], a[92:95], v[136:139], v[48:63]
  v_add_f32 v227, v227, v180
  v_cvt_pk_bf16_f32 v177, v178, v179
  v_fma_f32 v169, v169, s42, v221
  v_xor_b32 v212, 0x10000, v212
  v_xor_b32 v213, 0x10000, v213
  v_xor_b32 v214, 0x10000, v214
  v_mfma_f32_32x32x16_bf16 v[112:127], a[92:95], v[152:155], v[112:127]
  ds_read_b128 v[144:147], v212 offset:0
  ds_read_b128 v[148:151], v213 offset:0
  ds_read_b128 v[152:155], v214 offset:0
  v_exp_f32 v183, v183
  v_add_f32 v228, v228, v181
  v_xor_b32 v215, 0x10000, v215
  s_waitcnt lgkmcnt(4)
  v_mfma_f32_32x32x16_bf16 v[128:143], v[192:195], a[128:131], 0
  ds_read_b128 v[156:159], v215 offset:0
  v_fma_f32 v170, v170, s42, v221
  v_exp_f32 v168, v168
  v_add_f32 v227, v227, v182
  v_cvt_pk_bf16_f32 v178, v180, v181
  v_fma_f32 v171, v171, s42, v221
  v_mfma_f32_32x32x16_bf16 v[128:143], v[196:199], a[132:135], v[128:143]
  v_exp_f32 v169, v169
  v_add_f32 v228, v228, v183
  v_fma_f32 v172, v172, s42, v221
  v_exp_f32 v170, v170
  v_add_f32 v225, v225, v168
  v_cvt_pk_bf16_f32 v179, v182, v183
  v_mfma_f32_32x32x16_bf16 v[128:143], v[200:203], a[136:139], v[128:143]
  v_fma_f32 v173, v173, s42, v221
  v_exp_f32 v171, v171
  v_add_f32 v226, v226, v169
  s_waitcnt lgkmcnt(4)
  v_mfma_f32_32x32x16_bf16 v[128:143], v[204:207], a[140:143], v[128:143]
  v_fma_f32 v174, v174, s42, v221
  v_exp_f32 v172, v172
  v_add_f32 v225, v225, v170
  v_cvt_pk_bf16_f32 v168, v168, v169
  s_waitcnt lgkmcnt(1)
  v_mfma_f32_32x32x16_bf16 v[128:143], v[144:147], a[144:147], v[128:143]
  v_fma_f32 v175, v175, s42, v221
  v_exp_f32 v173, v173
  v_add_f32 v226, v226, v171
  v_fma_f32 v184, v184, s42, v222
  v_mfma_f32_32x32x16_bf16 v[128:143], v[148:151], a[148:151], v[128:143]
  v_exp_f32 v174, v174
  v_add_f32 v225, v225, v172
  v_cvt_pk_bf16_f32 v169, v170, v171
  v_fma_f32 v185, v185, s42, v222
  v_mfma_f32_32x32x16_bf16 v[128:143], v[152:155], a[152:155], v[128:143]
  v_exp_f32 v175, v175
  v_add_f32 v226, v226, v173
  v_fma_f32 v186, v186, s42, v222
  s_waitcnt lgkmcnt(0)
  v_mfma_f32_32x32x16_bf16 v[128:143], v[156:159], a[156:159], v[128:143]
  v_exp_f32 v184, v184
  v_add_f32 v225, v225, v174
  v_cvt_pk_bf16_f32 v170, v172, v173
  v_fma_f32 v187, v187, s42, v222
  v_mfma_f32_32x32x16_bf16 v[0:15], a[96:99], v[160:163], v[0:15]
  v_exp_f32 v185, v185
  v_add_f32 v226, v226, v175
  v_fma_f32 v188, v188, s42, v222
  v_exp_f32 v186, v186
  v_mfma_f32_32x32x16_bf16 v[64:79], a[96:99], v[176:179], v[64:79]
  v_add_f32 v227, v227, v184
  s_nop 0
  v_max3_f32 v233, v128, v129, v130
  v_cvt_pk_bf16_f32 v171, v174, v175
  v_max3_f32 v234, v131, v132, v133
  v_fma_f32 v189, v189, s42, v222
  v_exp_f32 v187, v187
  v_mfma_f32_32x32x16_bf16 v[16:31], a[100:103], v[160:163], v[16:31]
  v_add_f32 v228, v228, v185
  v_max3_f32 v235, v134, v135, v136
  v_fma_f32 v190, v190, s42, v222
  v_max3_f32 v236, v137, v138, v139
  v_exp_f32 v188, v188
  v_add_f32 v227, v227, v186
  v_mfma_f32_32x32x16_bf16 v[80:95], a[100:103], v[176:179], v[80:95]
  v_cvt_pk_bf16_f32 v184, v184, v185
  v_max3_f32 v233, v233, v140, v141
  v_fma_f32 v191, v191, s42, v222
  v_max3_f32 v234, v234, v142, v143
  v_exp_f32 v189, v189
  v_add_f32 v228, v228, v187
  v_mfma_f32_32x32x16_bf16 v[32:47], a[104:107], v[160:163], v[32:47]
  v_exp_f32 v190, v190
  v_max3_f32 v235, v235, v236, v233
  v_add_f32 v227, v227, v188
  v_cvt_pk_bf16_f32 v185, v186, v187
  v_exp_f32 v191, v191
  v_mfma_f32_32x32x16_bf16 v[96:111], a[104:107], v[176:179], v[96:111]
  v_add_f32 v228, v228, v189
  v_max_f32 v233, v234, v235
  v_add_f32 v227, v227, v190
  v_mov_b32 v234, v233
  v_cvt_pk_bf16_f32 v186, v188, v189
  v_add_f32 v228, v228, v191
  v_cvt_pk_bf16_f32 v187, v190, v191
  v_mfma_f32_32x32x16_bf16 v[48:63], a[108:111], v[160:163], v[48:63]
  v_add_f32 v225, v225, v226
  v_add_f32 v227, v227, v228
  v_mov_b32 v226, v225
  v_mov_b32 v228, v227
  s_nop 0
  v_permlane32_swap_b32 v225, v226
  v_mfma_f32_32x32x16_bf16 v[112:127], a[108:111], v[176:179], v[112:127]
  v_permlane32_swap_b32 v227, v228
  v_add_f32 v225, v225, v226
  v_permlane32_swap_b32 v233, v234
  v_add_f32 v227, v227, v228
  v_rcp_f32 v251, v225
  v_mfma_f32_32x32x16_bf16 v[0:15], a[112:115], v[168:171], v[0:15]
  v_rcp_f32 v252, v227
  v_cmp_ngt_f32 s[38:39], s44, v225
  v_max_f32 v233, v233, v234
  v_cmp_ngt_f32 s[62:63], s44, v227
  s_nop 3
  v_mfma_f32_32x32x16_bf16 v[64:79], a[112:115], v[184:187], v[64:79]
  ds_read_b128 v[192:195], v208 offset:8192
  s_cmp_lg_u64 s[38:39], 0
  s_cselect_b32 s38, 8, 0
  s_or_b32 s45, s45, s38
  s_cmp_lg_u64 s[62:63], 0
  s_cselect_b32 s62, 16, 0
  s_or_b32 s45, s45, s62
  v_mfma_f32_32x32x16_bf16 v[16:31], a[116:119], v[168:171], v[16:31]
  ds_read_b128 v[196:199], v209 offset:8192
  v_mul_f32 v223, s43, v233
  v_fma_f32 v128, v128, s42, v223
  v_fma_f32 v129, v129, s42, v223
  v_fma_f32 v130, v130, s42, v223
  v_exp_f32 v128, v128
  v_mfma_f32_32x32x16_bf16 v[80:95], a[116:119], v[184:187], v[80:95]
  ds_read_b128 v[200:203], v210 offset:8192
  v_fma_f32 v131, v131, s42, v223
  v_mul_f32 v0, v0, v251
  v_exp_f32 v129, v129
  v_mul_f32 v1, v1, v251
  v_fma_f32 v132, v132, s42, v223
  v_mul_f32 v2, v2, v251
  v_exp_f32 v130, v130
  v_mul_f32 v3, v3, v251
  v_mul_f32 v4, v4, v251
  v_mul_f32 v5, v5, v251
  v_mul_f32 v6, v6, v251
  v_mul_f32 v7, v7, v251
  v_mul_f32 v8, v8, v251
  v_mul_f32 v9, v9, v251
  v_mul_f32 v10, v10, v251
  v_mul_f32 v11, v11, v251
  v_mul_f32 v12, v12, v251
  v_mul_f32 v13, v13, v251
  v_mul_f32 v14, v14, v251
  v_mul_f32 v15, v15, v251
  v_cvt_pk_bf16_f32 v0, v0, v1
  v_mfma_f32_32x32x16_bf16 v[32:47], a[120:123], v[168:171], v[32:47]
  ds_read_b128 v[204:207], v211 offset:8192
  v_add_f32 v229, 0, v128
  v_cvt_pk_bf16_f32 v1, v2, v3
  v_fma_f32 v133, v133, s42, v223
  v_cvt_pk_bf16_f32 v2, v4, v5
  v_exp_f32 v131, v131
  v_cvt_pk_bf16_f32 v3, v6, v7
  v_add_f32 v230, 0, v129
  v_cvt_pk_bf16_f32 v8, v8, v9
  v_fma_f32 v134, v134, s42, v223
  v_cvt_pk_bf16_f32 v9, v10, v11
  v_cvt_pk_bf16_f32 v10, v12, v13
  v_cvt_pk_bf16_f32 v11, v14, v15
  ds_write_b64 v247, v[0:1]
  ds_write_b64 v248, v[2:3]
  ds_write_b64 v255, v[8:9]
  ds_write_b64 v254, v[10:11]
  ds_read_b128 a[192:195], v250 offset:0
  ds_read_b128 a[196:199], v250 offset:1024
  v_mfma_f32_32x32x16_bf16 v[96:111], a[120:123], v[184:187], v[96:111]
  ds_read_b128 v[144:147], v212 offset:8192
  v_exp_f32 v132, v132
  v_mul_f32 v64, v64, v252
  v_add_f32 v229, v229, v130
  v_mul_f32 v65, v65, v252
  v_cvt_pk_bf16_f32 v128, v128, v129
  v_mul_f32 v66, v66, v252
  v_fma_f32 v135, v135, s42, v223
  v_mul_f32 v67, v67, v252
  v_mul_f32 v68, v68, v252
  v_mul_f32 v69, v69, v252
  v_mul_f32 v70, v70, v252
  v_mul_f32 v71, v71, v252
  v_mul_f32 v72, v72, v252
  v_mul_f32 v73, v73, v252
  v_mul_f32 v74, v74, v252
  v_mul_f32 v75, v75, v252
  v_mul_f32 v76, v76, v252
  v_mul_f32 v77, v77, v252
  v_mul_f32 v78, v78, v252
  v_mul_f32 v79, v79, v252
  v_cvt_pk_bf16_f32 v64, v64, v65
  v_cvt_pk_bf16_f32 v65, v66, v67
  v_mfma_f32_32x32x16_bf16 v[48:63], a[124:127], v[168:171], v[48:63]
  ds_read_b128 v[148:151], v213 offset:8192
  v_exp_f32 v133, v133
  v_cvt_pk_bf16_f32 v66, v68, v69
  v_add_f32 v230, v230, v131
  v_cvt_pk_bf16_f32 v67, v70, v71
  v_fma_f32 v136, v136, s42, v223
  v_cvt_pk_bf16_f32 v72, v72, v73
  v_exp_f32 v134, v134
  v_cvt_pk_bf16_f32 v73, v74, v75
  v_cvt_pk_bf16_f32 v74, v76, v77
  v_cvt_pk_bf16_f32 v75, v78, v79
  ds_write_b64 v247, v[64:65]
  ds_write_b64 v248, v[66:67]
  ds_write_b64 v255, v[72:73]
  ds_write_b64 v254, v[74:75]
  ds_read_b128 a[224:227], v250 offset:0
  ds_read_b128 a[228:231], v250 offset:1024
  v_mfma_f32_32x32x16_bf16 v[112:127], a[124:127], v[184:187], v[112:127]
  ds_read_b128 v[152:155], v214 offset:8192
  v_add_f32 v229, v229, v132
  v_mul_f32 v16, v16, v251
  v_cvt_pk_bf16_f32 v129, v130, v131
  v_mul_f32 v17, v17, v251
  v_fma_f32 v137, v137, s42, v223
  v_mul_f32 v18, v18, v251
  v_exp_f32 v135, v135
  v_mul_f32 v19, v19, v251
  v_mul_f32 v20, v20, v251
  v_mul_f32 v21, v21, v251
  v_mul_f32 v22, v22, v251
  v_mul_f32 v23, v23, v251
  v_mul_f32 v24, v24, v251
  v_mul_f32 v25, v25, v251
  v_mul_f32 v26, v26, v251
  v_mul_f32 v27, v27, v251
  v_mul_f32 v28, v28, v251
  v_mul_f32 v29, v29, v251
  v_mul_f32 v30, v30, v251
  v_mul_f32 v31, v31, v251
  v_cvt_pk_bf16_f32 v16, v16, v17
  s_waitcnt lgkmcnt(15)
  v_mfma_f32_32x32x16_bf16 v[160:175], v[192:195], a[128:131], 0
  ds_read_b128 v[156:159], v215 offset:8192
  v_add_f32 v230, v230, v133
  v_cvt_pk_bf16_f32 v17, v18, v19
  v_fma_f32 v138, v138, s42, v223
  v_cvt_pk_bf16_f32 v18, v20, v21
  v_exp_f32 v136, v136
  v_cvt_pk_bf16_f32 v19, v22, v23
  v_add_f32 v229, v229, v134
  v_cvt_pk_bf16_f32 v24, v24, v25
  v_cvt_pk_bf16_f32 v25, v26, v27
  v_cvt_pk_bf16_f32 v26, v28, v29
  v_cvt_pk_bf16_f32 v27, v30, v31
  ds_write_b64 v247, v[16:17]
  ds_write_b64 v248, v[18:19]
  ds_write_b64 v255, v[24:25]
  ds_write_b64 v254, v[26:27]
  ds_read_b128 a[200:203], v250 offset:0
  ds_read_b128 a[204:207], v250 offset:1024
  v_mfma_f32_32x32x16_bf16 v[160:175], v[196:199], a[132:135], v[160:175]
  ds_read_b64_tr_b16 v[192:193], v216 offset:0
  ds_read_b64_tr_b16 v[194:195], v216 offset:2048
  v_cvt_pk_bf16_f32 v130, v132, v133
  v_mul_f32 v80, v80, v252
  v_fma_f32 v139, v139, s42, v223
  v_mul_f32 v81, v81, v252
  v_exp_f32 v137, v137
  v_mul_f32 v82, v82, v252
  v_add_f32 v230, v230, v135
  v_mul_f32 v83, v83, v252
  v_mul_f32 v84, v84, v252
  v_mul_f32 v85, v85, v252
  v_mul_f32 v86, v86, v252
  v_mul_f32 v87, v87, v252
  v_mul_f32 v88, v88, v252
  v_mul_f32 v89, v89, v252
  v_mul_f32 v90, v90, v252
  v_mul_f32 v91, v91, v252
  v_mul_f32 v92, v92, v252
  v_mul_f32 v93, v93, v252
  v_mul_f32 v94, v94, v252
  v_mul_f32 v95, v95, v252
  v_cvt_pk_bf16_f32 v80, v80, v81
  v_mfma_f32_32x32x16_bf16 v[160:175], v[200:203], a[136:139], v[160:175]
  ds_read_b64_tr_b16 v[196:197], v217 offset:0
  ds_read_b64_tr_b16 v[198:199], v217 offset:2048
  v_fma_f32 v140, v140, s42, v223
  v_cvt_pk_bf16_f32 v81, v82, v83
  v_exp_f32 v138, v138
  v_cvt_pk_bf16_f32 v82, v84, v85
  v_add_f32 v229, v229, v136
  v_cvt_pk_bf16_f32 v83, v86, v87
  v_cvt_pk_bf16_f32 v131, v134, v135
  v_cvt_pk_bf16_f32 v88, v88, v89
  v_cvt_pk_bf16_f32 v89, v90, v91
  v_cvt_pk_bf16_f32 v90, v92, v93
  v_cvt_pk_bf16_f32 v91, v94, v95
  ds_write_b64 v247, v[80:81]
  ds_write_b64 v248, v[82:83]
  ds_write_b64 v255, v[88:89]
  ds_write_b64 v254, v[90:91]
  ds_read_b128 a[232:235], v250 offset:0
  ds_read_b128 a[236:239], v250 offset:1024
  v_mfma_f32_32x32x16_bf16 v[160:175], v[204:207], a[140:143], v[160:175]
  ds_read_b64_tr_b16 v[200:201], v218 offset:0
  ds_read_b64_tr_b16 v[202:203], v218 offset:2048
  v_fma_f32 v141, v141, s42, v223
  v_mul_f32 v32, v32, v251
  v_exp_f32 v139, v139
  v_mul_f32 v33, v33, v251
  v_mul_f32 v34, v34, v251
  v_mul_f32 v35, v35, v251
  v_mul_f32 v36, v36, v251
  v_mul_f32 v37, v37, v251
  v_mul_f32 v38, v38, v251
  v_mul_f32 v39, v39, v251
  v_mul_f32 v40, v40, v251
  v_mul_f32 v41, v41, v251
  v_mul_f32 v42, v42, v251
  v_mul_f32 v43, v43, v251
  v_mul_f32 v44, v44, v251
  v_mul_f32 v45, v45, v251
  v_mul_f32 v46, v46, v251
  v_mul_f32 v47, v47, v251
  s_waitcnt lgkmcnt(15)
  v_mfma_f32_32x32x16_bf16 v[160:175], v[144:147], a[144:147], v[160:175]
  ds_read_b64_tr_b16 v[204:205], v219 offset:0
  ds_read_b64_tr_b16 v[206:207], v219 offset:2048
  v_add_f32 v230, v230, v137
  v_cvt_pk_bf16_f32 v32, v32, v33
  v_fma_f32 v142, v142, s42, v223
  v_cvt_pk_bf16_f32 v33, v34, v35
  v_cvt_pk_bf16_f32 v34, v36, v37
  v_cvt_pk_bf16_f32 v35, v38, v39
  v_cvt_pk_bf16_f32 v40, v40, v41
  v_cvt_pk_bf16_f32 v41, v42, v43
  v_cvt_pk_bf16_f32 v42, v44, v45
  v_cvt_pk_bf16_f32 v43, v46, v47
  ds_write_b64 v247, v[32:33]
  ds_write_b64 v248, v[34:35]
  ds_write_b64 v255, v[40:41]
  ds_write_b64 v254, v[42:43]
  ds_read_b128 a[208:211], v250 offset:0
  ds_read_b128 a[212:215], v250 offset:1024
  v_mfma_f32_32x32x16_bf16 v[160:175], v[148:151], a[148:151], v[160:175]
  ds_read_b64_tr_b16 v[144:145], v216 offset:4096
  ds_read_b64_tr_b16 v[146:147], v216 offset:6144
  v_exp_f32 v140, v140
  v_mul_f32 v96, v96, v252
  v_add_f32 v229, v229, v138
  v_mul_f32 v97, v97, v252
  v_mul_f32 v98, v98, v252
  v_mul_f32 v99, v99, v252
  v_mul_f32 v100, v100, v252
  v_mul_f32 v101, v101, v252
  v_mul_f32 v102, v102, v252
  v_mul_f32 v103, v103, v252
  v_mul_f32 v104, v104, v252
  v_mul_f32 v105, v105, v252
  v_mul_f32 v106, v106, v252
  v_mul_f32 v107, v107, v252
  v_mul_f32 v108, v108, v252
  v_mul_f32 v109, v109, v252
  v_mul_f32 v110, v110, v252
  v_mul_f32 v111, v111, v252
  v_cvt_pk_bf16_f32 v96, v96, v97
  v_cvt_pk_bf16_f32 v97, v98, v99
  v_mfma_f32_32x32x16_bf16 v[160:175], v[152:155], a[152:155], v[160:175]
  ds_read_b64_tr_b16 v[148:149], v217 offset:4096
  ds_read_b64_tr_b16 v[150:151], v217 offset:6144
  v_cvt_pk_bf16_f32 v136, v136, v137
  v_cvt_pk_bf16_f32 v98, v100, v101
  v_fma_f32 v143, v143, s42, v223
  v_cvt_pk_bf16_f32 v99, v102, v103
  v_exp_f32 v141, v141
  v_cvt_pk_bf16_f32 v104, v104, v105
  v_cvt_pk_bf16_f32 v105, v106, v107
  v_cvt_pk_bf16_f32 v106, v108, v109
  v_cvt_pk_bf16_f32 v107, v110, v111
  ds_write_b64 v247, v[96:97]
  ds_write_b64 v248, v[98:99]
  ds_write_b64 v255, v[104:105]
  ds_write_b64 v254, v[106:107]
  ds_read_b128 a[240:243], v250 offset:0
  ds_read_b128 a[244:247], v250 offset:1024
  v_mfma_f32_32x32x16_bf16 v[160:175], v[156:159], a[156:159], v[160:175]
  ds_read_b64_tr_b16 v[152:153], v218 offset:4096
  ds_read_b64_tr_b16 v[154:155], v218 offset:6144
  v_add_f32 v230, v230, v139
  v_mul_f32 v48, v48, v251
  v_mul_f32 v49, v49, v251
  v_mul_f32 v50, v50, v251
  v_mul_f32 v51, v51, v251
  v_mul_f32 v52, v52, v251
  v_mul_f32 v53, v53, v251
  v_mul_f32 v54, v54, v251
  v_mul_f32 v55, v55, v251
  v_mul_f32 v56, v56, v251
  v_mul_f32 v57, v57, v251
  v_mul_f32 v58, v58, v251
  v_mul_f32 v59, v59, v251
  v_mul_f32 v60, v60, v251
  v_mul_f32 v61, v61, v251
  v_mul_f32 v62, v62, v251
  v_mul_f32 v63, v63, v251
  v_cvt_pk_bf16_f32 v48, v48, v49
  v_cvt_pk_bf16_f32 v49, v50, v51
  s_waitcnt lgkmcnt(15)
  v_mfma_f32_32x32x16_bf16 v[0:15], v[192:195], v[128:131], 0
  ds_read_b64_tr_b16 v[156:157], v219 offset:4096
  ds_read_b64_tr_b16 v[158:159], v219 offset:6144
  v_exp_f32 v142, v142
  v_cvt_pk_bf16_f32 v50, v52, v53
  v_add_f32 v229, v229, v140
  v_cvt_pk_bf16_f32 v51, v54, v55
  v_cvt_pk_bf16_f32 v137, v138, v139
  v_cvt_pk_bf16_f32 v56, v56, v57
  v_cvt_pk_bf16_f32 v57, v58, v59
  v_cvt_pk_bf16_f32 v58, v60, v61
  v_cvt_pk_bf16_f32 v59, v62, v63
  ds_write_b64 v247, v[48:49]
  ds_write_b64 v248, v[50:51]
  ds_write_b64 v255, v[56:57]
  ds_write_b64 v254, v[58:59]
  ds_read_b128 a[216:219], v250 offset:0
  ds_read_b128 a[220:223], v250 offset:1024
  v_mfma_f32_32x32x16_bf16 v[16:31], v[196:199], v[128:131], 0
  ds_read_b128 v[192:195], v208 offset:16384
  v_exp_f32 v143, v143
  v_fma_f32 v160, v160, s42, v223
  v_mul_f32 v112, v112, v252
  v_add_f32 v230, v230, v141
  v_fma_f32 v161, v161, s42, v223
  v_mul_f32 v113, v113, v252
  v_mul_f32 v114, v114, v252
  v_mul_f32 v115, v115, v252
  v_mul_f32 v116, v116, v252
  v_mul_f32 v117, v117, v252
  v_mul_f32 v118, v118, v252
  v_mul_f32 v119, v119, v252
  v_mul_f32 v120, v120, v252
  v_mul_f32 v121, v121, v252
  v_mul_f32 v122, v122, v252
  v_mul_f32 v123, v123, v252
  v_mul_f32 v124, v124, v252
  v_mul_f32 v125, v125, v252
  v_mul_f32 v126, v126, v252
  v_mul_f32 v127, v127, v252
  v_cvt_pk_bf16_f32 v112, v112, v113
  v_cvt_pk_bf16_f32 v113, v114, v115
  v_cvt_pk_bf16_f32 v114, v116, v117
  v_cvt_pk_bf16_f32 v115, v118, v119
  v_cvt_pk_bf16_f32 v120, v120, v121
  v_cvt_pk_bf16_f32 v121, v122, v123
  v_cvt_pk_bf16_f32 v122, v124, v125
  v_cvt_pk_bf16_f32 v123, v126, v127
  ds_write_b64 v247, v[112:113]
  ds_write_b64 v248, v[114:115]
  ds_write_b64 v255, v[120:121]
  ds_write_b64 v254, v[122:123]
  ds_read_b128 a[248:251], v250 offset:0
  ds_read_b128 a[252:255], v250 offset:1024
  v_mfma_f32_32x32x16_bf16 v[32:47], v[200:203], v[128:131], 0
  ds_read_b128 v[196:199], v209 offset:16384
  v_add_f32 v229, v229, v142
  v_fma_f32 v162, v162, s42, v223
  v_cvt_pk_bf16_f32 v138, v140, v141
  v_add_f32 v230, v230, v143
  v_cvt_pk_bf16_f32 v139, v142, v143
  v_mfma_f32_32x32x16_bf16 v[48:63], v[204:207], v[128:131], 0
  ds_read_b128 v[200:203], v210 offset:16384
  v_exp_f32 v160, v160
  v_fma_f32 v163, v163, s42, v223
  v_exp_f32 v161, v161
  s_waitcnt lgkmcnt(15)
  v_mfma_f32_32x32x16_bf16 v[0:15], v[144:147], v[136:139], v[0:15]
  ds_read_b128 v[204:207], v211 offset:16384
  v_fma_f32 v164, v164, s42, v223
  v_exp_f32 v162, v162
  v_add_f32 v229, v229, v160
  v_fma_f32 v165, v165, s42, v223
  v_mfma_f32_32x32x16_bf16 v[16:31], v[148:151], v[136:139], v[16:31]
  ds_read_b128 v[144:147], v212 offset:16384
  v_exp_f32 v163, v163
  v_add_f32 v230, v230, v161
  v_fma_f32 v166, v166, s42, v223
  v_exp_f32 v164, v164
  v_mfma_f32_32x32x16_bf16 v[32:47], v[152:155], v[136:139], v[32:47]
  ds_read_b128 v[148:151], v213 offset:16384
  v_add_f32 v229, v229, v162
  v_cvt_pk_bf16_f32 v160, v160, v161
  v_fma_f32 v167, v167, s42, v223
  v_exp_f32 v165, v165
  v_mfma_f32_32x32x16_bf16 v[48:63], v[156:159], v[136:139], v[48:63]
  ds_read_b128 v[152:155], v214 offset:16384
  v_add_f32 v230, v230, v163
  v_fma_f32 v168, v168, s42, v223
  v_exp_f32 v166, v166
  s_waitcnt lgkmcnt(4)
  v_mfma_f32_32x32x16_bf16 v[128:143], v[192:195], a[128:131], 0
  ds_read_b128 v[156:159], v215 offset:16384
  v_add_f32 v229, v229, v164
  v_cvt_pk_bf16_f32 v161, v162, v163
  v_fma_f32 v169, v169, s42, v223
  v_exp_f32 v167, v167
  v_mfma_f32_32x32x16_bf16 v[128:143], v[196:199], a[132:135], v[128:143]
  ds_read_b64_tr_b16 v[192:193], v216 offset:8192
  ds_read_b64_tr_b16 v[194:195], v216 offset:10240
  v_add_f32 v230, v230, v165
  v_fma_f32 v170, v170, s42, v223
  v_exp_f32 v168, v168
  v_mfma_f32_32x32x16_bf16 v[128:143], v[200:203], a[136:139], v[128:143]
  ds_read_b64_tr_b16 v[196:197], v217 offset:8192
  ds_read_b64_tr_b16 v[198:199], v217 offset:10240
  buffer_store_dwordx4 a[192:195], v249, s[32:35], s49 offen offset:0 sc1
  v_add_f32 v229, v229, v166
  v_cvt_pk_bf16_f32 v162, v164, v165
  v_fma_f32 v171, v171, s42, v223
  s_waitcnt lgkmcnt(6)
  v_mfma_f32_32x32x16_bf16 v[128:143], v[204:207], a[140:143], v[128:143]
  ds_read_b64_tr_b16 v[200:201], v218 offset:8192
  ds_read_b64_tr_b16 v[202:203], v218 offset:10240
  v_exp_f32 v169, v169
  v_add_f32 v230, v230, v167
  v_fma_f32 v172, v172, s42, v223
  v_mfma_f32_32x32x16_bf16 v[128:143], v[144:147], a[144:147], v[128:143]
  ds_read_b64_tr_b16 v[204:205], v219 offset:8192
  ds_read_b64_tr_b16 v[206:207], v219 offset:10240
  v_exp_f32 v170, v170
  v_add_f32 v229, v229, v168
  v_cvt_pk_bf16_f32 v163, v166, v167
  v_mfma_f32_32x32x16_bf16 v[128:143], v[148:151], a[148:151], v[128:143]
  ds_read_b64_tr_b16 v[144:145], v216 offset:12288
  ds_read_b64_tr_b16 v[146:147], v216 offset:14336
  v_fma_f32 v173, v173, s42, v223
  v_exp_f32 v171, v171
  s_waitcnt lgkmcnt(8)
  v_mfma_f32_32x32x16_bf16 v[128:143], v[152:155], a[152:155], v[128:143]
  ds_read_b64_tr_b16 v[148:149], v217 offset:12288
  ds_read_b64_tr_b16 v[150:151], v217 offset:14336
  v_add_f32 v230, v230, v169
  v_fma_f32 v174, v174, s42, v223
  v_exp_f32 v172, v172
  v_mfma_f32_32x32x16_bf16 v[128:143], v[156:159], a[156:159], v[128:143]
  ds_read_b64_tr_b16 v[152:153], v218 offset:12288
  ds_read_b64_tr_b16 v[154:155], v218 offset:14336
  v_add_f32 v229, v229, v170
  v_cvt_pk_bf16_f32 v168, v168, v169
  v_fma_f32 v175, v175, s42, v223
  v_exp_f32 v173, v173
  v_mfma_f32_32x32x16_bf16 v[0:15], v[192:195], v[160:163], v[0:15]
  ds_read_b64_tr_b16 v[156:157], v219 offset:12288
  ds_read_b64_tr_b16 v[158:159], v219 offset:14336
  v_add_f32 v230, v230, v171
  v_exp_f32 v174, v174
  s_waitcnt lgkmcnt(8)
  v_mfma_f32_32x32x16_bf16 v[16:31], v[196:199], v[160:163], v[16:31]
  ds_read_b128 v[192:195], v208 offset:24576
  v_add_f32 v229, v229, v172
  v_fma_f32 v128, v128, s42, v223
  v_cvt_pk_bf16_f32 v169, v170, v171
  v_fma_f32 v129, v129, s42, v223
  v_exp_f32 v175, v175
  v_mfma_f32_32x32x16_bf16 v[32:47], v[200:203], v[160:163], v[32:47]
  ds_read_b128 v[196:199], v209 offset:24576
  v_add_f32 v230, v230, v173
  v_add_f32 v229, v229, v174
  v_cvt_pk_bf16_f32 v170, v172, v173
  v_add_f32 v230, v230, v175
  v_cvt_pk_bf16_f32 v171, v174, v175
  v_mfma_f32_32x32x16_bf16 v[48:63], v[204:207], v[160:163], v[48:63]
  ds_read_b128 v[200:203], v210 offset:24576
  v_fma_f32 v130, v130, s42, v223
  v_exp_f32 v128, v128
  v_fma_f32 v131, v131, s42, v223
  s_waitcnt lgkmcnt(5)
  v_mfma_f32_32x32x16_bf16 v[0:15], v[144:147], v[168:171], v[0:15]
  ds_read_b128 v[204:207], v211 offset:24576
  buffer_store_dwordx4 a[200:203], v249, s[32:35], s49 offen offset:64 sc1
  v_exp_f32 v129, v129
  v_fma_f32 v132, v132, s42, v223
  v_exp_f32 v130, v130
  v_mfma_f32_32x32x16_bf16 v[16:31], v[148:151], v[168:171], v[16:31]
  ds_read_b128 v[144:147], v212 offset:24576
  v_add_f32 v229, v229, v128
  v_fma_f32 v133, v133, s42, v223
  v_exp_f32 v131, v131
  v_add_f32 v230, v230, v129
  v_fma_f32 v134, v134, s42, v223
  v_mfma_f32_32x32x16_bf16 v[32:47], v[152:155], v[168:171], v[32:47]
  ds_read_b128 v[148:151], v213 offset:24576
  v_exp_f32 v132, v132
  v_add_f32 v229, v229, v130
  v_cvt_pk_bf16_f32 v128, v128, v129
  s_waitcnt lgkmcnt(4)
  v_mfma_f32_32x32x16_bf16 v[48:63], v[156:159], v[168:171], v[48:63]
  ds_read_b128 v[152:155], v214 offset:24576
  v_fma_f32 v135, v135, s42, v223
  v_exp_f32 v133, v133
  v_add_f32 v230, v230, v131
  v_fma_f32 v136, v136, s42, v223
  v_mfma_f32_32x32x16_bf16 v[160:175], v[192:195], a[128:131], 0
  ds_read_b128 v[156:159], v215 offset:24576
  v_exp_f32 v134, v134
  v_add_f32 v229, v229, v132
  v_cvt_pk_bf16_f32 v129, v130, v131
  v_fma_f32 v137, v137, s42, v223
  v_exp_f32 v135, v135
  v_mfma_f32_32x32x16_bf16 v[160:175], v[196:199], a[132:135], v[160:175]
  ds_read_b64_tr_b16 v[192:193], v216 offset:16384
  ds_read_b64_tr_b16 v[194:195], v216 offset:18432
  v_add_f32 v230, v230, v133
  v_fma_f32 v138, v138, s42, v223
  s_waitcnt lgkmcnt(5)
  v_mfma_f32_32x32x16_bf16 v[160:175], v[200:203], a[136:139], v[160:175]
  ds_read_b64_tr_b16 v[196:197], v217 offset:16384
  ds_read_b64_tr_b16 v[198:199], v217 offset:18432
  v_exp_f32 v136, v136
  v_add_f32 v229, v229, v134
  v_cvt_pk_bf16_f32 v130, v132, v133
  v_fma_f32 v139, v139, s42, v223
  v_mfma_f32_32x32x16_bf16 v[160:175], v[204:207], a[140:143], v[160:175]
  ds_read_b64_tr_b16 v[200:201], v218 offset:16384
  ds_read_b64_tr_b16 v[202:203], v218 offset:18432
  v_exp_f32 v137, v137
  v_add_f32 v230, v230, v135
  v_fma_f32 v140, v140, s42, v223
  v_mfma_f32_32x32x16_bf16 v[160:175], v[144:147], a[144:147], v[160:175]
  ds_read_b64_tr_b16 v[204:205], v219 offset:16384
  ds_read_b64_tr_b16 v[206:207], v219 offset:18432
  v_exp_f32 v138, v138
  v_add_f32 v229, v229, v136
  v_cvt_pk_bf16_f32 v131, v134, v135
  s_waitcnt lgkmcnt(8)
  v_mfma_f32_32x32x16_bf16 v[160:175], v[148:151], a[148:151], v[160:175]
  ds_read_b64_tr_b16 v[144:145], v216 offset:20480
  ds_read_b64_tr_b16 v[146:147], v216 offset:22528
  v_fma_f32 v141, v141, s42, v223
  v_exp_f32 v139, v139
  v_add_f32 v230, v230, v137
  v_fma_f32 v142, v142, s42, v223
  v_mfma_f32_32x32x16_bf16 v[160:175], v[152:155], a[152:155], v[160:175]
  ds_read_b64_tr_b16 v[148:149], v217 offset:20480
  ds_read_b64_tr_b16 v[150:151], v217 offset:22528
  buffer_store_dwordx4 a[224:227], v249, s[32:35], s50 offen offset:0 sc1
  v_exp_f32 v140, v140
  v_add_f32 v229, v229, v138
  v_mfma_f32_32x32x16_bf16 v[160:175], v[156:159], a[156:159], v[160:175]
  ds_read_b64_tr_b16 v[152:153], v218 offset:20480
  ds_read_b64_tr_b16 v[154:155], v218 offset:22528
  v_cvt_pk_bf16_f32 v136, v136, v137
  v_fma_f32 v143, v143, s42, v223
  v_exp_f32 v141, v141
  s_waitcnt lgkmcnt(8)
  v_mfma_f32_32x32x16_bf16 v[0:15], v[192:195], v[128:131], v[0:15]
  ds_read_b64_tr_b16 v[156:157], v219 offset:20480
  ds_read_b64_tr_b16 v[158:159], v219 offset:22528
  v_add_f32 v230, v230, v139
  v_exp_f32 v142, v142
  s_waitcnt vmcnt(3)
  s_barrier
  v_mfma_f32_32x32x16_bf16 v[16:31], v[196:199], v[128:131], v[16:31]
  ds_read_b128 v[192:195], v208 offset:32768
  v_add_f32 v229, v229, v140
  v_fma_f32 v160, v160, s42, v223
  v_cvt_pk_bf16_f32 v137, v138, v139
  v_exp_f32 v143, v143
  v_add_f32 v230, v230, v141
  v_mfma_f32_32x32x16_bf16 v[32:47], v[200:203], v[128:131], v[32:47]
  ds_read_b128 v[196:199], v209 offset:32768
  v_add_f32 v229, v229, v142
  v_cvt_pk_bf16_f32 v138, v140, v141
  v_add_f32 v230, v230, v143
  v_cvt_pk_bf16_f32 v139, v142, v143
  s_waitcnt lgkmcnt(6)
  v_mfma_f32_32x32x16_bf16 v[48:63], v[204:207], v[128:131], v[48:63]
  ds_read_b128 v[200:203], v210 offset:32768
  v_fma_f32 v161, v161, s42, v223
  v_fma_f32 v162, v162, s42, v223
  v_exp_f32 v160, v160
  v_fma_f32 v163, v163, s42, v223
  v_mfma_f32_32x32x16_bf16 v[0:15], v[144:147], v[136:139], v[0:15]
  ds_read_b128 v[204:207], v211 offset:32768
  v_exp_f32 v161, v161
  v_fma_f32 v164, v164, s42, v223
  v_exp_f32 v162, v162
  v_add_f32 v229, v229, v160
  v_mfma_f32_32x32x16_bf16 v[16:31], v[148:151], v[136:139], v[16:31]
  ds_read_b128 v[144:147], v212 offset:32768
  v_fma_f32 v165, v165, s42, v223
  v_exp_f32 v163, v163
  v_add_f32 v230, v230, v161
  v_fma_f32 v166, v166, s42, v223
  s_waitcnt lgkmcnt(4)
  v_mfma_f32_32x32x16_bf16 v[32:47], v[152:155], v[136:139], v[32:47]
  ds_read_b128 v[148:151], v213 offset:32768
  v_exp_f32 v164, v164
  v_add_f32 v229, v229, v162
  v_cvt_pk_bf16_f32 v160, v160, v161
  v_fma_f32 v167, v167, s42, v223
  v_mfma_f32_32x32x16_bf16 v[48:63], v[156:159], v[136:139], v[48:63]
  ds_read_b128 v[152:155], v214 offset:32768
  v_exp_f32 v165, v165
  v_add_f32 v230, v230, v163
  v_fma_f32 v168, v168, s42, v223
  v_exp_f32 v166, v166
  v_mfma_f32_32x32x16_bf16 v[128:143], v[192:195], a[128:131], 0
  ds_read_b128 v[156:159], v215 offset:32768
  buffer_store_dwordx4 a[232:235], v249, s[32:35], s50 offen offset:64 sc1
  v_add_f32 v229, v229, v164
  v_cvt_pk_bf16_f32 v161, v162, v163
  v_fma_f32 v169, v169, s42, v223
  s_waitcnt lgkmcnt(4)
  v_mfma_f32_32x32x16_bf16 v[128:143], v[196:199], a[132:135], v[128:143]
  ds_read_b64_tr_b16 v[192:193], v216 offset:24576
  ds_read_b64_tr_b16 v[194:195], v216 offset:26624
  v_exp_f32 v167, v167
  v_add_f32 v230, v230, v165
  v_fma_f32 v170, v170, s42, v223
  v_mfma_f32_32x32x16_bf16 v[128:143], v[200:203], a[136:139], v[128:143]
  ds_read_b64_tr_b16 v[196:197], v217 offset:24576
  ds_read_b64_tr_b16 v[198:199], v217 offset:26624
  v_exp_f32 v168, v168
  v_add_f32 v229, v229, v166
  v_cvt_pk_bf16_f32 v162, v164, v165
  v_fma_f32 v171, v171, s42, v223
  v_mfma_f32_32x32x16_bf16 v[128:143], v[204:207], a[140:143], v[128:143]
  ds_read_b64_tr_b16 v[200:201], v218 offset:24576
  ds_read_b64_tr_b16 v[202:203], v218 offset:26624
  v_exp_f32 v169, v169
  v_add_f32 v230, v230, v167
  v_fma_f32 v172, v172, s42, v223
  s_waitcnt lgkmcnt(7)
  v_mfma_f32_32x32x16_bf16 v[128:143], v[144:147], a[144:147], v[128:143]
  ds_read_b64_tr_b16 v[204:205], v219 offset:24576
  ds_read_b64_tr_b16 v[206:207], v219 offset:26624
  v_exp_f32 v170, v170
  v_add_f32 v229, v229, v168
  v_cvt_pk_bf16_f32 v163, v166, v167
  v_mfma_f32_32x32x16_bf16 v[128:143], v[148:151], a[148:151], v[128:143]
  ds_read_b64_tr_b16 v[144:145], v216 offset:28672
  ds_read_b64_tr_b16 v[146:147], v216 offset:30720
  v_fma_f32 v173, v173, s42, v223
  v_exp_f32 v171, v171
  v_add_f32 v230, v230, v169
  v_mfma_f32_32x32x16_bf16 v[128:143], v[152:155], a[152:155], v[128:143]
  ds_read_b64_tr_b16 v[148:149], v217 offset:28672
  ds_read_b64_tr_b16 v[150:151], v217 offset:30720
  v_fma_f32 v174, v174, s42, v223
  v_exp_f32 v172, v172
  s_waitcnt lgkmcnt(8)
  v_mfma_f32_32x32x16_bf16 v[128:143], v[156:159], a[156:159], v[128:143]
  ds_read_b64_tr_b16 v[152:153], v218 offset:28672
  ds_read_b64_tr_b16 v[154:155], v218 offset:30720
  v_add_f32 v229, v229, v170
  v_cvt_pk_bf16_f32 v168, v168, v169
  v_fma_f32 v175, v175, s42, v223
  v_exp_f32 v173, v173
  v_mfma_f32_32x32x16_bf16 v[0:15], v[192:195], v[160:163], v[0:15]
  ds_read_b64_tr_b16 v[156:157], v219 offset:28672
  ds_read_b64_tr_b16 v[158:159], v219 offset:30720
  v_add_f32 v230, v230, v171
  v_exp_f32 v174, v174
  v_add_f32 v229, v229, v172
  v_mfma_f32_32x32x16_bf16 v[16:31], v[196:199], v[160:163], v[16:31]
  ds_read_b128 v[192:195], v208 offset:40960
  v_cvt_pk_bf16_f32 v169, v170, v171
  v_fma_f32 v128, v128, s42, v223
  v_exp_f32 v175, v175
  v_add_f32 v230, v230, v173
  s_waitcnt lgkmcnt(7)
  v_mfma_f32_32x32x16_bf16 v[32:47], v[200:203], v[160:163], v[32:47]
  ds_read_b128 v[196:199], v209 offset:40960
  buffer_store_dwordx4 a[196:199], v249, s[32:35], s55 offen offset:0 sc1
  v_add_f32 v229, v229, v174
  v_cvt_pk_bf16_f32 v170, v172, v173
  v_add_f32 v230, v230, v175
  v_cvt_pk_bf16_f32 v171, v174, v175
  v_mfma_f32_32x32x16_bf16 v[48:63], v[204:207], v[160:163], v[48:63]
  ds_read_b128 v[200:203], v210 offset:40960
  v_fma_f32 v129, v129, s42, v223
  v_fma_f32 v130, v130, s42, v223
  v_exp_f32 v128, v128
  v_fma_f32 v131, v131, s42, v223
  v_mfma_f32_32x32x16_bf16 v[0:15], v[144:147], v[168:171], v[0:15]
  ds_read_b128 v[204:207], v211 offset:40960
  v_exp_f32 v129, v129
  v_fma_f32 v132, v132, s42, v223
  v_exp_f32 v130, v130
  s_waitcnt lgkmcnt(4)
  v_mfma_f32_32x32x16_bf16 v[16:31], v[148:151], v[168:171], v[16:31]
  ds_read_b128 v[144:147], v212 offset:40960
  v_add_f32 v229, v229, v128
  v_fma_f32 v133, v133, s42, v223
  v_exp_f32 v131, v131
  v_add_f32 v230, v230, v129
  v_fma_f32 v134, v134, s42, v223
  v_mfma_f32_32x32x16_bf16 v[32:47], v[152:155], v[168:171], v[32:47]
  ds_read_b128 v[148:151], v213 offset:40960
  v_exp_f32 v132, v132
  v_add_f32 v229, v229, v130
  v_cvt_pk_bf16_f32 v128, v128, v129
  v_fma_f32 v135, v135, s42, v223
  v_mfma_f32_32x32x16_bf16 v[48:63], v[156:159], v[168:171], v[48:63]
  ds_read_b128 v[152:155], v214 offset:40960
  v_exp_f32 v133, v133
  v_add_f32 v230, v230, v131
  v_fma_f32 v136, v136, s42, v223
  s_waitcnt lgkmcnt(4)
  v_mfma_f32_32x32x16_bf16 v[160:175], v[192:195], a[128:131], 0
  ds_read_b128 v[156:159], v215 offset:40960
  v_exp_f32 v134, v134
  v_add_f32 v229, v229, v132
  v_cvt_pk_bf16_f32 v129, v130, v131
  v_fma_f32 v137, v137, s42, v223
  v_exp_f32 v135, v135
  v_mfma_f32_32x32x16_bf16 v[160:175], v[196:199], a[132:135], v[160:175]
  ds_read_b64_tr_b16 v[192:193], v216 offset:32768
  ds_read_b64_tr_b16 v[194:195], v216 offset:34816
  v_add_f32 v230, v230, v133
  v_fma_f32 v138, v138, s42, v223
  v_exp_f32 v136, v136
  v_mfma_f32_32x32x16_bf16 v[160:175], v[200:203], a[136:139], v[160:175]
  ds_read_b64_tr_b16 v[196:197], v217 offset:32768
  ds_read_b64_tr_b16 v[198:199], v217 offset:34816
  v_add_f32 v229, v229, v134
  v_cvt_pk_bf16_f32 v130, v132, v133
  v_fma_f32 v139, v139, s42, v223
  s_waitcnt lgkmcnt(6)
  v_mfma_f32_32x32x16_bf16 v[160:175], v[204:207], a[140:143], v[160:175]
  ds_read_b64_tr_b16 v[200:201], v218 offset:32768
  ds_read_b64_tr_b16 v[202:203], v218 offset:34816
  v_exp_f32 v137, v137
  v_add_f32 v230, v230, v135
  v_fma_f32 v140, v140, s42, v223
  v_mfma_f32_32x32x16_bf16 v[160:175], v[144:147], a[144:147], v[160:175]
  ds_read_b64_tr_b16 v[204:205], v219 offset:32768
  ds_read_b64_tr_b16 v[206:207], v219 offset:34816
  buffer_store_dwordx4 a[204:207], v249, s[32:35], s55 offen offset:64 sc1
  v_exp_f32 v138, v138
  v_add_f32 v229, v229, v136
  v_cvt_pk_bf16_f32 v131, v134, v135
  v_mfma_f32_32x32x16_bf16 v[160:175], v[148:151], a[148:151], v[160:175]
  ds_read_b64_tr_b16 v[144:145], v216 offset:36864
  ds_read_b64_tr_b16 v[146:147], v216 offset:38912
  v_fma_f32 v141, v141, s42, v223
  v_exp_f32 v139, v139
  v_add_f32 v230, v230, v137
  s_waitcnt lgkmcnt(8)
  v_mfma_f32_32x32x16_bf16 v[160:175], v[152:155], a[152:155], v[160:175]
  ds_read_b64_tr_b16 v[148:149], v217 offset:36864
  ds_read_b64_tr_b16 v[150:151], v217 offset:38912
  v_fma_f32 v142, v142, s42, v223
  v_exp_f32 v140, v140
  v_add_f32 v229, v229, v138
  v_mfma_f32_32x32x16_bf16 v[160:175], v[156:159], a[156:159], v[160:175]
  ds_read_b64_tr_b16 v[152:153], v218 offset:36864
  ds_read_b64_tr_b16 v[154:155], v218 offset:38912
  v_cvt_pk_bf16_f32 v136, v136, v137
  v_fma_f32 v143, v143, s42, v223
  v_exp_f32 v141, v141
  v_add_f32 v230, v230, v139
  v_mfma_f32_32x32x16_bf16 v[0:15], v[192:195], v[128:131], v[0:15]
  ds_read_b64_tr_b16 v[156:157], v219 offset:36864
  ds_read_b64_tr_b16 v[158:159], v219 offset:38912
  v_exp_f32 v142, v142
  v_add_f32 v229, v229, v140
  s_barrier
  s_waitcnt lgkmcnt(8)
  v_mfma_f32_32x32x16_bf16 v[16:31], v[196:199], v[128:131], v[16:31]
  ds_read_b128 v[192:195], v208 offset:49152
  v_cvt_pk_bf16_f32 v137, v138, v139
  v_fma_f32 v160, v160, s42, v223
  v_exp_f32 v143, v143
  v_add_f32 v230, v230, v141
  v_add_f32 v229, v229, v142
  v_mfma_f32_32x32x16_bf16 v[32:47], v[200:203], v[128:131], v[32:47]
  s_add_u32 m0, s40, 32768
  s_add_u32 s41, s59, 0
  buffer_load_dwordx4 v253, s[24:27], s41 offen lds
  ds_read_b128 v[196:199], v209 offset:49152
  v_cvt_pk_bf16_f32 v138, v140, v141
  v_add_f32 v230, v230, v143
  v_cvt_pk_bf16_f32 v139, v142, v143
  v_mfma_f32_32x32x16_bf16 v[48:63], v[204:207], v[128:131], v[48:63]
  ds_read_b128 v[200:203], v210 offset:49152
  v_fma_f32 v161, v161, s42, v223
  v_fma_f32 v162, v162, s42, v223
  v_exp_f32 v160, v160
  v_fma_f32 v163, v163, s42, v223
  s_waitcnt lgkmcnt(5)
  v_mfma_f32_32x32x16_bf16 v[0:15], v[144:147], v[136:139], v[0:15]
  s_add_u32 m0, s40, 36864
  s_add_u32 s41, s59, 4096
  buffer_load_dwordx4 v253, s[24:27], s41 offen lds
  ds_read_b128 v[204:207], v211 offset:49152
  v_exp_f32 v161, v161
  v_fma_f32 v164, v164, s42, v223
  v_mfma_f32_32x32x16_bf16 v[16:31], v[148:151], v[136:139], v[16:31]
  ds_read_b128 v[144:147], v212 offset:49152
  v_exp_f32 v162, v162
  v_add_f32 v229, v229, v160
  v_fma_f32 v165, v165, s42, v223
  v_exp_f32 v163, v163
  v_mfma_f32_32x32x16_bf16 v[32:47], v[152:155], v[136:139], v[32:47]
  ds_read_b128 v[148:151], v213 offset:49152
  buffer_store_dwordx4 a[228:231], v249, s[32:35], s56 offen offset:0 sc1
  v_add_f32 v230, v230, v161
  v_fma_f32 v166, v166, s42, v223
  v_exp_f32 v164, v164
  s_waitcnt lgkmcnt(4)
  v_mfma_f32_32x32x16_bf16 v[48:63], v[156:159], v[136:139], v[48:63]
  ds_read_b128 v[152:155], v214 offset:49152
  v_add_f32 v229, v229, v162
  v_cvt_pk_bf16_f32 v160, v160, v161
  v_fma_f32 v167, v167, s42, v223
  v_exp_f32 v165, v165
  v_mfma_f32_32x32x16_bf16 v[128:143], v[192:195], a[128:131], 0
  ds_read_b128 v[156:159], v215 offset:49152
  v_add_f32 v230, v230, v163
  v_fma_f32 v168, v168, s42, v223
  v_exp_f32 v166, v166
  v_add_f32 v229, v229, v164
  v_cvt_pk_bf16_f32 v161, v162, v163
  v_mfma_f32_32x32x16_bf16 v[128:143], v[196:199], a[132:135], v[128:143]
  ds_read_b64_tr_b16 v[192:193], v216 offset:40960
  ds_read_b64_tr_b16 v[194:195], v216 offset:43008
  v_fma_f32 v169, v169, s42, v223
  v_exp_f32 v167, v167
  v_add_f32 v230, v230, v165
  s_waitcnt lgkmcnt(5)
  v_mfma_f32_32x32x16_bf16 v[128:143], v[200:203], a[136:139], v[128:143]
  ds_read_b64_tr_b16 v[196:197], v217 offset:40960
  ds_read_b64_tr_b16 v[198:199], v217 offset:43008
  v_fma_f32 v170, v170, s42, v223
  v_exp_f32 v168, v168
  v_add_f32 v229, v229, v166
  v_cvt_pk_bf16_f32 v162, v164, v165
  v_mfma_f32_32x32x16_bf16 v[128:143], v[204:207], a[140:143], v[128:143]
  ds_read_b64_tr_b16 v[200:201], v218 offset:40960
  ds_read_b64_tr_b16 v[202:203], v218 offset:43008
  v_fma_f32 v171, v171, s42, v223
  v_exp_f32 v169, v169
  v_add_f32 v230, v230, v167
  v_fma_f32 v172, v172, s42, v223
  v_mfma_f32_32x32x16_bf16 v[128:143], v[144:147], a[144:147], v[128:143]
  ds_read_b64_tr_b16 v[204:205], v219 offset:40960
  ds_read_b64_tr_b16 v[206:207], v219 offset:43008
  v_exp_f32 v170, v170
  v_add_f32 v229, v229, v168
  v_cvt_pk_bf16_f32 v163, v166, v167
  s_waitcnt lgkmcnt(8)
  v_mfma_f32_32x32x16_bf16 v[128:143], v[148:151], a[148:151], v[128:143]
  ds_read_b64_tr_b16 v[144:145], v216 offset:45056
  ds_read_b64_tr_b16 v[146:147], v216 offset:47104
  v_fma_f32 v173, v173, s42, v223
  v_exp_f32 v171, v171
  v_add_f32 v230, v230, v169
  v_mfma_f32_32x32x16_bf16 v[128:143], v[152:155], a[152:155], v[128:143]
  ds_read_b64_tr_b16 v[148:149], v217 offset:45056
  ds_read_b64_tr_b16 v[150:151], v217 offset:47104
  v_fma_f32 v174, v174, s42, v223
  v_exp_f32 v172, v172
  v_add_f32 v229, v229, v170
  v_mfma_f32_32x32x16_bf16 v[128:143], v[156:159], a[156:159], v[128:143]
  ds_read_b64_tr_b16 v[152:153], v218 offset:45056
  ds_read_b64_tr_b16 v[154:155], v218 offset:47104
  v_cvt_pk_bf16_f32 v168, v168, v169
  v_fma_f32 v175, v175, s42, v223
  v_exp_f32 v173, v173
  s_waitcnt lgkmcnt(8)
  v_mfma_f32_32x32x16_bf16 v[0:15], v[192:195], v[160:163], v[0:15]
  ds_read_b64_tr_b16 v[156:157], v219 offset:45056
  ds_read_b64_tr_b16 v[158:159], v219 offset:47104
  buffer_store_dwordx4 a[236:239], v249, s[32:35], s56 offen offset:64 sc1
  v_add_f32 v230, v230, v171
  v_exp_f32 v174, v174
  v_mfma_f32_32x32x16_bf16 v[16:31], v[196:199], v[160:163], v[16:31]
  ds_read_b128 v[192:195], v208 offset:57344
  v_add_f32 v229, v229, v172
  v_fma_f32 v128, v128, s42, v223
  v_cvt_pk_bf16_f32 v169, v170, v171
  v_exp_f32 v175, v175
  v_add_f32 v230, v230, v173
  v_mfma_f32_32x32x16_bf16 v[32:47], v[200:203], v[160:163], v[32:47]
  ds_read_b128 v[196:199], v209 offset:57344
  v_add_f32 v229, v229, v174
  v_cvt_pk_bf16_f32 v170, v172, v173
  v_add_f32 v230, v230, v175
  v_cvt_pk_bf16_f32 v171, v174, v175
  s_waitcnt lgkmcnt(6)
  v_mfma_f32_32x32x16_bf16 v[48:63], v[204:207], v[160:163], v[48:63]
  ds_read_b128 v[200:203], v210 offset:57344
  v_fma_f32 v129, v129, s42, v223
  v_fma_f32 v130, v130, s42, v223
  v_exp_f32 v128, v128
  v_fma_f32 v131, v131, s42, v223
  v_mfma_f32_32x32x16_bf16 v[0:15], v[144:147], v[168:171], v[0:15]
  ds_read_b128 v[204:207], v211 offset:57344
  v_exp_f32 v129, v129
  v_fma_f32 v132, v132, s42, v223
  v_exp_f32 v130, v130
  v_add_f32 v229, v229, v128
  v_mfma_f32_32x32x16_bf16 v[16:31], v[148:151], v[168:171], v[16:31]
  ds_read_b128 v[144:147], v212 offset:57344
  v_fma_f32 v133, v133, s42, v223
  v_exp_f32 v131, v131
  v_add_f32 v230, v230, v129
  v_fma_f32 v134, v134, s42, v223
  s_waitcnt lgkmcnt(4)
  v_mfma_f32_32x32x16_bf16 v[32:47], v[152:155], v[168:171], v[32:47]
  ds_read_b128 v[148:151], v213 offset:57344
  v_exp_f32 v132, v132
  v_add_f32 v229, v229, v130
  v_cvt_pk_bf16_f32 v128, v128, v129
  v_fma_f32 v135, v135, s42, v223
  v_mfma_f32_32x32x16_bf16 v[48:63], v[156:159], v[168:171], v[48:63]
  ds_read_b128 v[152:155], v214 offset:57344
  v_exp_f32 v133, v133
  v_add_f32 v230, v230, v131
  v_fma_f32 v136, v136, s42, v223
  v_exp_f32 v134, v134
  v_mfma_f32_32x32x16_bf16 v[160:175], v[192:195], a[128:131], 0
  ds_read_b128 v[156:159], v215 offset:57344
  v_add_f32 v229, v229, v132
  v_cvt_pk_bf16_f32 v129, v130, v131
  v_fma_f32 v137, v137, s42, v223
  v_exp_f32 v135, v135
  s_waitcnt lgkmcnt(4)
  v_mfma_f32_32x32x16_bf16 v[160:175], v[196:199], a[132:135], v[160:175]
  ds_read_b64_tr_b16 v[192:193], v216 offset:49152
  ds_read_b64_tr_b16 v[194:195], v216 offset:51200
  v_add_f32 v230, v230, v133
  v_fma_f32 v138, v138, s42, v223
  v_exp_f32 v136, v136
  v_mfma_f32_32x32x16_bf16 v[160:175], v[200:203], a[136:139], v[160:175]
  ds_read_b64_tr_b16 v[196:197], v217 offset:49152
  ds_read_b64_tr_b16 v[198:199], v217 offset:51200
  buffer_store_dwordx4 a[208:211], v249, s[32:35], s49 offen offset:128 sc1
  v_add_f32 v229, v229, v134
  v_cvt_pk_bf16_f32 v130, v132, v133
  v_fma_f32 v139, v139, s42, v223
  v_mfma_f32_32x32x16_bf16 v[160:175], v[204:207], a[140:143], v[160:175]
  ds_read_b64_tr_b16 v[200:201], v218 offset:49152
  ds_read_b64_tr_b16 v[202:203], v218 offset:51200
  v_exp_f32 v137, v137
  v_add_f32 v230, v230, v135
  v_fma_f32 v140, v140, s42, v223
  s_waitcnt lgkmcnt(7)
  v_mfma_f32_32x32x16_bf16 v[160:175], v[144:147], a[144:147], v[160:175]
  ds_read_b64_tr_b16 v[204:205], v219 offset:49152
  ds_read_b64_tr_b16 v[206:207], v219 offset:51200
  v_exp_f32 v138, v138
  v_add_f32 v229, v229, v136
  v_cvt_pk_bf16_f32 v131, v134, v135
  v_mfma_f32_32x32x16_bf16 v[160:175], v[148:151], a[148:151], v[160:175]
  ds_read_b64_tr_b16 v[144:145], v216 offset:53248
  ds_read_b64_tr_b16 v[146:147], v216 offset:55296
  v_fma_f32 v141, v141, s42, v223
  v_exp_f32 v139, v139
  v_add_f32 v230, v230, v137
  v_fma_f32 v142, v142, s42, v223
  v_mfma_f32_32x32x16_bf16 v[160:175], v[152:155], a[152:155], v[160:175]
  ds_read_b64_tr_b16 v[148:149], v217 offset:53248
  ds_read_b64_tr_b16 v[150:151], v217 offset:55296
  v_exp_f32 v140, v140
  v_add_f32 v229, v229, v138
  s_waitcnt lgkmcnt(8)
  v_mfma_f32_32x32x16_bf16 v[160:175], v[156:159], a[156:159], v[160:175]
  ds_read_b64_tr_b16 v[152:153], v218 offset:53248
  ds_read_b64_tr_b16 v[154:155], v218 offset:55296
  v_cvt_pk_bf16_f32 v136, v136, v137
  v_fma_f32 v143, v143, s42, v223
  v_exp_f32 v141, v141
  v_add_f32 v230, v230, v139
  v_mfma_f32_32x32x16_bf16 v[0:15], v[192:195], v[128:131], v[0:15]
  ds_read_b64_tr_b16 v[156:157], v219 offset:53248
  ds_read_b64_tr_b16 v[158:159], v219 offset:55296
  v_exp_f32 v142, v142
  v_add_f32 v229, v229, v140
  v_xor_b32 v208, 0x10000, v208
  v_mfma_f32_32x32x16_bf16 v[16:31], v[196:199], v[128:131], v[16:31]
  ds_read_b128 v[192:195], v208 offset:0
  v_cvt_pk_bf16_f32 v137, v138, v139
  v_exp_f32 v143, v143
  v_add_f32 v230, v230, v141
  v_xor_b32 v209, 0x10000, v209
  s_waitcnt lgkmcnt(7)
  v_mfma_f32_32x32x16_bf16 v[32:47], v[200:203], v[128:131], v[32:47]
  ds_read_b128 v[196:199], v209 offset:0
  v_add_f32 v229, v229, v142
  v_fma_f32 v160, v160, s42, v223
  v_cvt_pk_bf16_f32 v138, v140, v141
  v_add_f32 v230, v230, v143
  v_cvt_pk_bf16_f32 v139, v142, v143
  v_xor_b32 v210, 0x10000, v210
  v_mfma_f32_32x32x16_bf16 v[48:63], v[204:207], v[128:131], v[48:63]
  ds_read_b128 v[200:203], v210 offset:0
  v_fma_f32 v161, v161, s42, v223
  v_fma_f32 v162, v162, s42, v223
  v_exp_f32 v160, v160
  v_fma_f32 v163, v163, s42, v223
  v_xor_b32 v211, 0x10000, v211
  v_mfma_f32_32x32x16_bf16 v[0:15], v[144:147], v[136:139], v[0:15]
  ds_read_b128 v[204:207], v211 offset:0
  buffer_store_dwordx4 a[216:219], v249, s[32:35], s49 offen offset:192 sc1
  v_exp_f32 v161, v161
  v_fma_f32 v164, v164, s42, v223
  v_xor_b32 v212, 0x10000, v212
  s_waitcnt lgkmcnt(4)
  v_mfma_f32_32x32x16_bf16 v[16:31], v[148:151], v[136:139], v[16:31]
  ds_read_b128 v[144:147], v212 offset:0
  v_exp_f32 v162, v162
  v_add_f32 v229, v229, v160
  v_fma_f32 v165, v165, s42, v223
  v_exp_f32 v163, v163
  v_xor_b32 v213, 0x10000, v213
  v_mfma_f32_32x32x16_bf16 v[32:47], v[152:155], v[136:139], v[32:47]
  ds_read_b128 v[148:151], v213 offset:0
  v_add_f32 v230, v230, v161
  v_fma_f32 v166, v166, s42, v223
  v_exp_f32 v164, v164
  v_xor_b32 v214, 0x10000, v214
  v_mfma_f32_32x32x16_bf16 v[48:63], v[156:159], v[136:139], v[48:63]
  ds_read_b128 v[152:155], v214 offset:0
  v_add_f32 v229, v229, v162
  v_cvt_pk_bf16_f32 v160, v160, v161
  v_fma_f32 v167, v167, s42, v223
  v_exp_f32 v165, v165
  v_xor_b32 v215, 0x10000, v215
  s_waitcnt lgkmcnt(4)
  v_mfma_f32_32x32x16_bf16 v[128:143], v[192:195], a[128:131], 0
  ds_read_b128 v[156:159], v215 offset:0
  v_add_f32 v230, v230, v163
  v_fma_f32 v168, v168, s42, v223
  v_exp_f32 v166, v166
  v_add_f32 v229, v229, v164
  v_mfma_f32_32x32x16_bf16 v[128:143], v[196:199], a[132:135], v[128:143]
  ds_read_b64_tr_b16 v[192:193], v216 offset:57344
  ds_read_b64_tr_b16 v[194:195], v216 offset:59392
  v_cvt_pk_bf16_f32 v161, v162, v163
  v_fma_f32 v169, v169, s42, v223
  v_exp_f32 v167, v167
  v_add_f32 v230, v230, v165
  v_mfma_f32_32x32x16_bf16 v[128:143], v[200:203], a[136:139], v[128:143]
  ds_read_b64_tr_b16 v[196:197], v217 offset:57344
  ds_read_b64_tr_b16 v[198:199], v217 offset:59392
  v_fma_f32 v170, v170, s42, v223
  v_exp_f32 v168, v168
  v_add_f32 v229, v229, v166
  s_waitcnt lgkmcnt(6)
  v_mfma_f32_32x32x16_bf16 v[128:143], v[204:207], a[140:143], v[128:143]
  ds_read_b64_tr_b16 v[200:201], v218 offset:57344
  ds_read_b64_tr_b16 v[202:203], v218 offset:59392
  v_cvt_pk_bf16_f32 v162, v164, v165
  v_fma_f32 v171, v171, s42, v223
  v_exp_f32 v169, v169
  v_add_f32 v230, v230, v167
  v_mfma_f32_32x32x16_bf16 v[128:143], v[144:147], a[144:147], v[128:143]
  ds_read_b64_tr_b16 v[204:205], v219 offset:57344
  ds_read_b64_tr_b16 v[206:207], v219 offset:59392
  v_fma_f32 v172, v172, s42, v223
  v_exp_f32 v170, v170
  v_add_f32 v229, v229, v168
  v_cvt_pk_bf16_f32 v163, v166, v167
  v_mfma_f32_32x32x16_bf16 v[128:143], v[148:151], a[148:151], v[128:143]
  ds_read_b64_tr_b16 v[144:145], v216 offset:61440
  ds_read_b64_tr_b16 v[146:147], v216 offset:63488
  v_fma_f32 v173, v173, s42, v223
  v_exp_f32 v171, v171
  v_add_f32 v230, v230, v169
  s_waitcnt lgkmcnt(8)
  v_mfma_f32_32x32x16_bf16 v[128:143], v[152:155], a[152:155], v[128:143]
  ds_read_b64_tr_b16 v[148:149], v217 offset:61440
  ds_read_b64_tr_b16 v[150:151], v217 offset:63488
  buffer_store_dwordx4 a[240:243], v249, s[32:35], s50 offen offset:128 sc1
  v_fma_f32 v174, v174, s42, v223
  v_exp_f32 v172, v172
  v_add_f32 v229, v229, v170
  v_mfma_f32_32x32x16_bf16 v[128:143], v[156:159], a[156:159], v[128:143]
  ds_read_b64_tr_b16 v[152:153], v218 offset:61440
  ds_read_b64_tr_b16 v[154:155], v218 offset:63488
  v_cvt_pk_bf16_f32 v168, v168, v169
  v_fma_f32 v175, v175, s42, v223
  v_exp_f32 v173, v173
  v_add_f32 v230, v230, v171
  v_mfma_f32_32x32x16_bf16 v[0:15], v[192:195], v[160:163], v[0:15]
  ds_read_b64_tr_b16 v[156:157], v219 offset:61440
  ds_read_b64_tr_b16 v[158:159], v219 offset:63488
  v_exp_f32 v174, v174
  s_waitcnt vmcnt(5)
  s_barrier
  v_xor_b32 v208, 0x10000, v208
  s_waitcnt lgkmcnt(8)
  v_mfma_f32_32x32x16_bf16 v[16:31], v[196:199], v[160:163], v[16:31]
  ds_read_b128 v[192:195], v208 offset:32768
  v_add_f32 v229, v229, v172
  v_cvt_pk_bf16_f32 v169, v170, v171
  v_exp_f32 v175, v175
  v_xor_b32 v209, 0x10000, v209
  v_mfma_f32_32x32x16_bf16 v[32:47], v[200:203], v[160:163], v[32:47]
  ds_read_b128 v[196:199], v209 offset:32768
  v_add_f32 v230, v230, v173
  v_add_f32 v229, v229, v174
  v_cvt_pk_bf16_f32 v170, v172, v173
  v_add_f32 v230, v230, v175
  v_cvt_pk_bf16_f32 v171, v174, v175
  v_xor_b32 v210, 0x10000, v210
  v_mfma_f32_32x32x16_bf16 v[48:63], v[204:207], v[160:163], v[48:63]
  ds_read_b128 v[200:203], v210 offset:32768
  v_fma_f32 v128, v128, s42, v223
  v_fma_f32 v129, v129, s42, v223
  v_fma_f32 v130, v130, s42, v223
  v_xor_b32 v211, 0x10000, v211
  s_waitcnt lgkmcnt(5)
  v_mfma_f32_32x32x16_bf16 v[0:15], v[144:147], v[168:171], v[0:15]
  ds_read_b128 v[204:207], v211 offset:32768
  v_exp_f32 v128, v128
  v_fma_f32 v131, v131, s42, v223
  v_exp_f32 v129, v129
  v_xor_b32 v212, 0x10000, v212
  v_mfma_f32_32x32x16_bf16 v[16:31], v[148:151], v[168:171], v[16:31]
  ds_read_b128 v[144:147], v212 offset:32768
  v_fma_f32 v132, v132, s42, v223
  v_exp_f32 v130, v130
  v_add_f32 v229, v229, v128
  v_fma_f32 v133, v133, s42, v223
  v_xor_b32 v213, 0x10000, v213
  v_mfma_f32_32x32x16_bf16 v[32:47], v[152:155], v[168:171], v[32:47]
  ds_read_b128 v[148:151], v213 offset:32768
  v_exp_f32 v131, v131
  v_add_f32 v230, v230, v129
  v_xor_b32 v214, 0x10000, v214
  s_waitcnt lgkmcnt(4)
  v_mfma_f32_32x32x16_bf16 v[48:63], v[156:159], v[168:171], v[48:63]
  ds_read_b128 v[152:155], v214 offset:32768
  v_fma_f32 v134, v134, s42, v223
  v_exp_f32 v132, v132
  v_add_f32 v229, v229, v130
  v_xor_b32 v215, 0x10000, v215
  v_mfma_f32_32x32x16_bf16 v[160:175], v[192:195], a[128:131], 0
  ds_read_b128 v[156:159], v215 offset:32768
  buffer_store_dwordx4 a[248:251], v249, s[32:35], s50 offen offset:192 sc1
  v_cvt_pk_bf16_f32 v128, v128, v129
  v_fma_f32 v135, v135, s42, v223
  v_exp_f32 v133, v133
  v_add_f32 v230, v230, v131
  v_mfma_f32_32x32x16_bf16 v[160:175], v[196:199], a[132:135], v[160:175]
  v_fma_f32 v136, v136, s42, v223
  v_exp_f32 v134, v134
  v_add_f32 v229, v229, v132
  v_cvt_pk_bf16_f32 v129, v130, v131
  s_waitcnt lgkmcnt(3)
  v_mfma_f32_32x32x16_bf16 v[160:175], v[200:203], a[136:139], v[160:175]
  v_fma_f32 v137, v137, s42, v223
  v_exp_f32 v135, v135
  v_add_f32 v230, v230, v133
  v_fma_f32 v138, v138, s42, v223
  v_exp_f32 v136, v136
  v_mfma_f32_32x32x16_bf16 v[160:175], v[204:207], a[140:143], v[160:175]
  v_add_f32 v229, v229, v134
  v_cvt_pk_bf16_f32 v130, v132, v133
  v_fma_f32 v139, v139, s42, v223
  v_exp_f32 v137, v137
  v_add_f32 v230, v230, v135
  v_mfma_f32_32x32x16_bf16 v[160:175], v[144:147], a[144:147], v[160:175]
  v_fma_f32 v140, v140, s42, v223
  v_exp_f32 v138, v138
  v_add_f32 v229, v229, v136
  v_cvt_pk_bf16_f32 v131, v134, v135
  s_waitcnt lgkmcnt(0)
  v_mfma_f32_32x32x16_bf16 v[160:175], v[148:151], a[148:151], v[160:175]
  v_fma_f32 v141, v141, s42, v223
  v_exp_f32 v139, v139
  v_add_f32 v230, v230, v137
  v_fma_f32 v142, v142, s42, v223
  v_mfma_f32_32x32x16_bf16 v[160:175], v[152:155], a[152:155], v[160:175]
  v_exp_f32 v140, v140
  v_add_f32 v229, v229, v138
  v_cvt_pk_bf16_f32 v136, v136, v137
  v_fma_f32 v143, v143, s42, v223
  v_mfma_f32_32x32x16_bf16 v[160:175], v[156:159], a[156:159], v[160:175]
  v_exp_f32 v141, v141
  v_add_f32 v230, v230, v139
  v_exp_f32 v142, v142
  v_mfma_f32_32x32x16_bf16 v[0:15], a[0:3], v[128:131], v[0:15]
  v_add_f32 v229, v229, v140
  v_cvt_pk_bf16_f32 v137, v138, v139
  v_exp_f32 v143, v143
  v_xor_b32 v208, 0x10000, v208
  v_mfma_f32_32x32x16_bf16 v[16:31], a[4:7], v[128:131], v[16:31]
  ds_read_b128 v[192:195], v208 offset:8192
  v_add_f32 v230, v230, v141
  s_nop 0
  v_fma_f32 v160, v160, s42, v223
  v_add_f32 v229, v229, v142
  v_cvt_pk_bf16_f32 v138, v140, v141
  v_xor_b32 v209, 0x10000, v209
  v_mfma_f32_32x32x16_bf16 v[32:47], a[8:11], v[128:131], v[32:47]
  ds_read_b128 v[196:199], v209 offset:8192
  buffer_store_dwordx4 a[212:215], v249, s[32:35], s55 offen offset:128 sc1
  v_add_f32 v230, v230, v143
  v_fma_f32 v161, v161, s42, v223
  v_cvt_pk_bf16_f32 v139, v142, v143
  v_xor_b32 v210, 0x10000, v210
  v_mfma_f32_32x32x16_bf16 v[48:63], a[12:15], v[128:131], v[48:63]
  ds_read_b128 v[200:203], v210 offset:8192
  v_fma_f32 v162, v162, s42, v223
  v_exp_f32 v160, v160
  v_fma_f32 v163, v163, s42, v223
  v_xor_b32 v211, 0x10000, v211
  v_mfma_f32_32x32x16_bf16 v[0:15], a[16:19], v[136:139], v[0:15]
  ds_read_b128 v[204:207], v211 offset:8192
  v_exp_f32 v161, v161
  v_fma_f32 v164, v164, s42, v223
  v_exp_f32 v162, v162
  v_xor_b32 v212, 0x10000, v212
  v_mfma_f32_32x32x16_bf16 v[16:31], a[20:23], v[136:139], v[16:31]
  ds_read_b128 v[144:147], v212 offset:8192
  v_add_f32 v229, v229, v160
  v_fma_f32 v165, v165, s42, v223
  v_exp_f32 v163, v163
  v_xor_b32 v213, 0x10000, v213
  v_mfma_f32_32x32x16_bf16 v[32:47], a[24:27], v[136:139], v[32:47]
  ds_read_b128 v[148:151], v213 offset:8192
  v_add_f32 v230, v230, v161
  v_fma_f32 v166, v166, s42, v223
  v_exp_f32 v164, v164
  v_xor_b32 v214, 0x10000, v214
  v_mfma_f32_32x32x16_bf16 v[48:63], a[28:31], v[136:139], v[48:63]
  ds_read_b128 v[152:155], v214 offset:8192
  v_add_f32 v229, v229, v162
  v_cvt_pk_bf16_f32 v160, v160, v161
  v_xor_b32 v215, 0x10000, v215
  s_waitcnt lgkmcnt(4)
  v_mfma_f32_32x32x16_bf16 v[128:143], v[192:195], a[128:131], 0
  ds_read_b128 v[156:159], v215 offset:8192
  v_fma_f32 v167, v167, s42, v223
  v_exp_f32 v165, v165
  v_add_f32 v230, v230, v163
  v_fma_f32 v168, v168, s42, v223
  v_mfma_f32_32x32x16_bf16 v[128:143], v[196:199], a[132:135], v[128:143]
  v_exp_f32 v166, v166
  v_add_f32 v229, v229, v164
  v_cvt_pk_bf16_f32 v161, v162, v163
  v_fma_f32 v169, v169, s42, v223
  v_exp_f32 v167, v167
  v_mfma_f32_32x32x16_bf16 v[128:143], v[200:203], a[136:139], v[128:143]
  v_add_f32 v230, v230, v165
  v_fma_f32 v170, v170, s42, v223
  v_exp_f32 v168, v168
  s_waitcnt lgkmcnt(2)
  v_mfma_f32_32x32x16_bf16 v[128:143], v[204:207], a[140:143], v[128:143]
  v_add_f32 v229, v229, v166
  v_cvt_pk_bf16_f32 v162, v164, v165
  v_fma_f32 v171, v171, s42, v223
  v_exp_f32 v169, v169
  v_add_f32 v230, v230, v167
  v_mfma_f32_32x32x16_bf16 v[128:143], v[144:147], a[144:147], v[128:143]
  buffer_store_dwordx4 a[220:223], v249, s[32:35], s55 offen offset:192 sc1
  v_fma_f32 v172, v172, s42, v223
  v_exp_f32 v170, v170
  v_add_f32 v229, v229, v168
  v_cvt_pk_bf16_f32 v163, v166, v167
  v_mfma_f32_32x32x16_bf16 v[128:143], v[148:151], a[148:151], v[128:143]
  v_fma_f32 v173, v173, s42, v223
  v_exp_f32 v171, v171
  v_add_f32 v230, v230, v169
  s_waitcnt lgkmcnt(0)
  v_mfma_f32_32x32x16_bf16 v[128:143], v[152:155], a[152:155], v[128:143]
  v_fma_f32 v174, v174, s42, v223
  v_exp_f32 v172, v172
  v_add_f32 v229, v229, v170
  v_mfma_f32_32x32x16_bf16 v[128:143], v[156:159], a[156:159], v[128:143]
  v_cvt_pk_bf16_f32 v168, v168, v169
  v_fma_f32 v175, v175, s42, v223
  v_exp_f32 v173, v173
  v_mfma_f32_32x32x16_bf16 v[0:15], a[32:35], v[160:163], v[0:15]
  v_add_f32 v230, v230, v171
  v_exp_f32 v174, v174
  v_add_f32 v229, v229, v172
  v_cvt_pk_bf16_f32 v169, v170, v171
  v_mfma_f32_32x32x16_bf16 v[16:31], a[36:39], v[160:163], v[16:31]
  ds_read_b128 v[192:195], v208 offset:16384
  v_exp_f32 v175, v175
  s_nop 0
  v_fma_f32 v128, v128, s42, v223
  v_add_f32 v230, v230, v173
  v_fma_f32 v129, v129, s42, v223
  v_mfma_f32_32x32x16_bf16 v[32:47], a[40:43], v[160:163], v[32:47]
  ds_read_b128 v[196:199], v209 offset:16384
  v_add_f32 v229, v229, v174
  v_fma_f32 v130, v130, s42, v223
  v_cvt_pk_bf16_f32 v170, v172, v173
  v_add_f32 v230, v230, v175
  v_cvt_pk_bf16_f32 v171, v174, v175
  v_mfma_f32_32x32x16_bf16 v[48:63], a[44:47], v[160:163], v[48:63]
  ds_read_b128 v[200:203], v210 offset:16384
  v_exp_f32 v128, v128
  v_fma_f32 v131, v131, s42, v223
  v_exp_f32 v129, v129
  v_mfma_f32_32x32x16_bf16 v[0:15], a[48:51], v[168:171], v[0:15]
  ds_read_b128 v[204:207], v211 offset:16384
  v_fma_f32 v132, v132, s42, v223
  v_exp_f32 v130, v130
  v_add_f32 v229, v229, v128
  v_mfma_f32_32x32x16_bf16 v[16:31], a[52:55], v[168:171], v[16:31]
  ds_read_b128 v[144:147], v212 offset:16384
  v_fma_f32 v133, v133, s42, v223
  v_exp_f32 v131, v131
  v_add_f32 v230, v230, v129
  v_mfma_f32_32x32x16_bf16 v[32:47], a[56:59], v[168:171], v[32:47]
  ds_read_b128 v[148:151], v213 offset:16384
  buffer_store_dwordx4 a[244:247], v249, s[32:35], s56 offen offset:128 sc1
  v_fma_f32 v134, v134, s42, v223
  v_exp_f32 v132, v132
  v_add_f32 v229, v229, v130
  v_mfma_f32_32x32x16_bf16 v[48:63], a[60:63], v[168:171], v[48:63]
  ds_read_b128 v[152:155], v214 offset:16384
  v_cvt_pk_bf16_f32 v128, v128, v129
  v_fma_f32 v135, v135, s42, v223
  v_exp_f32 v133, v133
  s_waitcnt lgkmcnt(4)
  v_mfma_f32_32x32x16_bf16 v[160:175], v[192:195], a[128:131], 0
  ds_read_b128 v[156:159], v215 offset:16384
  v_add_f32 v230, v230, v131
  v_fma_f32 v136, v136, s42, v223
  v_exp_f32 v134, v134
  v_mfma_f32_32x32x16_bf16 v[160:175], v[196:199], a[132:135], v[160:175]
  v_add_f32 v229, v229, v132
  v_cvt_pk_bf16_f32 v129, v130, v131
  v_fma_f32 v137, v137, s42, v223
  v_exp_f32 v135, v135
  v_mfma_f32_32x32x16_bf16 v[160:175], v[200:203], a[136:139], v[160:175]
  v_add_f32 v230, v230, v133
  v_fma_f32 v138, v138, s42, v223
  v_exp_f32 v136, v136
  s_waitcnt lgkmcnt(2)
  v_mfma_f32_32x32x16_bf16 v[160:175], v[204:207], a[140:143], v[160:175]
  v_add_f32 v229, v229, v134
  v_cvt_pk_bf16_f32 v130, v132, v133
  v_fma_f32 v139, v139, s42, v223
  v_exp_f32 v137, v137
  v_add_f32 v230, v230, v135
  v_mfma_f32_32x32x16_bf16 v[160:175], v[144:147], a[144:147], v[160:175]
  v_fma_f32 v140, v140, s42, v223
  v_exp_f32 v138, v138
  v_add_f32 v229, v229, v136
  v_cvt_pk_bf16_f32 v131, v134, v135
  v_mfma_f32_32x32x16_bf16 v[160:175], v[148:151], a[148:151], v[160:175]
  v_fma_f32 v141, v141, s42, v223
  v_exp_f32 v139, v139
  v_add_f32 v230, v230, v137
  s_waitcnt lgkmcnt(0)
  v_mfma_f32_32x32x16_bf16 v[160:175], v[152:155], a[152:155], v[160:175]
  v_fma_f32 v142, v142, s42, v223
  v_exp_f32 v140, v140
  v_add_f32 v229, v229, v138
  v_mfma_f32_32x32x16_bf16 v[160:175], v[156:159], a[156:159], v[160:175]
  v_cvt_pk_bf16_f32 v136, v136, v137
  v_fma_f32 v143, v143, s42, v223
  v_exp_f32 v141, v141
  v_mfma_f32_32x32x16_bf16 v[0:15], a[64:67], v[128:131], v[0:15]
  buffer_store_dwordx4 a[252:255], v249, s[32:35], s56 offen offset:192 sc1
  v_add_f32 v230, v230, v139
  v_exp_f32 v142, v142
  v_add_f32 v229, v229, v140
  v_mfma_f32_32x32x16_bf16 v[16:31], a[68:71], v[128:131], v[16:31]
  v_cvt_pk_bf16_f32 v137, v138, v139
  s_nop 1
  v_fma_f32 v160, v160, s42, v223
  v_exp_f32 v143, v143
  v_fma_f32 v161, v161, s42, v223
  v_add_f32 v230, v230, v141
  v_fma_f32 v162, v162, s42, v223
  v_exp_f32 v160, v160
  v_mfma_f32_32x32x16_bf16 v[32:47], a[72:75], v[128:131], v[32:47]
  v_add_f32 v229, v229, v142
  v_fma_f32 v163, v163, s42, v223
  v_cvt_pk_bf16_f32 v138, v140, v141
  v_exp_f32 v161, v161
  v_add_f32 v230, v230, v143
  v_fma_f32 v164, v164, s42, v223
  v_cvt_pk_bf16_f32 v139, v142, v143
  v_exp_f32 v162, v162
  v_mfma_f32_32x32x16_bf16 v[48:63], a[76:79], v[128:131], v[48:63]
  v_add_f32 v229, v229, v160
  v_fma_f32 v165, v165, s42, v223
  v_exp_f32 v163, v163
  v_add_f32 v230, v230, v161
  v_fma_f32 v166, v166, s42, v223
  v_exp_f32 v164, v164
  v_add_f32 v229, v229, v162
  v_mfma_f32_32x32x16_bf16 v[0:15], a[80:83], v[136:139], v[0:15]
  v_cvt_pk_bf16_f32 v160, v160, v161
  v_fma_f32 v167, v167, s42, v223
  v_exp_f32 v165, v165
  v_add_f32 v230, v230, v163
  v_fma_f32 v168, v168, s42, v223
  v_exp_f32 v166, v166
  v_add_f32 v229, v229, v164
  v_mfma_f32_32x32x16_bf16 v[16:31], a[84:87], v[136:139], v[16:31]
  v_cvt_pk_bf16_f32 v161, v162, v163
  v_fma_f32 v169, v169, s42, v223
  v_exp_f32 v167, v167
  v_add_f32 v230, v230, v165
  v_fma_f32 v170, v170, s42, v223
  v_exp_f32 v168, v168
  v_add_f32 v229, v229, v166
  v_cvt_pk_bf16_f32 v162, v164, v165
  v_mfma_f32_32x32x16_bf16 v[32:47], a[88:91], v[136:139], v[32:47]
  v_fma_f32 v171, v171, s42, v223
  v_exp_f32 v169, v169
  v_add_f32 v230, v230, v167
  v_fma_f32 v172, v172, s42, v223
  v_exp_f32 v170, v170
  v_add_f32 v229, v229, v168
  v_cvt_pk_bf16_f32 v163, v166, v167
  v_mfma_f32_32x32x16_bf16 v[48:63], a[92:95], v[136:139], v[48:63]
  v_fma_f32 v173, v173, s42, v223
  v_exp_f32 v171, v171
  v_add_f32 v230, v230, v169
  v_fma_f32 v174, v174, s42, v223
  v_exp_f32 v172, v172
  v_mfma_f32_32x32x16_bf16 v[0:15], a[96:99], v[160:163], v[0:15]
  v_add_f32 v229, v229, v170
  v_cvt_pk_bf16_f32 v168, v168, v169
  v_fma_f32 v175, v175, s42, v223
  v_exp_f32 v173, v173
  v_mfma_f32_32x32x16_bf16 v[16:31], a[100:103], v[160:163], v[16:31]
  v_add_f32 v230, v230, v171
  v_exp_f32 v174, v174
  v_add_f32 v229, v229, v172
  v_cvt_pk_bf16_f32 v169, v170, v171
  v_exp_f32 v175, v175
  v_mfma_f32_32x32x16_bf16 v[32:47], a[104:107], v[160:163], v[32:47]
  v_add_f32 v230, v230, v173
  v_add_f32 v229, v229, v174
  v_cvt_pk_bf16_f32 v170, v172, v173
  v_add_f32 v230, v230, v175
  v_cvt_pk_bf16_f32 v171, v174, v175
  v_mfma_f32_32x32x16_bf16 v[48:63], a[108:111], v[160:163], v[48:63]
  v_add_f32 v229, v229, v230
  v_mov_b32 v230, v229
  s_nop 1
  v_permlane32_swap_b32 v229, v230
  v_mfma_f32_32x32x16_bf16 v[0:15], a[112:115], v[168:171], v[0:15]
  v_add_f32 v229, v229, v230
  v_rcp_f32 v251, v229
  v_mfma_f32_32x32x16_bf16 v[16:31], a[116:119], v[168:171], v[16:31]
  v_cmp_ngt_f32 s[38:39], s44, v229
  s_nop 3
  v_mfma_f32_32x32x16_bf16 v[32:47], a[120:123], v[168:171], v[32:47]
  s_cmp_lg_u64 s[38:39], 0
  s_cselect_b32 s38, 32, 0
  s_or_b32 s45, s45, s38
  v_mfma_f32_32x32x16_bf16 v[48:63], a[124:127], v[168:171], v[48:63]
  v_mul_f32 v0, v0, v251
  v_mul_f32 v1, v1, v251
  v_mul_f32 v2, v2, v251
  v_mul_f32 v3, v3, v251
  v_mul_f32 v4, v4, v251
  v_mul_f32 v5, v5, v251
  v_mul_f32 v6, v6, v251
  v_mul_f32 v7, v7, v251
  v_mul_f32 v8, v8, v251
  v_mul_f32 v9, v9, v251
  v_mul_f32 v10, v10, v251
  v_mul_f32 v11, v11, v251
  v_mul_f32 v12, v12, v251
  v_mul_f32 v13, v13, v251
  v_mul_f32 v14, v14, v251
  v_mul_f32 v15, v15, v251
  v_cvt_pk_bf16_f32 v0, v0, v1
  v_cvt_pk_bf16_f32 v1, v2, v3
  v_cvt_pk_bf16_f32 v2, v4, v5
  v_cvt_pk_bf16_f32 v3, v6, v7
  v_cvt_pk_bf16_f32 v8, v8, v9
  v_cvt_pk_bf16_f32 v9, v10, v11
  v_cvt_pk_bf16_f32 v10, v12, v13
  v_cvt_pk_bf16_f32 v11, v14, v15
  ds_write_b64 v247, v[0:1]
  ds_write_b64 v248, v[2:3]
  ds_write_b64 v255, v[8:9]
  ds_write_b64 v254, v[10:11]
  ds_read_b128 a[192:195], v250 offset:0
  ds_read_b128 a[196:199], v250 offset:1024
  v_mul_f32 v16, v16, v251
  v_mul_f32 v17, v17, v251
  v_mul_f32 v18, v18, v251
  v_mul_f32 v19, v19, v251
  v_mul_f32 v20, v20, v251
  v_mul_f32 v21, v21, v251
  v_mul_f32 v22, v22, v251
  v_mul_f32 v23, v23, v251
  v_mul_f32 v24, v24, v251
  v_mul_f32 v25, v25, v251
  v_mul_f32 v26, v26, v251
  v_mul_f32 v27, v27, v251
  v_mul_f32 v28, v28, v251
  v_mul_f32 v29, v29, v251
  v_mul_f32 v30, v30, v251
  v_mul_f32 v31, v31, v251
  v_cvt_pk_bf16_f32 v16, v16, v17
  v_cvt_pk_bf16_f32 v17, v18, v19
  v_cvt_pk_bf16_f32 v18, v20, v21
  v_cvt_pk_bf16_f32 v19, v22, v23
  v_cvt_pk_bf16_f32 v24, v24, v25
  v_cvt_pk_bf16_f32 v25, v26, v27
  v_cvt_pk_bf16_f32 v26, v28, v29
  v_cvt_pk_bf16_f32 v27, v30, v31
  ds_write_b64 v247, v[16:17]
  ds_write_b64 v248, v[18:19]
  ds_write_b64 v255, v[24:25]
  ds_write_b64 v254, v[26:27]
  ds_read_b128 a[200:203], v250 offset:0
  ds_read_b128 a[204:207], v250 offset:1024
  s_waitcnt lgkmcnt(7)
  buffer_store_dwordx4 a[192:195], v249, s[32:35], s51 offen offset:0 sc1
  s_waitcnt lgkmcnt(6)
  buffer_store_dwordx4 a[196:199], v249, s[32:35], s57 offen offset:0 sc1
  v_mul_f32 v32, v32, v251
  v_mul_f32 v33, v33, v251
  v_mul_f32 v34, v34, v251
  v_mul_f32 v35, v35, v251
  v_mul_f32 v36, v36, v251
  v_mul_f32 v37, v37, v251
  v_mul_f32 v38, v38, v251
  v_mul_f32 v39, v39, v251
  v_mul_f32 v40, v40, v251
  v_mul_f32 v41, v41, v251
  v_mul_f32 v42, v42, v251
  v_mul_f32 v43, v43, v251
  v_mul_f32 v44, v44, v251
  v_mul_f32 v45, v45, v251
  v_mul_f32 v46, v46, v251
  v_mul_f32 v47, v47, v251
  v_cvt_pk_bf16_f32 v32, v32, v33
  v_cvt_pk_bf16_f32 v33, v34, v35
  v_cvt_pk_bf16_f32 v34, v36, v37
  v_cvt_pk_bf16_f32 v35, v38, v39
  v_cvt_pk_bf16_f32 v40, v40, v41
  v_cvt_pk_bf16_f32 v41, v42, v43
  v_cvt_pk_bf16_f32 v42, v44, v45
  v_cvt_pk_bf16_f32 v43, v46, v47
  ds_write_b64 v247, v[32:33]
  ds_write_b64 v248, v[34:35]
  ds_write_b64 v255, v[40:41]
  ds_write_b64 v254, v[42:43]
  ds_read_b128 a[208:211], v250 offset:0
  ds_read_b128 a[212:215], v250 offset:1024
  s_waitcnt lgkmcnt(7)
  buffer_store_dwordx4 a[200:203], v249, s[32:35], s51 offen offset:64 sc1
  s_waitcnt lgkmcnt(6)
  buffer_store_dwordx4 a[204:207], v249, s[32:35], s57 offen offset:64 sc1
  v_mul_f32 v48, v48, v251
  v_mul_f32 v49, v49, v251
  v_mul_f32 v50, v50, v251
  v_mul_f32 v51, v51, v251
  v_mul_f32 v52, v52, v251
  v_mul_f32 v53, v53, v251
  v_mul_f32 v54, v54, v251
  v_mul_f32 v55, v55, v251
  v_mul_f32 v56, v56, v251
  v_mul_f32 v57, v57, v251
  v_mul_f32 v58, v58, v251
  v_mul_f32 v59, v59, v251
  v_mul_f32 v60, v60, v251
  v_mul_f32 v61, v61, v251
  v_mul_f32 v62, v62, v251
  v_mul_f32 v63, v63, v251
  v_cvt_pk_bf16_f32 v48, v48, v49
  v_cvt_pk_bf16_f32 v49, v50, v51
  v_cvt_pk_bf16_f32 v50, v52, v53
  v_cvt_pk_bf16_f32 v51, v54, v55
  v_cvt_pk_bf16_f32 v56, v56, v57
  v_cvt_pk_bf16_f32 v57, v58, v59
  v_cvt_pk_bf16_f32 v58, v60, v61
  v_cvt_pk_bf16_f32 v59, v62, v63
  ds_write_b64 v247, v[48:49]
  ds_write_b64 v248, v[50:51]
  ds_write_b64 v255, v[56:57]
  ds_write_b64 v254, v[58:59]
  ds_read_b128 a[216:219], v250 offset:0
  ds_read_b128 a[220:223], v250 offset:1024
  s_waitcnt lgkmcnt(7)
  buffer_store_dwordx4 a[208:211], v249, s[32:35], s51 offen offset:128 sc1
  s_waitcnt lgkmcnt(6)
  buffer_store_dwordx4 a[212:215], v249, s[32:35], s57 offen offset:128 sc1
  s_waitcnt lgkmcnt(1)
  buffer_store_dwordx4 a[216:219], v249, s[32:35], s51 offen offset:192 sc1
  s_waitcnt lgkmcnt(0)
  buffer_store_dwordx4 a[220:223], v249, s[32:35], s57 offen offset:192 sc1
  s_waitcnt vmcnt(0) lgkmcnt(0)
  s_cmp_eq_u32 s45, 0
  s_cbranch_scc1 L_end
  s_nop 15
  s_nop 15
  s_mul_i32 s19, s13, 3
  s_mov_b32 s12, 0
L_slow_it:
  s_lshr_b32 s41, s45, s12
  s_and_b32 s41, s41, 1
  s_cmp_eq_u32 s41, 0
  s_cbranch_scc1 L_slow_next
  s_lshl_b32 s16, s12, 13
  s_add_u32 s17, s16, 8192
  buffer_load_dwordx4 a[128:131], v220, s[20:23], s16 offen offset:0
  buffer_load_dwordx4 a[132:135], v220, s[20:23], s16 offen offset:32
  buffer_load_dwordx4 a[136:139], v220, s[20:23], s16 offen offset:64
  buffer_load_dwordx4 a[140:143], v220, s[20:23], s16 offen offset:96
  buffer_load_dwordx4 a[144:147], v220, s[20:23], s16 offen offset:128
  buffer_load_dwordx4 a[148:151], v220, s[20:23], s16 offen offset:160
  buffer_load_dwordx4 a[152:155], v220, s[20:23], s16 offen offset:192
  buffer_load_dwordx4 a[156:159], v220, s[20:23], s16 offen offset:224
  v_mov_b32 v223, 0xff800000
  v_mov_b32 v224, 0xff800000
  s_waitcnt vmcnt(0)
  s_mov_b32 s14, 0
L_slow_p1:
  s_add_u32 s18, s14, s19
  s_sub_u32 s41, s18, 12
  s_cmp_ge_u32 s18, 12
  s_cselect_b32 s18, s41, s18
  s_lshl_b32 s18, s18, 13
  buffer_load_dwordx4 v[160:163], v220, s[24:27], s18 offen offset:0
  buffer_load_dwordx4 v[164:167], v220, s[24:27], s18 offen offset:32
  buffer_load_dwordx4 v[168:171], v220, s[24:27], s18 offen offset:64
  buffer_load_dwordx4 v[172:175], v220, s[24:27], s18 offen offset:96
  buffer_load_dwordx4 v[176:179], v220, s[24:27], s18 offen offset:128
  buffer_load_dwordx4 v[180:183], v220, s[24:27], s18 offen offset:160
  buffer_load_dwordx4 v[184:187], v220, s[24:27], s18 offen offset:192
  buffer_load_dwordx4 v[188:191], v220, s[24:27], s18 offen offset:224
  s_waitcnt vmcnt(0)
  v_mfma_f32_32x32x16_bf16 v[128:143], v[160:163], a[128:131], 0
  v_mfma_f32_32x32x16_bf16 v[128:143], v[164:167], a[132:135], v[128:143]
  v_mfma_f32_32x32x16_bf16 v[128:143], v[168:171], a[136:139], v[128:143]
  v_mfma_f32_32x32x16_bf16 v[128:143], v[172:175], a[140:143], v[128:143]
  v_mfma_f32_32x32x16_bf16 v[128:143], v[176:179], a[144:147], v[128:143]
  v_mfma_f32_32x32x16_bf16 v[128:143], v[180:183], a[148:151], v[128:143]
  v_mfma_f32_32x32x16_bf16 v[128:143], v[184:187], a[152:155], v[128:143]
  v_mfma_f32_32x32x16_bf16 v[128:143], v[188:191], a[156:159], v[128:143]
  s_nop 15
  v_max_f32 v223, v223, v128
  v_max_f32 v223, v223, v129
  v_max_f32 v223, v223, v130
  v_max_f32 v223, v223, v131
  v_max_f32 v223, v223, v132
  v_max_f32 v223, v223, v133
  v_max_f32 v223, v223, v134
  v_max_f32 v223, v223, v135
  v_max_f32 v223, v223, v136
  v_max_f32 v223, v223, v137
  v_max_f32 v223, v223, v138
  v_max_f32 v223, v223, v139
  v_max_f32 v223, v223, v140
  v_max_f32 v223, v223, v141
  v_max_f32 v223, v223, v142
  v_max_f32 v223, v223, v143
  s_add_u32 s14, s14, 1
  s_cmp_lt_u32 s14, 12
  s_cbranch_scc1 L_slow_p1
  v_mov_b32 v251, v223
  s_nop 2
  v_permlane32_swap_b32 v223, v251
  s_nop 1
  v_max_f32 v223, v223, v251
  v_mul_f32 v221, s43, v223
  v_mov_b32 v225, 0
  v_mov_b32 v0, 0
  v_mov_b32 v1, 0
  v_mov_b32 v2, 0
  v_mov_b32 v3, 0
  v_mov_b32 v4, 0
  v_mov_b32 v5, 0
  v_mov_b32 v6, 0
  v_mov_b32 v7, 0
  v_mov_b32 v8, 0
  v_mov_b32 v9, 0
  v_mov_b32 v10, 0
  v_mov_b32 v11, 0
  v_mov_b32 v12, 0
  v_mov_b32 v13, 0
  v_mov_b32 v14, 0
  v_mov_b32 v15, 0
  v_mov_b32 v16, 0
  v_mov_b32 v17, 0
  v_mov_b32 v18, 0
  v_mov_b32 v19, 0
  v_mov_b32 v20, 0
  v_mov_b32 v21, 0
  v_mov_b32 v22, 0
  v_mov_b32 v23, 0
  v_mov_b32 v24, 0
  v_mov_b32 v25, 0
  v_mov_b32 v26, 0
  v_mov_b32 v27, 0
  v_mov_b32 v28, 0
  v_mov_b32 v29, 0
  v_mov_b32 v30, 0
  v_mov_b32 v31, 0
  v_mov_b32 v32, 0
  v_mov_b32 v33, 0
  v_mov_b32 v34, 0
  v_mov_b32 v35, 0
  v_mov_b32 v36, 0
  v_mov_b32 v37, 0
  v_mov_b32 v38, 0
  v_mov_b32 v39, 0
  v_mov_b32 v40, 0
  v_mov_b32 v41, 0
  v_mov_b32 v42, 0
  v_mov_b32 v43, 0
  v_mov_b32 v44, 0
  v_mov_b32 v45, 0
  v_mov_b32 v46, 0
  v_mov_b32 v47, 0
  v_mov_b32 v48, 0
  v_mov_b32 v49, 0
  v_mov_b32 v50, 0
  v_mov_b32 v51, 0
  v_mov_b32 v52, 0
  v_mov_b32 v53, 0
  v_mov_b32 v54, 0
  v_mov_b32 v55, 0
  v_mov_b32 v56, 0
  v_mov_b32 v57, 0
  v_mov_b32 v58, 0
  v_mov_b32 v59, 0
  v_mov_b32 v60, 0
  v_mov_b32 v61, 0
  v_mov_b32 v62, 0
  v_mov_b32 v63, 0
  v_mov_b32 v64, 0
  v_mov_b32 v65, 0
  v_mov_b32 v66, 0
  v_mov_b32 v67, 0
  v_mov_b32 v68, 0
  v_mov_b32 v69, 0
  v_mov_b32 v70, 0
  v_mov_b32 v71, 0
  v_mov_b32 v72, 0
  v_mov_b32 v73, 0
  v_mov_b32 v74, 0
  v_mov_b32 v75, 0
  v_mov_b32 v76, 0
  v_mov_b32 v77, 0
  v_mov_b32 v78, 0
  v_mov_b32 v79, 0
  v_mov_b32 v80, 0
  v_mov_b32 v81, 0
  v_mov_b32 v82, 0
  v_mov_b32 v83, 0
  v_mov_b32 v84, 0
  v_mov_b32 v85, 0
  v_mov_b32 v86, 0
  v_mov_b32 v87, 0
  v_mov_b32 v88, 0
  v_mov_b32 v89, 0
  v_mov_b32 v90, 0
  v_mov_b32 v91, 0
  v_mov_b32 v92, 0
  v_mov_b32 v93, 0
  v_mov_b32 v94, 0
  v_mov_b32 v95, 0
  v_mov_b32 v96, 0
  v_mov_b32 v97, 0
  v_mov_b32 v98, 0
  v_mov_b32 v99, 0
  v_mov_b32 v100, 0
  v_mov_b32 v101, 0
  v_mov_b32 v102, 0
  v_mov_b32 v103, 0
  v_mov_b32 v104, 0
  v_mov_b32 v105, 0
  v_mov_b32 v106, 0
  v_mov_b32 v107, 0
  v_mov_b32 v108, 0
  v_mov_b32 v109, 0
  v_mov_b32 v110, 0
  v_mov_b32 v111, 0
  v_mov_b32 v112, 0
  v_mov_b32 v113, 0
  v_mov_b32 v114, 0
  v_mov_b32 v115, 0
  v_mov_b32 v116, 0
  v_mov_b32 v117, 0
  v_mov_b32 v118, 0
  v_mov_b32 v119, 0
  v_mov_b32 v120, 0
  v_mov_b32 v121, 0
  v_mov_b32 v122, 0
  v_mov_b32 v123, 0
  v_mov_b32 v124, 0
  v_mov_b32 v125, 0
  v_mov_b32 v126, 0
  v_mov_b32 v127, 0
  v_mov_b32 v241, v216
  v_mov_b32 v242, v217
  v_mov_b32 v243, v218
  v_mov_b32 v244, v219
  s_mov_b32 s14, 0
L_slow_p2:
  s_add_u32 s18, s14, s19
  s_sub_u32 s41, s18, 12
  s_cmp_ge_u32 s18, 12
  s_cselect_b32 s18, s41, s18
  s_lshl_b32 s18, s18, 13
  buffer_load_dwordx4 v[160:163], v220, s[24:27], s18 offen offset:0
  buffer_load_dwordx4 v[164:167], v220, s[24:27], s18 offen offset:32
  buffer_load_dwordx4 v[168:171], v220, s[24:27], s18 offen offset:64
  buffer_load_dwordx4 v[172:175], v220, s[24:27], s18 offen offset:96
  buffer_load_dwordx4 v[176:179], v220, s[24:27], s18 offen offset:128
  buffer_load_dwordx4 v[180:183], v220, s[24:27], s18 offen offset:160
  buffer_load_dwordx4 v[184:187], v220, s[24:27], s18 offen offset:192
  buffer_load_dwordx4 v[188:191], v220, s[24:27], s18 offen offset:224
  s_waitcnt vmcnt(0)
  v_mfma_f32_32x32x16_bf16 v[128:143], v[160:163], a[128:131], 0
  v_mfma_f32_32x32x16_bf16 v[128:143], v[164:167], a[132:135], v[128:143]
  v_mfma_f32_32x32x16_bf16 v[128:143], v[168:171], a[136:139], v[128:143]
  v_mfma_f32_32x32x16_bf16 v[128:143], v[172:175], a[140:143], v[128:143]
  v_mfma_f32_32x32x16_bf16 v[128:143], v[176:179], a[144:147], v[128:143]
  v_mfma_f32_32x32x16_bf16 v[128:143], v[180:183], a[148:151], v[128:143]
  v_mfma_f32_32x32x16_bf16 v[128:143], v[184:187], a[152:155], v[128:143]
  v_mfma_f32_32x32x16_bf16 v[128:143], v[188:191], a[156:159], v[128:143]
  s_nop 15
  v_fma_f32 v128, v128, s42, v221
  v_fma_f32 v129, v129, s42, v221
  v_fma_f32 v130, v130, s42, v221
  v_fma_f32 v131, v131, s42, v221
  v_fma_f32 v132, v132, s42, v221
  v_fma_f32 v133, v133, s42, v221
  v_fma_f32 v134, v134, s42, v221
  v_fma_f32 v135, v135, s42, v221
  v_fma_f32 v136, v136, s42, v221
  v_fma_f32 v137, v137, s42, v221
  v_fma_f32 v138, v138, s42, v221
  v_fma_f32 v139, v139, s42, v221
  v_fma_f32 v140, v140, s42, v221
  v_fma_f32 v141, v141, s42, v221
  v_fma_f32 v142, v142, s42, v221
  v_fma_f32 v143, v143, s42, v221
  v_exp_f32 v128, v128
  v_exp_f32 v129, v129
  v_exp_f32 v130, v130
  v_exp_f32 v131, v131
  v_exp_f32 v132, v132
  v_exp_f32 v133, v133
  v_exp_f32 v134, v134
  v_exp_f32 v135, v135
  v_exp_f32 v136, v136
  v_exp_f32 v137, v137
  v_exp_f32 v138, v138
  v_exp_f32 v139, v139
  v_exp_f32 v140, v140
  v_exp_f32 v141, v141
  v_exp_f32 v142, v142
  v_exp_f32 v143, v143
  s_nop 1
  v_add_f32 v225, v225, v128
  v_add_f32 v225, v225, v129
  v_add_f32 v225, v225, v130
  v_add_f32 v225, v225, v131
  v_add_f32 v225, v225, v132
  v_add_f32 v225, v225, v133
  v_add_f32 v225, v225, v134
  v_add_f32 v225, v225, v135
  v_add_f32 v225, v225, v136
  v_add_f32 v225, v225, v137
  v_add_f32 v225, v225, v138
  v_add_f32 v225, v225, v139
  v_add_f32 v225, v225, v140
  v_add_f32 v225, v225, v141
  v_add_f32 v225, v225, v142
  v_add_f32 v225, v225, v143
  v_cvt_pk_bf16_f32 v128, v128, v129
  v_cvt_pk_bf16_f32 v129, v130, v131
  v_cvt_pk_bf16_f32 v130, v132, v133
  v_cvt_pk_bf16_f32 v131, v134, v135
  v_cvt_pk_bf16_f32 v136, v136, v137
  v_cvt_pk_bf16_f32 v137, v138, v139
  v_cvt_pk_bf16_f32 v138, v140, v141
  v_cvt_pk_bf16_f32 v139, v142, v143
  s_nop 2
  ds_read_b64_tr_b16 v[192:193], v241 offset:0
  ds_read_b64_tr_b16 v[194:195], v241 offset:2048
  s_waitcnt lgkmcnt(0)
  v_mfma_f32_32x32x16_bf16 v[0:15], v[192:195], v[128:131], v[0:15]
  ds_read_b64_tr_b16 v[196:197], v242 offset:0
  ds_read_b64_tr_b16 v[198:199], v242 offset:2048
  s_waitcnt lgkmcnt(0)
  v_mfma_f32_32x32x16_bf16 v[16:31], v[196:199], v[128:131], v[16:31]
  ds_read_b64_tr_b16 v[200:201], v243 offset:0
  ds_read_b64_tr_b16 v[202:203], v243 offset:2048
  s_waitcnt lgkmcnt(0)
  v_mfma_f32_32x32x16_bf16 v[32:47], v[200:203], v[128:131], v[32:47]
  ds_read_b64_tr_b16 v[204:205], v244 offset:0
  ds_read_b64_tr_b16 v[206:207], v244 offset:2048
  s_waitcnt lgkmcnt(0)
  v_mfma_f32_32x32x16_bf16 v[48:63], v[204:207], v[128:131], v[48:63]
  ds_read_b64_tr_b16 v[192:193], v241 offset:4096
  ds_read_b64_tr_b16 v[194:195], v241 offset:6144
  s_waitcnt lgkmcnt(0)
  v_mfma_f32_32x32x16_bf16 v[0:15], v[192:195], v[136:139], v[0:15]
  ds_read_b64_tr_b16 v[196:197], v242 offset:4096
  ds_read_b64_tr_b16 v[198:199], v242 offset:6144
  s_waitcnt lgkmcnt(0)
  v_mfma_f32_32x32x16_bf16 v[16:31], v[196:199], v[136:139], v[16:31]
  ds_read_b64_tr_b16 v[200:201], v243 offset:4096
  ds_read_b64_tr_b16 v[202:203], v243 offset:6144
  s_waitcnt lgkmcnt(0)
  v_mfma_f32_32x32x16_bf16 v[32:47], v[200:203], v[136:139], v[32:47]
  ds_read_b64_tr_b16 v[204:205], v244 offset:4096
  ds_read_b64_tr_b16 v[206:207], v244 offset:6144
  s_waitcnt lgkmcnt(0)
  v_mfma_f32_32x32x16_bf16 v[48:63], v[204:207], v[136:139], v[48:63]
  s_nop 15
  v_add_u32 v241, 8192, v241
  v_add_u32 v242, 8192, v242
  v_add_u32 v243, 8192, v243
  v_add_u32 v244, 8192, v244
  s_add_u32 s14, s14, 1
  s_cmp_lt_u32 s14, 8
  s_cbranch_scc1 L_slow_p2
  s_add_u32 s18, s14, s19
  s_sub_u32 s41, s18, 12
  s_cmp_ge_u32 s18, 12
  s_cselect_b32 s18, s41, s18
  s_lshl_b32 s18, s18, 13
  buffer_load_dwordx4 v[160:163], v220, s[24:27], s18 offen offset:0
  buffer_load_dwordx4 v[164:167], v220, s[24:27], s18 offen offset:32
  buffer_load_dwordx4 v[168:171], v220, s[24:27], s18 offen offset:64
  buffer_load_dwordx4 v[172:175], v220, s[24:27], s18 offen offset:96
  buffer_load_dwordx4 v[176:179], v220, s[24:27], s18 offen offset:128
  buffer_load_dwordx4 v[180:183], v220, s[24:27], s18 offen offset:160
  buffer_load_dwordx4 v[184:187], v220, s[24:27], s18 offen offset:192
  buffer_load_dwordx4 v[188:191], v220, s[24:27], s18 offen offset:224
  s_waitcnt vmcnt(0)
  v_mfma_f32_32x32x16_bf16 v[128:143], v[160:163], a[128:131], 0
  v_mfma_f32_32x32x16_bf16 v[128:143], v[164:167], a[132:135], v[128:143]
  v_mfma_f32_32x32x16_bf16 v[128:143], v[168:171], a[136:139], v[128:143]
  v_mfma_f32_32x32x16_bf16 v[128:143], v[172:175], a[140:143], v[128:143]
  v_mfma_f32_32x32x16_bf16 v[128:143], v[176:179], a[144:147], v[128:143]
  v_mfma_f32_32x32x16_bf16 v[128:143], v[180:183], a[148:151], v[128:143]
  v_mfma_f32_32x32x16_bf16 v[128:143], v[184:187], a[152:155], v[128:143]
  v_mfma_f32_32x32x16_bf16 v[128:143], v[188:191], a[156:159], v[128:143]
  s_nop 15
  v_fma_f32 v128, v128, s42, v221
  v_fma_f32 v129, v129, s42, v221
  v_fma_f32 v130, v130, s42, v221
  v_fma_f32 v131, v131, s42, v221
  v_fma_f32 v132, v132, s42, v221
  v_fma_f32 v133, v133, s42, v221
  v_fma_f32 v134, v134, s42, v221
  v_fma_f32 v135, v135, s42, v221
  v_fma_f32 v136, v136, s42, v221
  v_fma_f32 v137, v137, s42, v221
  v_fma_f32 v138, v138, s42, v221
  v_fma_f32 v139, v139, s42, v221
  v_fma_f32 v140, v140, s42, v221
  v_fma_f32 v141, v141, s42, v221
  v_fma_f32 v142, v142, s42, v221
  v_fma_f32 v143, v143, s42, v221
  v_exp_f32 v128, v128
  v_exp_f32 v129, v129
  v_exp_f32 v130, v130
  v_exp_f32 v131, v131
  v_exp_f32 v132, v132
  v_exp_f32 v133, v133
  v_exp_f32 v134, v134
  v_exp_f32 v135, v135
  v_exp_f32 v136, v136
  v_exp_f32 v137, v137
  v_exp_f32 v138, v138
  v_exp_f32 v139, v139
  v_exp_f32 v140, v140
  v_exp_f32 v141, v141
  v_exp_f32 v142, v142
  v_exp_f32 v143, v143
  s_nop 1
  v_add_f32 v225, v225, v128
  v_add_f32 v225, v225, v129
  v_add_f32 v225, v225, v130
  v_add_f32 v225, v225, v131
  v_add_f32 v225, v225, v132
  v_add_f32 v225, v225, v133
  v_add_f32 v225, v225, v134
  v_add_f32 v225, v225, v135
  v_add_f32 v225, v225, v136
  v_add_f32 v225, v225, v137
  v_add_f32 v225, v225, v138
  v_add_f32 v225, v225, v139
  v_add_f32 v225, v225, v140
  v_add_f32 v225, v225, v141
  v_add_f32 v225, v225, v142
  v_add_f32 v225, v225, v143
  v_cvt_pk_bf16_f32 v128, v128, v129
  v_cvt_pk_bf16_f32 v129, v130, v131
  v_cvt_pk_bf16_f32 v130, v132, v133
  v_cvt_pk_bf16_f32 v131, v134, v135
  v_cvt_pk_bf16_f32 v136, v136, v137
  v_cvt_pk_bf16_f32 v137, v138, v139
  v_cvt_pk_bf16_f32 v138, v140, v141
  v_cvt_pk_bf16_f32 v139, v142, v143
  s_nop 2
  v_mfma_f32_32x32x16_bf16 v[0:15], a[0:3], v[128:131], v[0:15]
  v_mfma_f32_32x32x16_bf16 v[16:31], a[4:7], v[128:131], v[16:31]
  v_mfma_f32_32x32x16_bf16 v[32:47], a[8:11], v[128:131], v[32:47]
  v_mfma_f32_32x32x16_bf16 v[48:63], a[12:15], v[128:131], v[48:63]
  v_mfma_f32_32x32x16_bf16 v[0:15], a[16:19], v[136:139], v[0:15]
  v_mfma_f32_32x32x16_bf16 v[16:31], a[20:23], v[136:139], v[16:31]
  v_mfma_f32_32x32x16_bf16 v[32:47], a[24:27], v[136:139], v[32:47]
  v_mfma_f32_32x32x16_bf16 v[48:63], a[28:31], v[136:139], v[48:63]
  s_nop 15
  s_add_u32 s14, s14, 1
  s_add_u32 s18, s14, s19
  s_sub_u32 s41, s18, 12
  s_cmp_ge_u32 s18, 12
  s_cselect_b32 s18, s41, s18
  s_lshl_b32 s18, s18, 13
  buffer_load_dwordx4 v[160:163], v220, s[24:27], s18 offen offset:0
  buffer_load_dwordx4 v[164:167], v220, s[24:27], s18 offen offset:32
  buffer_load_dwordx4 v[168:171], v220, s[24:27], s18 offen offset:64
  buffer_load_dwordx4 v[172:175], v220, s[24:27], s18 offen offset:96
  buffer_load_dwordx4 v[176:179], v220, s[24:27], s18 offen offset:128
  buffer_load_dwordx4 v[180:183], v220, s[24:27], s18 offen offset:160
  buffer_load_dwordx4 v[184:187], v220, s[24:27], s18 offen offset:192
  buffer_load_dwordx4 v[188:191], v220, s[24:27], s18 offen offset:224
  s_waitcnt vmcnt(0)
  v_mfma_f32_32x32x16_bf16 v[128:143], v[160:163], a[128:131], 0
  v_mfma_f32_32x32x16_bf16 v[128:143], v[164:167], a[132:135], v[128:143]
  v_mfma_f32_32x32x16_bf16 v[128:143], v[168:171], a[136:139], v[128:143]
  v_mfma_f32_32x32x16_bf16 v[128:143], v[172:175], a[140:143], v[128:143]
  v_mfma_f32_32x32x16_bf16 v[128:143], v[176:179], a[144:147], v[128:143]
  v_mfma_f32_32x32x16_bf16 v[128:143], v[180:183], a[148:151], v[128:143]
  v_mfma_f32_32x32x16_bf16 v[128:143], v[184:187], a[152:155], v[128:143]
  v_mfma_f32_32x32x16_bf16 v[128:143], v[188:191], a[156:159], v[128:143]
  s_nop 15
  v_fma_f32 v128, v128, s42, v221
  v_fma_f32 v129, v129, s42, v221
  v_fma_f32 v130, v130, s42, v221
  v_fma_f32 v131, v131, s42, v221
  v_fma_f32 v132, v132, s42, v221
  v_fma_f32 v133, v133, s42, v221
  v_fma_f32 v134, v134, s42, v221
  v_fma_f32 v135, v135, s42, v221
  v_fma_f32 v136, v136, s42, v221
  v_fma_f32 v137, v137, s42, v221
  v_fma_f32 v138, v138, s42, v221
  v_fma_f32 v139, v139, s42, v221
  v_fma_f32 v140, v140, s42, v221
  v_fma_f32 v141, v141, s42, v221
  v_fma_f32 v142, v142, s42, v221
  v_fma_f32 v143, v143, s42, v221
  v_exp_f32 v128, v128
  v_exp_f32 v129, v129
  v_exp_f32 v130, v130
  v_exp_f32 v131, v131
  v_exp_f32 v132, v132
  v_exp_f32 v133, v133
  v_exp_f32 v134, v134
  v_exp_f32 v135, v135
  v_exp_f32 v136, v136
  v_exp_f32 v137, v137
  v_exp_f32 v138, v138
  v_exp_f32 v139, v139
  v_exp_f32 v140, v140
  v_exp_f32 v141, v141
  v_exp_f32 v142, v142
  v_exp_f32 v143, v143
  s_nop 1
  v_add_f32 v225, v225, v128
  v_add_f32 v225, v225, v129
  v_add_f32 v225, v225, v130
  v_add_f32 v225, v225, v131
  v_add_f32 v225, v225, v132
  v_add_f32 v225, v225, v133
  v_add_f32 v225, v225, v134
  v_add_f32 v225, v225, v135
  v_add_f32 v225, v225, v136
  v_add_f32 v225, v225, v137
  v_add_f32 v225, v225, v138
  v_add_f32 v225, v225, v139
  v_add_f32 v225, v225, v140
  v_add_f32 v225, v225, v141
  v_add_f32 v225, v225, v142
  v_add_f32 v225, v225, v143
  v_cvt_pk_bf16_f32 v128, v128, v129
  v_cvt_pk_bf16_f32 v129, v130, v131
  v_cvt_pk_bf16_f32 v130, v132, v133
  v_cvt_pk_bf16_f32 v131, v134, v135
  v_cvt_pk_bf16_f32 v136, v136, v137
  v_cvt_pk_bf16_f32 v137, v138, v139
  v_cvt_pk_bf16_f32 v138, v140, v141
  v_cvt_pk_bf16_f32 v139, v142, v143
  s_nop 2
  v_mfma_f32_32x32x16_bf16 v[0:15], a[32:35], v[128:131], v[0:15]
  v_mfma_f32_32x32x16_bf16 v[16:31], a[36:39], v[128:131], v[16:31]
  v_mfma_f32_32x32x16_bf16 v[32:47], a[40:43], v[128:131], v[32:47]
  v_mfma_f32_32x32x16_bf16 v[48:63], a[44:47], v[128:131], v[48:63]
  v_mfma_f32_32x32x16_bf16 v[0:15], a[48:51], v[136:139], v[0:15]
  v_mfma_f32_32x32x16_bf16 v[16:31], a[52:55], v[136:139], v[16:31]
  v_mfma_f32_32x32x16_bf16 v[32:47], a[56:59], v[136:139], v[32:47]
  v_mfma_f32_32x32x16_bf16 v[48:63], a[60:63], v[136:139], v[48:63]
  s_nop 15
  s_add_u32 s14, s14, 1
  s_add_u32 s18, s14, s19
  s_sub_u32 s41, s18, 12
  s_cmp_ge_u32 s18, 12
  s_cselect_b32 s18, s41, s18
  s_lshl_b32 s18, s18, 13
  buffer_load_dwordx4 v[160:163], v220, s[24:27], s18 offen offset:0
  buffer_load_dwordx4 v[164:167], v220, s[24:27], s18 offen offset:32
  buffer_load_dwordx4 v[168:171], v220, s[24:27], s18 offen offset:64
  buffer_load_dwordx4 v[172:175], v220, s[24:27], s18 offen offset:96
  buffer_load_dwordx4 v[176:179], v220, s[24:27], s18 offen offset:128
  buffer_load_dwordx4 v[180:183], v220, s[24:27], s18 offen offset:160
  buffer_load_dwordx4 v[184:187], v220, s[24:27], s18 offen offset:192
  buffer_load_dwordx4 v[188:191], v220, s[24:27], s18 offen offset:224
  s_waitcnt vmcnt(0)
  v_mfma_f32_32x32x16_bf16 v[128:143], v[160:163], a[128:131], 0
  v_mfma_f32_32x32x16_bf16 v[128:143], v[164:167], a[132:135], v[128:143]
  v_mfma_f32_32x32x16_bf16 v[128:143], v[168:171], a[136:139], v[128:143]
  v_mfma_f32_32x32x16_bf16 v[128:143], v[172:175], a[140:143], v[128:143]
  v_mfma_f32_32x32x16_bf16 v[128:143], v[176:179], a[144:147], v[128:143]
  v_mfma_f32_32x32x16_bf16 v[128:143], v[180:183], a[148:151], v[128:143]
  v_mfma_f32_32x32x16_bf16 v[128:143], v[184:187], a[152:155], v[128:143]
  v_mfma_f32_32x32x16_bf16 v[128:143], v[188:191], a[156:159], v[128:143]
  s_nop 15
  v_fma_f32 v128, v128, s42, v221
  v_fma_f32 v129, v129, s42, v221
  v_fma_f32 v130, v130, s42, v221
  v_fma_f32 v131, v131, s42, v221
  v_fma_f32 v132, v132, s42, v221
  v_fma_f32 v133, v133, s42, v221
  v_fma_f32 v134, v134, s42, v221
  v_fma_f32 v135, v135, s42, v221
  v_fma_f32 v136, v136, s42, v221
  v_fma_f32 v137, v137, s42, v221
  v_fma_f32 v138, v138, s42, v221
  v_fma_f32 v139, v139, s42, v221
  v_fma_f32 v140, v140, s42, v221
  v_fma_f32 v141, v141, s42, v221
  v_fma_f32 v142, v142, s42, v221
  v_fma_f32 v143, v143, s42, v221
  v_exp_f32 v128, v128
  v_exp_f32 v129, v129
  v_exp_f32 v130, v130
  v_exp_f32 v131, v131
  v_exp_f32 v132, v132
  v_exp_f32 v133, v133
  v_exp_f32 v134, v134
  v_exp_f32 v135, v135
  v_exp_f32 v136, v136
  v_exp_f32 v137, v137
  v_exp_f32 v138, v138
  v_exp_f32 v139, v139
  v_exp_f32 v140, v140
  v_exp_f32 v141, v141
  v_exp_f32 v142, v142
  v_exp_f32 v143, v143
  s_nop 1
  v_add_f32 v225, v225, v128
  v_add_f32 v225, v225, v129
  v_add_f32 v225, v225, v130
  v_add_f32 v225, v225, v131
  v_add_f32 v225, v225, v132
  v_add_f32 v225, v225, v133
  v_add_f32 v225, v225, v134
  v_add_f32 v225, v225, v135
  v_add_f32 v225, v225, v136
  v_add_f32 v225, v225, v137
  v_add_f32 v225, v225, v138
  v_add_f32 v225, v225, v139
  v_add_f32 v225, v225, v140
  v_add_f32 v225, v225, v141
  v_add_f32 v225, v225, v142
  v_add_f32 v225, v225, v143
  v_cvt_pk_bf16_f32 v128, v128, v129
  v_cvt_pk_bf16_f32 v129, v130, v131
  v_cvt_pk_bf16_f32 v130, v132, v133
  v_cvt_pk_bf16_f32 v131, v134, v135
  v_cvt_pk_bf16_f32 v136, v136, v137
  v_cvt_pk_bf16_f32 v137, v138, v139
  v_cvt_pk_bf16_f32 v138, v140, v141
  v_cvt_pk_bf16_f32 v139, v142, v143
  s_nop 2
  v_mfma_f32_32x32x16_bf16 v[0:15], a[64:67], v[128:131], v[0:15]
  v_mfma_f32_32x32x16_bf16 v[16:31], a[68:71], v[128:131], v[16:31]
  v_mfma_f32_32x32x16_bf16 v[32:47], a[72:75], v[128:131], v[32:47]
  v_mfma_f32_32x32x16_bf16 v[48:63], a[76:79], v[128:131], v[48:63]
  v_mfma_f32_32x32x16_bf16 v[0:15], a[80:83], v[136:139], v[0:15]
  v_mfma_f32_32x32x16_bf16 v[16:31], a[84:87], v[136:139], v[16:31]
  v_mfma_f32_32x32x16_bf16 v[32:47], a[88:91], v[136:139], v[32:47]
  v_mfma_f32_32x32x16_bf16 v[48:63], a[92:95], v[136:139], v[48:63]
  s_nop 15
  s_add_u32 s14, s14, 1
  s_add_u32 s18, s14, s19
  s_sub_u32 s41, s18, 12
  s_cmp_ge_u32 s18, 12
  s_cselect_b32 s18, s41, s18
  s_lshl_b32 s18, s18, 13
  buffer_load_dwordx4 v[160:163], v220, s[24:27], s18 offen offset:0
  buffer_load_dwordx4 v[164:167], v220, s[24:27], s18 offen offset:32
  buffer_load_dwordx4 v[168:171], v220, s[24:27], s18 offen offset:64
  buffer_load_dwordx4 v[172:175], v220, s[24:27], s18 offen offset:96
  buffer_load_dwordx4 v[176:179], v220, s[24:27], s18 offen offset:128
  buffer_load_dwordx4 v[180:183], v220, s[24:27], s18 offen offset:160
  buffer_load_dwordx4 v[184:187], v220, s[24:27], s18 offen offset:192
  buffer_load_dwordx4 v[188:191], v220, s[24:27], s18 offen offset:224
  s_waitcnt vmcnt(0)
  v_mfma_f32_32x32x16_bf16 v[128:143], v[160:163], a[128:131], 0
  v_mfma_f32_32x32x16_bf16 v[128:143], v[164:167], a[132:135], v[128:143]
  v_mfma_f32_32x32x16_bf16 v[128:143], v[168:171], a[136:139], v[128:143]
  v_mfma_f32_32x32x16_bf16 v[128:143], v[172:175], a[140:143], v[128:143]
  v_mfma_f32_32x32x16_bf16 v[128:143], v[176:179], a[144:147], v[128:143]
  v_mfma_f32_32x32x16_bf16 v[128:143], v[180:183], a[148:151], v[128:143]
  v_mfma_f32_32x32x16_bf16 v[128:143], v[184:187], a[152:155], v[128:143]
  v_mfma_f32_32x32x16_bf16 v[128:143], v[188:191], a[156:159], v[128:143]
  s_nop 15
  v_fma_f32 v128, v128, s42, v221
  v_fma_f32 v129, v129, s42, v221
  v_fma_f32 v130, v130, s42, v221
  v_fma_f32 v131, v131, s42, v221
  v_fma_f32 v132, v132, s42, v221
  v_fma_f32 v133, v133, s42, v221
  v_fma_f32 v134, v134, s42, v221
  v_fma_f32 v135, v135, s42, v221
  v_fma_f32 v136, v136, s42, v221
  v_fma_f32 v137, v137, s42, v221
  v_fma_f32 v138, v138, s42, v221
  v_fma_f32 v139, v139, s42, v221
  v_fma_f32 v140, v140, s42, v221
  v_fma_f32 v141, v141, s42, v221
  v_fma_f32 v142, v142, s42, v221
  v_fma_f32 v143, v143, s42, v221
  v_exp_f32 v128, v128
  v_exp_f32 v129, v129
  v_exp_f32 v130, v130
  v_exp_f32 v131, v131
  v_exp_f32 v132, v132
  v_exp_f32 v133, v133
  v_exp_f32 v134, v134
  v_exp_f32 v135, v135
  v_exp_f32 v136, v136
  v_exp_f32 v137, v137
  v_exp_f32 v138, v138
  v_exp_f32 v139, v139
  v_exp_f32 v140, v140
  v_exp_f32 v141, v141
  v_exp_f32 v142, v142
  v_exp_f32 v143, v143
  s_nop 1
  v_add_f32 v225, v225, v128
  v_add_f32 v225, v225, v129
  v_add_f32 v225, v225, v130
  v_add_f32 v225, v225, v131
  v_add_f32 v225, v225, v132
  v_add_f32 v225, v225, v133
  v_add_f32 v225, v225, v134
  v_add_f32 v225, v225, v135
  v_add_f32 v225, v225, v136
  v_add_f32 v225, v225, v137
  v_add_f32 v225, v225, v138
  v_add_f32 v225, v225, v139
  v_add_f32 v225, v225, v140
  v_add_f32 v225, v225, v141
  v_add_f32 v225, v225, v142
  v_add_f32 v225, v225, v143
  v_cvt_pk_bf16_f32 v128, v128, v129
  v_cvt_pk_bf16_f32 v129, v130, v131
  v_cvt_pk_bf16_f32 v130, v132, v133
  v_cvt_pk_bf16_f32 v131, v134, v135
  v_cvt_pk_bf16_f32 v136, v136, v137
  v_cvt_pk_bf16_f32 v137, v138, v139
  v_cvt_pk_bf16_f32 v138, v140, v141
  v_cvt_pk_bf16_f32 v139, v142, v143
  s_nop 2
  v_mfma_f32_32x32x16_bf16 v[0:15], a[96:99], v[128:131], v[0:15]
  v_mfma_f32_32x32x16_bf16 v[16:31], a[100:103], v[128:131], v[16:31]
  v_mfma_f32_32x32x16_bf16 v[32:47], a[104:107], v[128:131], v[32:47]
  v_mfma_f32_32x32x16_bf16 v[48:63], a[108:111], v[128:131], v[48:63]
  v_mfma_f32_32x32x16_bf16 v[0:15], a[112:115], v[136:139], v[0:15]
  v_mfma_f32_32x32x16_bf16 v[16:31], a[116:119], v[136:139], v[16:31]
  v_mfma_f32_32x32x16_bf16 v[32:47], a[120:123], v[136:139], v[32:47]
  v_mfma_f32_32x32x16_bf16 v[48:63], a[124:127], v[136:139], v[48:63]
  s_nop 15
  s_add_u32 s14, s14, 1
  v_mov_b32 v226, v225
  s_nop 2
  v_permlane32_swap_b32 v225, v226
  s_nop 1
  v_add_f32 v225, v225, v226
  v_rcp_f32 v251, v225
  s_nop 1
  v_mul_f32 v0, v0, v251
  v_mul_f32 v1, v1, v251
  v_mul_f32 v2, v2, v251
  v_mul_f32 v3, v3, v251
  v_mul_f32 v4, v4, v251
  v_mul_f32 v5, v5, v251
  v_mul_f32 v6, v6, v251
  v_mul_f32 v7, v7, v251
  v_mul_f32 v8, v8, v251
  v_mul_f32 v9, v9, v251
  v_mul_f32 v10, v10, v251
  v_mul_f32 v11, v11, v251
  v_mul_f32 v12, v12, v251
  v_mul_f32 v13, v13, v251
  v_mul_f32 v14, v14, v251
  v_mul_f32 v15, v15, v251
  v_cvt_pk_bf16_f32 v0, v0, v1
  v_cvt_pk_bf16_f32 v1, v2, v3
  v_cvt_pk_bf16_f32 v2, v4, v5
  v_cvt_pk_bf16_f32 v3, v6, v7
  v_cvt_pk_bf16_f32 v8, v8, v9
  v_cvt_pk_bf16_f32 v9, v10, v11
  v_cvt_pk_bf16_f32 v10, v12, v13
  v_cvt_pk_bf16_f32 v11, v14, v15
  s_nop 2
  v_permlane32_swap_b32 v0, v2
  v_permlane32_swap_b32 v1, v3
  v_permlane32_swap_b32 v8, v10
  v_permlane32_swap_b32 v9, v11
  s_nop 1
  buffer_store_dwordx4 v[0:3], v220, s[32:35], s16 offen offset:0
  buffer_store_dwordx4 v[8:11], v220, s[32:35], s16 offen offset:32
  v_mul_f32 v16, v16, v251
  v_mul_f32 v17, v17, v251
  v_mul_f32 v18, v18, v251
  v_mul_f32 v19, v19, v251
  v_mul_f32 v20, v20, v251
  v_mul_f32 v21, v21, v251
  v_mul_f32 v22, v22, v251
  v_mul_f32 v23, v23, v251
  v_mul_f32 v24, v24, v251
  v_mul_f32 v25, v25, v251
  v_mul_f32 v26, v26, v251
  v_mul_f32 v27, v27, v251
  v_mul_f32 v28, v28, v251
  v_mul_f32 v29, v29, v251
  v_mul_f32 v30, v30, v251
  v_mul_f32 v31, v31, v251
  v_cvt_pk_bf16_f32 v16, v16, v17
  v_cvt_pk_bf16_f32 v17, v18, v19
  v_cvt_pk_bf16_f32 v18, v20, v21
  v_cvt_pk_bf16_f32 v19, v22, v23
  v_cvt_pk_bf16_f32 v24, v24, v25
  v_cvt_pk_bf16_f32 v25, v26, v27
  v_cvt_pk_bf16_f32 v26, v28, v29
  v_cvt_pk_bf16_f32 v27, v30, v31
  s_nop 2
  v_permlane32_swap_b32 v16, v18
  v_permlane32_swap_b32 v17, v19
  v_permlane32_swap_b32 v24, v26
  v_permlane32_swap_b32 v25, v27
  s_nop 1
  buffer_store_dwordx4 v[16:19], v220, s[32:35], s16 offen offset:64
  buffer_store_dwordx4 v[24:27], v220, s[32:35], s16 offen offset:96
  v_mul_f32 v32, v32, v251
  v_mul_f32 v33, v33, v251
  v_mul_f32 v34, v34, v251
  v_mul_f32 v35, v35, v251
  v_mul_f32 v36, v36, v251
  v_mul_f32 v37, v37, v251
  v_mul_f32 v38, v38, v251
  v_mul_f32 v39, v39, v251
  v_mul_f32 v40, v40, v251
  v_mul_f32 v41, v41, v251
  v_mul_f32 v42, v42, v251
  v_mul_f32 v43, v43, v251
  v_mul_f32 v44, v44, v251
  v_mul_f32 v45, v45, v251
  v_mul_f32 v46, v46, v251
  v_mul_f32 v47, v47, v251
  v_cvt_pk_bf16_f32 v32, v32, v33
  v_cvt_pk_bf16_f32 v33, v34, v35
  v_cvt_pk_bf16_f32 v34, v36, v37
  v_cvt_pk_bf16_f32 v35, v38, v39
  v_cvt_pk_bf16_f32 v40, v40, v41
  v_cvt_pk_bf16_f32 v41, v42, v43
  v_cvt_pk_bf16_f32 v42, v44, v45
  v_cvt_pk_bf16_f32 v43, v46, v47
  s_nop 2
  v_permlane32_swap_b32 v32, v34
  v_permlane32_swap_b32 v33, v35
  v_permlane32_swap_b32 v40, v42
  v_permlane32_swap_b32 v41, v43
  s_nop 1
  buffer_store_dwordx4 v[32:35], v220, s[32:35], s16 offen offset:128
  buffer_store_dwordx4 v[40:43], v220, s[32:35], s16 offen offset:160
  v_mul_f32 v48, v48, v251
  v_mul_f32 v49, v49, v251
  v_mul_f32 v50, v50, v251
  v_mul_f32 v51, v51, v251
  v_mul_f32 v52, v52, v251
  v_mul_f32 v53, v53, v251
  v_mul_f32 v54, v54, v251
  v_mul_f32 v55, v55, v251
  v_mul_f32 v56, v56, v251
  v_mul_f32 v57, v57, v251
  v_mul_f32 v58, v58, v251
  v_mul_f32 v59, v59, v251
  v_mul_f32 v60, v60, v251
  v_mul_f32 v61, v61, v251
  v_mul_f32 v62, v62, v251
  v_mul_f32 v63, v63, v251
  v_cvt_pk_bf16_f32 v48, v48, v49
  v_cvt_pk_bf16_f32 v49, v50, v51
  v_cvt_pk_bf16_f32 v50, v52, v53
  v_cvt_pk_bf16_f32 v51, v54, v55
  v_cvt_pk_bf16_f32 v56, v56, v57
  v_cvt_pk_bf16_f32 v57, v58, v59
  v_cvt_pk_bf16_f32 v58, v60, v61
  v_cvt_pk_bf16_f32 v59, v62, v63
  s_nop 2
  v_permlane32_swap_b32 v48, v50
  v_permlane32_swap_b32 v49, v51
  v_permlane32_swap_b32 v56, v58
  v_permlane32_swap_b32 v57, v59
  s_nop 1
  buffer_store_dwordx4 v[48:51], v220, s[32:35], s16 offen offset:192
  buffer_store_dwordx4 v[56:59], v220, s[32:35], s16 offen offset:224
  s_waitcnt vmcnt(0)
L_slow_next:
  s_add_u32 s12, s12, 1
  s_cmp_lt_u32 s12, 6
  s_cbranch_scc1 L_slow_it
L_end:
  s_endpgm
.section .rodata,"a"
.p2align 6
.amdhsa_kernel standalone__gqa_softmax__near_ridge_kernel
  .amdhsa_next_free_vgpr 512
  .amdhsa_next_free_sgpr 102
  .amdhsa_accum_offset 256
  .amdhsa_group_segment_fixed_size 0
  .amdhsa_kernarg_size 48
  .amdhsa_user_sgpr_count 2
  .amdhsa_user_sgpr_kernarg_segment_ptr 1
  .amdhsa_system_sgpr_workgroup_id_x 1
.end_amdhsa_kernel
```
